```python
import torch

def _softmax(x, axis=-1):
    return torch.softmax(x, dim=axis)
def _gelu(x):
    return torch.nn.functional.gelu(x, approximate="tanh")
def _silu(x):
    return torch.nn.functional.silu(x)
def _sigmoid(x):
    return torch.sigmoid(x)
def _layernorm(x, axis=-1, eps=1e-5):
    m = x.mean(dim=axis, keepdim=True)
    v = x.var(dim=axis, keepdim=True, unbiased=False)
    return (x - m) / torch.sqrt(v + eps)
def _scatter_add(tgt, idx, src, axis=0):
    return tgt.clone().index_add_(axis, idx, src)
def _segment_sum(src, seg, n):
    out = torch.zeros((n,) + src.shape[1:], dtype=src.dtype)
    return out.index_add_(0, seg, src)
def _pad(x, pw):
    flat = tuple(v for pair in reversed(pw) for v in pair)
    return torch.nn.functional.pad(x, flat)

kernel_name = 'interleave_layers__linear_attn_block__linear_kernel_hedgehog__prompt'

def setup_inputs():

    _w = (lambda a: (lambda t: t.to(torch.bfloat16) if t.is_floating_point() else t)(torch.as_tensor(a)))
    def _A_setup():
        B, S, D = 1, 2048, 640
        return {
            "x": _w((lambda *s: torch.randn(*s, dtype=torch.bfloat16) * 0.4)(B, S, D)),
            "wqkv": _w((lambda *s: torch.randn(*s, dtype=torch.bfloat16) * 0.8)(D, 3 * D)),
            "wo": _w((lambda *s: torch.randn(*s, dtype=torch.bfloat16) * 0.8)(D, D)),
        }
    _A_in = _A_setup()

    def _B_setup():
        B, S, D, H = 1, 2048, 640, 32
        Dh = D // H
        return {
            "x": _w((lambda *s: torch.randn(*s, dtype=torch.bfloat16) * 0.4)(B, S, D)),
            "wqkv": _w((lambda *s: torch.randn(*s, dtype=torch.bfloat16) * 0.8)(D, 3 * D)),
            "w_phi": _w((lambda *s: torch.randn(*s, dtype=torch.bfloat16) * 0.8)(H, Dh, Dh) * (Dh ** -0.5)),
            "wo": _w((lambda *s: torch.randn(*s, dtype=torch.bfloat16) * 0.4)(D, D)),
        }
    _B_in = _B_setup()

    return {
        "A_x": _A_in["x"],
        "A_wqkv": _A_in["wqkv"],
        "A_wo": _A_in["wo"],
        "B_x": _B_in["x"],
        "B_wqkv": _B_in["wqkv"],
        "B_w_phi": _B_in["w_phi"],
        "B_wo": _B_in["wo"],
    }

def reference(A_x, A_wqkv, A_wo, B_x, B_wqkv, B_w_phi, B_wo):
    def _A_ref(x, wqkv, wo):
        B, S, D = x.shape
        H = 32; Dh = D // H
        qkv = (lambda x, *d: x.permute(*d))((x @ wqkv).reshape(B, S, 3, H, Dh), 2, 0, 3, 1, 4)
        q, k, v = qkv[0], qkv[1], qkv[2]
        phi = lambda t: torch.where(t > 0, t + 1, torch.exp(t)) + 1e-6
        pq, pk = phi(q), phi(k)
        kv = torch.einsum("bhsd,bhse->bhde", pk, v)
        z = torch.einsum("bhsd->bhd", pk)
        num = torch.einsum("bhqd,bhde->bhqe", pq, kv)
        den = torch.einsum("bhqd,bhd->bhq", pq, z)[..., None] + 1e-6
        o = num / den
        return (lambda x, *d: x.permute(*d))(o, 0, 2, 1, 3).reshape(B, S, D) @ wo

    def _B_ref(x, wqkv, w_phi, wo):
        B, S, D = x.shape
        H = 32; Dh = D // H
        qkv = (lambda x, *d: x.permute(*d))((x @ wqkv).reshape(B, S, 3, H, Dh), 2, 0, 3, 1, 4)
        q, k, v = qkv[0], qkv[1], qkv[2]
        pq = torch.einsum("bhsd,hdf->bhsf", q, w_phi)
        pk = torch.einsum("bhsd,hdf->bhsf", k, w_phi)
        phi_q = torch.concatenate([_softmax(pq, axis=-1), _softmax(-pq, axis=-1)], axis=-1)
        phi_k = torch.concatenate([_softmax(pk, axis=-1), _softmax(-pk, axis=-1)], axis=-1)
        kv = torch.einsum("bhsf,bhsd->bhfd", phi_k, v)
        z  = torch.einsum("bhsf->bhf", phi_k)
        num = torch.einsum("bhqf,bhfd->bhqd", phi_q, kv)
        den = torch.einsum("bhqf,bhf->bhq", phi_q, z)[..., None] + 1e-6
        o = num / den
        return (lambda x, *d: x.permute(*d))(o, 0, 2, 1, 3).reshape(B, S, D) @ wo

    x = A_x
    x = x + _A_ref(_layernorm(x, axis=-1), A_wqkv, A_wo)
    x = x + _B_ref(_layernorm(x, axis=-1), B_wqkv, B_w_phi, B_wo)
    x = x + _A_ref(_layernorm(x, axis=-1), A_wqkv, A_wo)
    x = x + _B_ref(_layernorm(x, axis=-1), B_wqkv, B_w_phi, B_wo)
    return x
```

```asm
; @launch grid=(256,1,1) block=(256,1,1) lds=163840
.amdgcn_target "amdgcn-amd-amdhsa--gfx950"
.text
.globl interleave_layers__linear_attn_block__linear_kernel_hedgehog__prompt_kernel
.p2align 8
.type interleave_layers__linear_attn_block__linear_kernel_hedgehog__prompt_kernel,@function
interleave_layers__linear_attn_block__linear_kernel_hedgehog__prompt_kernel:
    s_cmp_ge_u32 s2, 256
    s_cbranch_scc1 END
    s_load_dwordx2 s[4:5], s[0:1], 0
    s_load_dwordx2 s[8:9], s[0:1], 8
    s_load_dwordx2 s[12:13], s[0:1], 16
    s_load_dwordx2 s[16:17], s[0:1], 32
    s_load_dwordx2 s[20:21], s[0:1], 40
    s_load_dwordx2 s[24:25], s[0:1], 48
    s_load_dwordx2 s[28:29], s[0:1], 56
    s_load_dwordx2 s[32:33], s[0:1], 64
    s_load_dwordx2 s[36:37], s[0:1], 72
    s_mov_b32 s6, 0x280000
    s_mov_b32 s7, 0x00020000
    s_mov_b32 s10, 0x258000
    s_mov_b32 s11, 0x00020000
    s_mov_b32 s14, 0xc8000
    s_mov_b32 s15, 0x00020000
    s_mov_b32 s18, 0x258000
    s_mov_b32 s19, 0x00020000
    s_mov_b32 s22, 0x6400
    s_mov_b32 s23, 0x00020000
    s_mov_b32 s26, 0xc8000
    s_mov_b32 s27, 0x00020000
    s_mov_b32 s30, 0x280000
    s_mov_b32 s31, 0x00020000
    s_mov_b32 s34, 0x100
    s_mov_b32 s35, 0x00020000
    s_mov_b32 s38, 0x10000000
    s_mov_b32 s39, 0x00020000
    v_and_b32 v3, 63, v0
    v_and_b32 v1, 15, v0
    v_bfe_u32 v2, v0, 4, 2
    v_lshrrev_b32 v61, 6, v0
    s_nop 0
    v_readfirstlane_b32 s42, v61
    s_getpc_b64 s[52:53]
    s_nop 3
PCB:
    s_mov_b32 s54, END-PCB
    s_mov_b32 s55, 0x00020000
    s_lshr_b32 s66, s2, 3
    s_lshl_b32 s66, s66, 2
    s_add_u32 s66, s66, s42
    s_lshl_b32 s66, s66, 7
    s_and_b32 s53, s53, 0xffff
    v_lshl_add_u32 v61, v3, 14, s66
    s_mov_b64 exec, 7
    buffer_load_dword a248, v61, s[52:55], 0 offen
    s_mov_b64 exec, -1
    s_and_b32 s40, s2, 7
    s_lshl_b32 s40, s40, 1
    s_lshr_b32 s66, s2, 7
    s_add_u32 s40, s40, s66
    s_lshr_b32 s41, s2, 3
    s_and_b32 s41, s41, 15
    v_lshlrev_b32 v4, 4, v3
    s_mov_b32 s87, 0xf00
    s_cmp_eq_u32 s42, 3
    s_cselect_b32 s87, 0x500, s87
    v_mul_u32_u24 v61, 205, v3
    v_lshrrev_b32 v61, 10, v61
    v_mul_u32_u24 v62, 80, v61
    v_sub_u32 v62, v4, v62
    v_mad_u32_u24 v56, v61, s87, v62
    s_mul_i32 s66, s41, 80
    s_mul_i32 s67, s40, 40
    s_mul_i32 s86, s67, s87
    s_add_u32 s86, s86, s66
    s_mov_b32 s67, 0x0
    s_cmp_eq_u32 s42, 1
    s_cselect_b32 s67, 0x500, s67
    s_cmp_eq_u32 s42, 2
    s_cselect_b32 s67, 0xa00, s67
    s_add_u32 s86, s86, s67
    s_mul_i32 s87, s87, 12
    s_mul_i32 s81, s42, 3328
    s_add_u32 s81, s81, 125952
    s_lshl_b32 s67, s40, 2
    s_add_u32 s67, s67, s42
    s_mul_i32 s100, s67, 40960
    s_add_u32 s101, s100, 20480
    s_add_u32 s62, s100, s66
    s_add_u32 s63, s62, 20480
    v_mul_u32_u24 v48, 1280, v1
    v_and_b32 v61, 1, v2
    v_lshl_add_u32 v49, v61, 3, v48
    v_add_u32 v49, 64, v49
    v_lshl_add_u32 v48, v2, 3, v48
    v_mov_b32 v63, 0
    v_lshlrev_b32 v62, 7, v3
    s_lshl_b32 s69, s40, 13
    s_lshl_b32 s55, s40, 11
    s_add_u32 s55, s55, 0x40000
    s_cmp_eq_u32 s42, 2
    s_cselect_b32 s69, s55, s69
    s_cselect_b64 s[84:85], 0xffff, -1
    s_mul_i32 s90, s40, 48
    s_mul_i32 s91, s41, 3
    s_add_u32 s90, s90, s91
    s_add_u32 s90, s90, s42
    s_lshl_b32 s91, s40, 4
    s_add_u32 s91, s91, s41
    s_cmp_eq_u32 s42, 3
    s_cselect_b32 s90, s91, s90
    s_mul_i32 s90, s90, 3200
    s_lshl_b32 s91, s91, 2
    s_add_u32 s91, s91, s42
    s_mul_i32 s91, s91, 2560
    s_cmp_eq_u32 s40, s41
    s_cselect_b32 s50, 1, 0
    s_bitcmp1_b32 s42, 0
    s_cselect_b32 s50, 0, s50
    s_waitcnt lgkmcnt(0)
    s_and_b32 s5, s5, 0xffff
    s_and_b32 s9, s9, 0xffff
    s_and_b32 s13, s13, 0xffff
    s_and_b32 s17, s17, 0xffff
    s_and_b32 s21, s21, 0xffff
    s_and_b32 s25, s25, 0xffff
    s_and_b32 s29, s29, 0xffff
    s_and_b32 s33, s33, 0xffff
    s_and_b32 s37, s37, 0xffff
    s_cmp_eq_u32 s42, 3
    s_cselect_b64 s[92:93], s[12:13], s[8:9]
    s_cselect_b64 s[94:95], s[14:15], s[10:11]
    s_cselect_b64 s[96:97], s[24:25], s[16:17]
    s_cselect_b64 s[98:99], s[26:27], s[18:19]
    s_cmp_eq_u32 s50, 0
    s_cbranch_scc1 OPT1
    s_mov_b64 exec, s[84:85]
    buffer_store_dword v63, v62, s[36:39], s69 offen sc1
    s_mov_b64 exec, -1
OPT1:
    s_mov_b32 exec_hi, 0x0fffffff
    s_mov_b32 s69, s86
    s_add_u32 m0, s81, 0
    s_nop 0
    buffer_load_dwordx4 v56, s[92:95], s69 offen lds
    s_add_u32 s69, s69, s87
    s_add_u32 m0, s81, 960
    s_nop 0
    buffer_load_dwordx4 v56, s[92:95], s69 offen lds
    s_add_u32 s69, s69, s87
    s_add_u32 m0, s81, 1920
    s_nop 0
    buffer_load_dwordx4 v56, s[92:95], s69 offen lds
    s_add_u32 s69, s69, s87
    s_mov_b64 exec, 0xfffff
    s_add_u32 m0, s81, 2880
    s_nop 0
    buffer_load_dwordx4 v56, s[92:95], s69 offen lds
    s_mov_b64 exec, -1
    s_mov_b64 exec, 0xfffff
    buffer_load_dword a248, v62, s[4:7], s91 offen
    s_mov_b64 exec, 0x1ffffff
    buffer_load_dword a248, v62, s[96:99], s90 offen
    s_mov_b64 exec, -1
    s_mul_i32 s69, s41, 1600
    s_lshl_b32 s66, s42, 9
    s_add_u32 s69, s69, s66
    s_add_u32 m0, s66, 159232
    s_mov_b32 exec_hi, 0
    buffer_load_dwordx4 v4, s[20:23], s69 offen lds
    s_mov_b64 exec, -1
    s_mul_i32 s69, s67, 90112
    s_add_u32 s56, s69, 0x1000000
    s_add_u32 s57, s69, 0x100b000
    s_lshl_b32 s69, s67, 11
    s_lshl_b32 s66, s41, 7
    s_add_u32 s60, s69, s66
    v_lshlrev_b32 v61, 7, v1
    v_add_u32 v9, s69, v61
    s_lshl_b32 s66, s40, 7
    s_lshl_b32 s69, s41, 11
    s_add_u32 s69, s69, 0x40000
    s_add_u32 s51, s69, s66
    v_add_u32 v11, s69, v61
    s_mul_i32 s59, s41, 0x50000
    s_add_u32 s59, s59, 0x100000
    s_lshl_b32 s66, s40, 12
    s_add_u32 s58, s59, s66
    s_lshl_b32 s88, s41, 14
    s_lshl_b32 s66, s42, 8
    s_add_u32 s88, s88, s66
    s_add_u32 s88, s88, 0x80000
    s_lshl_b32 s66, s40, 10
    s_add_u32 s89, s88, s66
    s_mul_i32 s46, s41, 204800
    s_add_u32 s46, s46, 0x900000
    s_add_u32 s47, s46, 0x320000
    s_mov_b32 s52, 0
    s_mov_b32 s53, 0x10000
    s_mov_b32 s54, 0
    s_mov_b32 s61, 1
    v_lshrrev_b32 v61, 2, v3
    v_and_b32 v62, 3, v3
    v_mul_u32_u24 v236, 80, v61
    v_lshl_add_u32 v236, v62, 3, v236
    v_add_u32 v236, s81, v236
    v_lshl_add_u32 v61, v2, 5, s81
    v_lshl_add_u32 v61, v1, 3, v61
    v_add_u32 v237, 0xa00, v61
    s_mov_b32 exec_lo, 0xf000f0
    s_mov_b32 exec_hi, 0xf0000030
    v_add_u32 v237, 0xa30, v61
    s_mov_b32 exec_lo, 0xf000f00
    s_mov_b32 exec_hi, 0x300
    v_add_u32 v237, 0xa60, v61
    s_mov_b32 exec_lo, 0xf000f000
    s_mov_b32 exec_hi, 0x3000
    v_add_u32 v237, 0xa90, v61
    s_mov_b32 exec_lo, 0x0
    s_mov_b32 exec_hi, 0xf0000
    v_add_u32 v237, 0x9a0, v61
    s_mov_b32 exec_lo, 0x0
    s_mov_b32 exec_hi, 0xf00000
    v_add_u32 v237, 0x9d0, v61
    s_mov_b32 exec_lo, 0x0
    s_mov_b32 exec_hi, 0xc
    v_add_u32 v237, 0x9f0, v61
    s_mov_b32 exec_lo, 0x0
    s_mov_b32 exec_hi, 0xc0
    v_add_u32 v237, 0xa20, v61
    s_mov_b32 exec_lo, 0x0
    s_mov_b32 exec_hi, 0xc00
    v_add_u32 v237, 0xa50, v61
    s_mov_b32 exec_lo, 0x0
    s_mov_b32 exec_hi, 0xc000
    v_add_u32 v237, 0xa80, v61
    s_mov_b64 exec, -1
    s_mov_b32 s90, 0xa00
    s_cmp_eq_u32 s42, 1
    s_cselect_b32 s90, 0x1400, s90
    s_cmp_eq_u32 s42, 2
    s_cselect_b32 s90, 0x1400, s90
    s_mov_b32 s91, 0x19000
    s_cmp_eq_u32 s42, 1
    s_cselect_b32 s91, 0x0, s91
    s_cmp_eq_u32 s42, 2
    s_cselect_b32 s91, 0xc00, s91
    s_cmp_eq_u32 s42, 3
    s_cselect_b32 s91, 0x25800, s91
    s_mov_b32 s69, 0x800
    s_cmp_eq_u32 s42, 2
    s_cselect_b32 s69, 0xfffffc80, s69
    s_mov_b32 s55, 0x80
    s_cmp_eq_u32 s42, 1
    s_cselect_b32 s55, 0x100, s55
    s_cmp_eq_u32 s42, 2
    s_cselect_b32 s55, 0x100, s55
    s_mul_i32 s66, s40, s90
    s_add_u32 s66, s66, s91
    v_add_u32 v55, s66, v4
    s_add_u32 s66, s66, s69
    v_lshlrev_b32 v61, 4, v1
    v_mad_u32_u24 v52, v2, s55, v61
    v_add_u32 v52, s66, v52
    s_lshr_b32 s66, s40, 2
    s_add_u32 s66, s66, 16
    s_mul_i32 s66, s66, s90
    s_add_u32 s66, s66, s91
    s_and_b32 s67, s40, 3
    s_lshl_b32 s68, s67, 8
    s_add_u32 s68, s68, s66
    v_lshl_add_u32 v53, v2, 10, v61
    v_add_u32 v53, s68, v53
    s_mul_i32 s67, s67, s55
    s_add_u32 s67, s67, s66
    s_add_u32 s67, s67, s69
    s_mov_b32 exec_lo, 0x0
    s_mov_b32 exec_hi, 0xffff
    v_add_u32 v53, s67, v61
    s_mov_b64 exec, -1
    v_mov_b32 v63, 0x3f803f80
    v_cmp_eq_u32 vcc, 0, v1
    s_nop 1
    v_cndmask_b32 v61, 0, v63, vcc
    v_accvgpr_write_b32 a160, v61
    v_accvgpr_write_b32 a161, v61
    v_accvgpr_write_b32 a162, v61
    v_accvgpr_write_b32 a163, v61
    v_cmp_eq_u32 vcc, 1, v1
    s_nop 1
    v_cndmask_b32 v61, 0, v63, vcc
    v_accvgpr_write_b32 a164, v61
    v_accvgpr_write_b32 a165, v61
    v_accvgpr_write_b32 a166, v61
    v_accvgpr_write_b32 a167, v61
    v_cmp_eq_u32 vcc, 2, v1
    s_nop 1
    v_cndmask_b32 v61, 0, v63, vcc
    v_accvgpr_write_b32 a168, v61
    v_accvgpr_write_b32 a169, v61
    v_accvgpr_write_b32 a170, v61
    v_accvgpr_write_b32 a171, v61
    v_cmp_eq_u32 vcc, v2, v1
    s_nop 1
    v_cndmask_b32 v61, 0, v63, vcc
    v_accvgpr_write_b32 a172, v61
    v_accvgpr_write_b32 a173, v61
    v_accvgpr_write_b32 a174, v61
    v_accvgpr_write_b32 a175, v61
    v_accvgpr_write_b32 a244, v63
    v_accvgpr_write_b32 a245, v63
    v_accvgpr_write_b32 a246, v63
    v_accvgpr_write_b32 a247, v63
    s_cmp_eq_u32 s50, 0
    s_nop 1
    s_cbranch_scc1 OPT2
    s_waitcnt vmcnt(7)
    s_lshl_b32 s66, s40, 2
    s_add_u32 s66, s66, s42
    s_lshl_b32 s66, s66, 2
    v_mov_b32 v61, 1
    s_mov_b64 exec, 1
    buffer_store_dword v61, off, s[32:35], s66 sc1
    s_mov_b64 exec, -1
OPT2:
    v_lshlrev_b32 v54, 2, v3
    v_mov_b32 v238, -1
    s_mul_i32 s3, s42, 20992
    s_add_u32 s3, s3, 41984
    s_mov_b32 s66, -656
    s_movk_i32 s67, 1280
    v_mul_u32_u24 v63, 1599, v3
    v_add_u32 v61, 0, v63
    v_lshrrev_b32 v61, 16, v61
    v_mad_i32_i24 v62, v61, s66, v4
    v_min_i32 v62, 624, v62
    v_mad_u32_u24 v148, v61, s67, v62
    v_add_u32 v61, 102336, v63
    v_lshrrev_b32 v61, 16, v61
    v_mad_i32_i24 v62, v61, s66, v4
    v_min_i32 v62, -400, v62
    v_mad_u32_u24 v149, v61, s67, v62
    v_add_u32 v61, 204672, v63
    v_lshrrev_b32 v61, 16, v61
    v_mad_i32_i24 v62, v61, s66, v4
    v_min_i32 v62, -1424, v62
    v_mad_u32_u24 v150, v61, s67, v62
    v_add_u32 v61, 307008, v63
    v_lshrrev_b32 v61, 16, v61
    v_mad_i32_i24 v62, v61, s66, v4
    v_min_i32 v62, -2448, v62
    v_mad_u32_u24 v151, v61, s67, v62
    v_add_u32 v61, 409344, v63
    v_add_u32 v163, 4096, v4
    v_lshrrev_b32 v61, 16, v61
    v_mad_i32_i24 v62, v61, s66, v163
    v_min_i32 v62, 624, v62
    v_mad_u32_u24 v152, v61, s67, v62
    v_add_u32 v61, 511680, v63
    v_lshrrev_b32 v61, 16, v61
    v_mad_i32_i24 v62, v61, s66, v163
    v_min_i32 v62, -400, v62
    v_mad_u32_u24 v153, v61, s67, v62
    v_add_u32 v61, 614016, v63
    v_lshrrev_b32 v61, 16, v61
    v_mad_i32_i24 v62, v61, s66, v163
    v_min_i32 v62, -1424, v62
    v_mad_u32_u24 v154, v61, s67, v62
    v_add_u32 v61, 716352, v63
    v_lshrrev_b32 v61, 16, v61
    v_mad_i32_i24 v62, v61, s66, v163
    v_min_i32 v62, -2448, v62
    v_mad_u32_u24 v155, v61, s67, v62
    v_add_u32 v61, 818688, v63
    v_add_u32 v163, 8192, v4
    v_lshrrev_b32 v61, 16, v61
    v_mad_i32_i24 v62, v61, s66, v163
    v_min_i32 v62, 624, v62
    v_mad_u32_u24 v156, v61, s67, v62
    v_add_u32 v61, 921024, v63
    v_lshrrev_b32 v61, 16, v61
    v_mad_i32_i24 v62, v61, s66, v163
    v_min_i32 v62, -400, v62
    v_mad_u32_u24 v157, v61, s67, v62
    v_add_u32 v61, 1023360, v63
    v_lshrrev_b32 v61, 16, v61
    v_mad_i32_i24 v62, v61, s66, v163
    v_min_i32 v62, -1424, v62
    v_mad_u32_u24 v158, v61, s67, v62
    s_add_u32 m0, s3, 0
    s_add_u32 s69, s100, 0
    buffer_load_dwordx4 v148, s[4:7], s69 offen offset:0 lds
    buffer_load_dwordx4 v149, s[4:7], s69 offen offset:1024 lds
    buffer_load_dwordx4 v150, s[4:7], s69 offen offset:2048 lds
    buffer_load_dwordx4 v151, s[4:7], s69 offen offset:3072 lds
    s_add_u32 m0, s3, 4096
    s_nop 0
    buffer_load_dwordx4 v152, s[4:7], s69 offen offset:0 lds
    buffer_load_dwordx4 v153, s[4:7], s69 offen offset:1024 lds
    s_mov_b32 s48, 0x0
    s_cmp_eq_u32 s42, 1
    s_cselect_b32 s48, 0x3000, s48
    s_cmp_eq_u32 s42, 2
    s_cselect_b32 s48, 0x6400, s48
    s_cmp_eq_u32 s42, 3
    s_cselect_b32 s48, 0x9400, s48
    s_mul_i32 s49, s42, 6144
    s_mov_b32 s43, 0
    s_mov_b32 s44, 51200
    s_mov_b32 s45, 102400
    s_mov_b32 s70, 0x3fb8aa3b
    s_mov_b32 s74, 0xbfb8aa3b
    s_mov_b32 s71, 0x358637bd
    s_mov_b32 s72, 0x00003f80
    s_mov_b32 s73, 0x3f800000
    s_mov_b64 s[76:77], 0xffff
    s_mov_b32 s66, 210
    v_cmp_gt_u32 s[64:65], s66, v0
    v_lshlrev_b32 v42, 3, v0
    v_lshlrev_b32 v41, 4, v0
    v_lshlrev_b32 v40, 5, v0
    s_getreg_b32 s75, hwreg(HW_REG_XCC_ID)
    s_and_b32 s75, s75, 15
    v_mov_b32 v232, 0
    v_mov_b32 v233, 0
    v_add_u32 v61, 0x26520, v42
    ds_write_b64 v61, v[232:233]
    s_lshl_b32 s66, s40, 2
    s_lshl_b64 s[84:85], 1, s66
    buffer_load_dwordx4 v154, s[4:7], s69 offen offset:2048 lds
    s_lshl_b32 s66, s41, 2
    s_lshl_b64 s[66:67], 4, s66
    s_or_b64 s[84:85], s[84:85], s[66:67]
    v_mov_b32 v61, -1
    v_accvgpr_write_b32 a236, v61
    v_accvgpr_write_b32 a237, v61
    v_accvgpr_write_b32 a238, v61
    v_accvgpr_write_b32 a239, v61
    v_mul_u32_u24 v61, 656, v1
    v_add_u32 v61, s3, v61
    v_lshl_add_u32 v159, v2, 3, v61
    v_add_u32 v160, 10496, v159
    v_mul_u32_u24 v62, 80, v2
    v_add3_u32 v162, v62, 64, v61
    s_and_b32 s66, s41, 7
    s_mul_i32 s66, s66, 80
    v_add_u32 v163, s66, v159
    v_and_b32 v62, 1, v2
    v_lshl_add_u32 v61, v62, 3, v61
    v_add3_u32 v164, s66, 64, v61
    v_mul_u32_u24 v61, 0x1000, v2
    v_lshl_add_u32 v61, v1, 4, v61
    v_add_u32 v50, 0x0, v61
    buffer_load_dwordx4 v155, s[4:7], s69 offen offset:3072 lds
    v_mul_u32_u24 v61, 0x4, v1
    v_add_u32 v46, 0x26600, v61
    s_mov_b32 s66, 0x140
    s_cmp_eq_u32 s42, 1
    s_cselect_b32 s66, 0x0, s66
    s_cmp_eq_u32 s42, 2
    s_cselect_b32 s66, 0xc0, s66
    s_cmp_eq_u32 s42, 3
    s_cselect_b32 s66, 0x1000, s66
    s_mov_b32 s67, 0x1c0
    s_cmp_eq_u32 s42, 1
    s_cselect_b32 s67, 0x80, s67
    s_cmp_eq_u32 s42, 2
    s_cselect_b32 s67, 0xa0, s67
    s_cmp_eq_u32 s42, 3
    s_cselect_b32 s67, 0x1080, s67
    v_lshl_add_u32 v61, v1, 2, s66
    v_add_u32 v51, 0x26600, v61
    s_mov_b32 exec_lo, 0x0
    s_mov_b32 exec_hi, 0xffff
    v_add_u32 v51, 0x26640, v61
    s_mov_b64 exec, -1
    s_mov_b32 exec_lo, 0xffff0000
    s_mov_b32 exec_hi, 0x0
    v_add_u32 v51, s67, v46
    s_mov_b64 exec, -1
    s_lshl_b32 s68, s42, 8
    v_lshl_add_u32 v61, v2, 3, s68
    v_lshl_add_u32 v61, v1, 4, v61
    v_add_u32 v43, 0x26a00, v61
    s_mov_b32 exec_lo, 0x0
    s_mov_b32 exec_hi, 0xffffffff
    v_add_u32 v43, 0x269f4, v61
    s_mov_b64 exec, -1
    v_lshl_add_u32 v61, v1, 4, s68
    v_add_u32 v44, 0x26a00, v61
    v_lshl_add_u32 v61, v2, 6, s68
    v_add_u32 v45, 0x26a00, v61
    v_lshl_add_u32 v61, v2, 12, s68
    v_lshl_add_u32 v61, v1, 4, v61
    v_add_u32 v59, 0x0, v61
    v_lshl_add_u32 v61, v2, 3, s68
    v_lshl_add_u32 v61, v1, 4, v61
    v_add_u32 v60, 0x25800, v61
    v_lshrrev_b32 v61, 2, v3
    s_add_u32 m0, s3, 8192
    s_nop 0
    buffer_load_dwordx4 v156, s[4:7], s69 offen offset:0 lds
    v_mul_u32_u24 v61, 40, v61
    v_mov_b32 v240, 0x26540
    v_mov_b32 v241, 0x26540
    v_mov_b32 v242, 0x26540
    v_mov_b32 v243, 0x26540
    v_mov_b32 v244, 0x26540
    v_mov_b32 v245, 0x26540
    s_mov_b32 exec_lo, 0x11111111
    s_mov_b32 exec_hi, 0x11111111
    v_add_u32 v240, 0x26e00, v61
    s_mov_b32 exec_lo, 0x22221111
    s_mov_b32 exec_hi, 0x22222222
    v_add_u32 v241, 0x27080, v61
    s_mov_b32 exec_lo, 0x44444444
    s_mov_b32 exec_hi, 0x44444444
    v_add_u32 v242, 0x26e00, v61
    s_mov_b32 exec_lo, 0x88884444
    s_mov_b32 exec_hi, 0x88888888
    v_add_u32 v243, 0x27080, v61
    s_mov_b64 exec, 0x22222222
    v_add_u32 v244, 0x27300, v61
    s_mov_b32 exec_lo, 0x88888888
    s_mov_b32 exec_hi, 0x0
    v_add_u32 v245, 0x27300, v61
    s_mov_b64 exec, -1
    s_lshl_b32 s66, s41, 11
    v_add_u32 v5, s66, v4
    s_lshr_b32 s66, s41, 2
    s_add_u32 s66, s66, 16
    s_lshl_b32 s66, s66, 11
    s_and_b32 s67, s41, 3
    s_lshl_b32 s67, s67, 8
    s_add_u32 s66, s66, s67
    v_lshl_add_u32 v61, v2, 3, s66
    v_lshl_add_u32 v61, v1, 4, v61
    v_add_u32 v6, 0x0, v61
    s_lshl_b32 s66, s41, 8
    v_lshl_add_u32 v61, v2, 3, s66
    v_lshl_add_u32 v61, v1, 4, v61
    v_add_u32 v7, 0xa000, v61
    buffer_load_dwordx4 v157, s[4:7], s69 offen offset:1024 lds
    s_mov_b32 exec_lo, 0x0
    s_mov_b32 exec_hi, 0xffffffff
    v_add_u32 v7, 0x9ff4, v61
    s_mov_b64 exec, -1
    v_mul_u32_u24 v61, 0x28, v1
    v_lshl_add_u32 v61, v2, 3, v61
    v_add_u32 v26, 0x25800, v61
    v_mul_u32_u24 v61, 0x28, v1
    v_mov_b32 v27, 0x26540
    s_mov_b64 exec, 0xffff
    v_add_u32 v27, 0x25820, v61
    s_mov_b64 exec, -1
    v_mul_u32_u24 v61, 0x28, v1
    v_lshl_add_u32 v61, v2, 3, v61
    v_mov_b32 v28, 0x26540
    s_mov_b32 exec_lo, 0xf000f
    s_mov_b32 exec_hi, 0xf000f
    v_add_u32 v28, 0x25a80, v61
    s_mov_b64 exec, -1
    v_mul_u32_u24 v61, 0x28, v1
    v_lshl_add_u32 v61, v2, 3, v61
    v_add_u32 v29, 0x25aa0, v61
    s_mov_b32 exec_lo, 0xffff0
    s_mov_b32 exec_hi, 0xf000f
    v_mov_b32 v29, 0x26540
    s_mov_b64 exec, -1
    v_mul_u32_u24 v61, 0x28, v1
    v_lshl_add_u32 v61, v2, 3, v61
    v_mov_b32 v30, 0x26540
    s_mov_b32 exec_lo, 0xfff0fff0
    s_mov_b32 exec_hi, 0x0
    v_add_u32 v30, 0x25ac0, v61
    s_mov_b64 exec, -1
    v_mul_u32_u24 v61, 0x28, v1
    v_lshl_add_u32 v61, v2, 3, v61
    v_mov_b32 v31, 0x26540
    s_mov_b32 exec_lo, 0xff0000
    s_mov_b32 exec_hi, 0xff00ff
    v_add_u32 v31, 0x25d20, v61
    s_mov_b64 exec, -1
    s_mov_b64 exec, 0xffff
    buffer_load_dwordx4 v158, s[4:7], s69 offen offset:2048 lds
    s_mov_b64 exec, -1
    v_mul_u32_u24 v61, 0x28, v1
    v_lshl_add_u32 v61, v2, 3, v61
    v_mov_b32 v32, 0x26540
    s_mov_b64 exec, 0xff00ff
    v_add_u32 v32, 0x25d40, v61
    s_mov_b64 exec, -1
    v_mul_u32_u24 v61, 0x8, v2
    v_mov_b32 v33, 0x26540
    s_mov_b32 exec_lo, 0x11111111
    s_mov_b32 exec_hi, 0x11111111
    v_add_u32 v33, 0x25b20, v61
    s_mov_b64 exec, -1
    v_mul_u32_u24 v61, 0x8, v2
    v_mov_b32 v34, 0x26540
    s_mov_b32 exec_lo, 0x22220000
    s_mov_b32 exec_hi, 0x22222222
    v_add_u32 v34, 0x25e60, v61
    s_mov_b64 exec, 0x1111
    v_add_u32 v34, 0x25b40, v61
    s_mov_b64 exec, -1
    v_mul_u32_u24 v61, 0x8, v2
    v_mov_b32 v35, 0x26540
    s_mov_b64 exec, 0x22222222
    v_add_u32 v35, 0x25e80, v61
    s_mov_b64 exec, -1
    s_waitcnt vmcnt(14)
    ds_read_b64_tr_b16 v[128:129], v236 offset:0
    ds_read_b64_tr_b16 v[130:131], v236 offset:1280
    ds_read_b64_tr_b16 v[132:133], v236 offset:32
    ds_read_b64_tr_b16 v[134:135], v236 offset:1312
    ds_read_b64_tr_b16 v[136:137], v236 offset:64
    ds_read_b64_tr_b16 v[138:139], v236 offset:1344
    ds_read_b64_tr_b16 v[140:141], v237 offset:0
    ds_read_b64_tr_b16 v[142:143], v237 offset:320
    s_waitcnt lgkmcnt(6)
    v_mfma_f32_16x16x32_bf16 v[144:147], a[160:163], v[128:131], 0
    s_waitcnt lgkmcnt(4)
    v_mfma_f32_16x16x32_bf16 v[144:147], a[164:167], v[132:135], v[144:147]
    s_waitcnt lgkmcnt(2)
    v_mfma_f32_16x16x32_bf16 v[144:147], a[168:171], v[136:139], v[144:147]
    s_waitcnt lgkmcnt(0)
    v_mfma_f32_16x16x32_bf16 v[144:147], a[172:175], v[140:143], v[144:147]
    buffer_store_dwordx4 v[128:131], v55, s[36:39], s46 offen sc1
    buffer_store_dwordx4 v[132:135], v55, s[36:39], s46 offen offset:1024 sc1
    s_mov_b32 exec_lo, 0xff00ff
    s_mov_b32 exec_hi, 0xff00ff
    buffer_store_dwordx4 v[136:139], v52, s[36:39], s46 offen sc1
    s_mov_b32 exec_lo, 0xffffffff
    s_mov_b32 exec_hi, 0xff
    buffer_store_dwordx4 v[140:143], v53, s[36:39], s46 offen sc1
    s_mov_b64 exec, 0xffff
    s_add_u32 s66, s89, 0x0
    buffer_store_dwordx4 v[144:147], v4, s[36:39], s66 offen sc1
    s_mov_b64 exec, -1
    s_cmp_lg_u32 s42, 0
    s_cbranch_scc1 OPT3
    buffer_load_dword v238, v54, s[32:35], 0 offen sc1
OPT3:
    v_mul_u32_u24 v61, 0x50, v1
    v_mov_b32 v36, 0x26540
    s_mov_b64 exec, 0xffff
    v_add_u32 v36, 0x25800, v61
    s_mov_b32 exec_lo, 0x0
    s_mov_b32 exec_hi, 0xffff
    v_add_u32 v36, 0x25810, v61
    s_mov_b64 exec, -1
    v_mul_u32_u24 v61, 0x50, v1
    v_mov_b32 v37, 0x26540
    s_add_u32 m0, s3, 10496
    s_add_u32 s69, s101, 0
    buffer_load_dwordx4 v148, s[4:7], s69 offen offset:0 lds
    s_mov_b32 exec_lo, 0xfff00000
    s_mov_b32 exec_hi, 0x0
    v_add_u32 v37, 0x25d50, v61
    s_mov_b32 exec_lo, 0x0
    s_mov_b32 exec_hi, 0xfff00000
    v_add_u32 v37, 0x25d60, v61
    s_mov_b64 exec, 0xf
    v_add_u32 v37, 0x25d00, v61
    s_mov_b32 exec_lo, 0x0
    s_mov_b32 exec_hi, 0xf
    v_add_u32 v37, 0x25d10, v61
    s_mov_b64 exec, -1
    v_mul_u32_u24 v61, 0x50, v1
    v_mov_b32 v38, 0x26540
    s_mov_b64 exec, 0xff0000
    v_add_u32 v38, 0x26250, v61
    s_mov_b32 exec_lo, 0x0
    s_mov_b32 exec_hi, 0xff0000
    v_add_u32 v38, 0x26260, v61
    s_mov_b64 exec, -1
    buffer_load_dwordx4 v149, s[4:7], s69 offen offset:1024 lds
    v_mul_u32_u24 v61, 0x0, v2
    v_add_u32 v39, 0x26540, v61
    s_mov_b64 exec, 0x1111
    v_add_u32 v39, 0x25e40, v61
    s_mov_b64 exec, 0x22220000
    v_add_u32 v39, 0x264d0, v61
    s_mov_b32 exec_lo, 0x0
    s_mov_b32 exec_hi, 0x1111
    v_add_u32 v39, 0x25e50, v61
    s_mov_b32 exec_lo, 0x0
    s_mov_b32 exec_hi, 0x22220000
    v_add_u32 v39, 0x264e0, v61
    s_mov_b64 exec, -1
    v_mul_u32_u24 v61, 0x10, v2
    v_add_u32 v47, 0x26600, v61
    buffer_load_dwordx4 v150, s[4:7], s69 offen offset:2048 lds
    v_mul_u32_u24 v61, 0x80, v2
    v_lshl_add_u32 v61, v1, 4, v61
    v_add_u32 v12, 0x800, v61
    s_mov_b32 exec_lo, 0xff00ff00
    s_mov_b32 exec_hi, 0xff00ff00
    v_add_u32 v12, 0x780, v61
    s_mov_b64 exec, -1
    buffer_load_dwordx4 v151, s[4:7], s69 offen offset:3072 lds
    v_mov_b32 v63, 0
    s_mov_b64 exec, 0x1000001
    v_mov_b32 v63, 0x3f80
    s_mov_b64 exec, 0x2000002
    v_mov_b32 v63, 0x3f800000
    s_mov_b64 exec, -1
    v_accvgpr_write_b32 a220, v63
    v_mov_b32 v63, 0
    s_add_u32 m0, s3, 14592
    s_nop 0
    buffer_load_dwordx4 v152, s[4:7], s69 offen offset:0 lds
    s_mov_b32 exec_lo, 0x0
    s_mov_b32 exec_hi, 0x1000001
    v_mov_b32 v63, 0x3f80
    s_mov_b32 exec_lo, 0x0
    s_mov_b32 exec_hi, 0x2000002
    v_mov_b32 v63, 0x3f800000
    s_mov_b64 exec, -1
    v_accvgpr_write_b32 a224, v63
    v_mov_b32 v63, 0
    s_mov_b64 exec, 0x4000004
    v_mov_b32 v63, 0x3f80
    s_mov_b64 exec, 0x8000008
    v_mov_b32 v63, 0x3f800000
    s_mov_b64 exec, -1
    v_accvgpr_write_b32 a221, v63
    buffer_load_dwordx4 v153, s[4:7], s69 offen offset:1024 lds
    v_mov_b32 v63, 0
    s_mov_b32 exec_lo, 0x0
    s_mov_b32 exec_hi, 0x4000004
    v_mov_b32 v63, 0x3f80
    s_mov_b32 exec_lo, 0x0
    s_mov_b32 exec_hi, 0x8000008
    v_mov_b32 v63, 0x3f800000
    s_mov_b64 exec, -1
    v_accvgpr_write_b32 a225, v63
    v_mov_b32 v63, 0
    buffer_load_dwordx4 v154, s[4:7], s69 offen offset:2048 lds
    s_mov_b64 exec, 0x10000010
    v_mov_b32 v63, 0x3f80
    s_mov_b64 exec, 0x20000020
    v_mov_b32 v63, 0x3f800000
    s_mov_b64 exec, -1
    v_accvgpr_write_b32 a222, v63
    v_mov_b32 v63, 0
    s_mov_b32 exec_lo, 0x0
    s_mov_b32 exec_hi, 0x10000010
    v_mov_b32 v63, 0x3f80
    s_mov_b32 exec_lo, 0x0
    s_mov_b32 exec_hi, 0x20000020
    v_mov_b32 v63, 0x3f800000
    s_mov_b64 exec, -1
    buffer_load_dwordx4 v155, s[4:7], s69 offen offset:3072 lds
    v_accvgpr_write_b32 a226, v63
    v_mov_b32 v63, 0
    s_mov_b64 exec, 0x40000040
    v_mov_b32 v63, 0x3f80
    s_mov_b32 exec_lo, 0x80000080
    s_mov_b32 exec_hi, 0x0
    v_mov_b32 v63, 0x3f800000
    s_mov_b64 exec, -1
    v_accvgpr_write_b32 a223, v63
    v_mov_b32 v63, 0
    s_add_u32 m0, s3, 18688
    s_nop 0
    buffer_load_dwordx4 v156, s[4:7], s69 offen offset:0 lds
    s_mov_b32 exec_lo, 0x0
    s_mov_b32 exec_hi, 0x40000040
    v_mov_b32 v63, 0x3f80
    s_mov_b32 exec_lo, 0x0
    s_mov_b32 exec_hi, 0x80000080
    v_mov_b32 v63, 0x3f800000
    s_mov_b64 exec, -1
    v_accvgpr_write_b32 a227, v63
    v_mov_b32 v63, 0
    s_mov_b32 exec_lo, 0x10001
    s_mov_b32 exec_hi, 0x10001
    v_mov_b32 v63, 0x3f80
    s_mov_b32 exec_lo, 0x20002
    s_mov_b32 exec_hi, 0x20002
    v_mov_b32 v63, 0x3f800000
    s_mov_b32 exec_lo, 0xff00ff00
    s_mov_b32 exec_hi, 0xff00ff00
    v_mov_b32 v63, 0x3f803f80
    s_mov_b64 exec, -1
    buffer_load_dwordx4 v157, s[4:7], s69 offen offset:1024 lds
    v_accvgpr_write_b32 a240, v63
    v_mov_b32 v63, 0
    s_mov_b32 exec_lo, 0x40004
    s_mov_b32 exec_hi, 0x40004
    v_mov_b32 v63, 0x3f80
    s_mov_b32 exec_lo, 0x80008
    s_mov_b32 exec_hi, 0x80008
    v_mov_b32 v63, 0x3f800000
    s_mov_b32 exec_lo, 0xff00ff00
    s_mov_b32 exec_hi, 0xff00ff00
    v_mov_b32 v63, 0x3f803f80
    s_mov_b64 exec, -1
    v_accvgpr_write_b32 a241, v63
    s_mov_b64 exec, 0xffff
    buffer_load_dwordx4 v158, s[4:7], s69 offen offset:2048 lds
    s_mov_b64 exec, -1
    s_mov_b32 s55, 131072
    s_waitcnt vmcnt(11)
LC:
    v_cmp_ne_u32 vcc, 0, v238
    s_and_b64 vcc, vcc, s[84:85]
    s_cmp_eq_u64 vcc, s[84:85]
    s_nop 2
    s_cbranch_scc1 LC_done
    s_sub_u32 s55, s55, 1
    s_cmp_eq_u32 s55, 0
    s_cbranch_scc1 ABORT
    s_sleep 4
    buffer_load_dword v238, v54, s[32:35], 0 offen sc1
    s_waitcnt vmcnt(0)
    s_branch LC
LC_done:
    v_mov_b32 v238, 1
    v_mov_b32 v239, s75
    s_waitcnt lgkmcnt(0)
    s_barrier
    s_mov_b64 exec, 1
    buffer_store_dwordx2 v[238:239], off, s[36:39], s60 sc1
    s_mov_b64 exec, -1
    s_cmp_lg_u32 s42, 0
    s_cbranch_scc1 OPT4
    s_mov_b64 exec, 1
    buffer_store_dword v238, off, s[36:39], s51 sc1
    s_mov_b64 exec, -1
OPT4:
    s_mov_b32 exec_hi, 0x0fffffff
    s_mov_b32 s69, s86
    s_add_u32 m0, s81, 13312
    s_nop 0
    buffer_load_dwordx4 v56, s[96:99], s69 offen lds
    s_add_u32 s69, s69, s87
    s_add_u32 m0, s81, 14272
    s_nop 0
    buffer_load_dwordx4 v56, s[96:99], s69 offen lds
    s_add_u32 s69, s69, s87
    s_add_u32 m0, s81, 15232
    s_nop 0
    buffer_load_dwordx4 v56, s[96:99], s69 offen lds
    s_add_u32 s69, s69, s87
    s_mov_b64 exec, 0xfffff
    s_add_u32 m0, s81, 16192
    s_nop 0
    buffer_load_dwordx4 v56, s[96:99], s69 offen lds
    s_mov_b64 exec, -1
    s_lshl_b32 s90, s42, 10
    s_add_u32 s91, s46, s90
    ds_read2_b64 a[0:3], v159 offset0:0 offset1:4
    ds_read2_b64 a[8:11], v159 offset0:10 offset1:14
    ds_read2_b64 a[16:19], v159 offset0:20 offset1:24
    ds_read2_b64 a[24:27], v159 offset0:30 offset1:34
    ds_read2_b64 a[32:35], v159 offset0:40 offset1:44
    ds_read2_b64 a[40:43], v159 offset0:50 offset1:54
    ds_read2_b64 a[48:51], v159 offset0:60 offset1:64
    ds_read2_b64 a[56:59], v159 offset0:70 offset1:74
    ds_read_b128 a[128:131], v162 offset:0
    ds_read_b128 a[136:139], v162 offset:320
    s_bitcmp0_b32 s41, 3
    s_cselect_b64 exec, -1, 0
    ds_read_b64 v[216:217], v163 offset:0
    ds_read_b64 v[218:219], v163 offset:32
    ds_read_b64 v[220:221], v164 offset:0
    s_mov_b64 exec, -1
    s_waitcnt lgkmcnt(0)
    v_mfma_f32_16x16x32_bf16 v[178:181], a[0:3], a[0:3], 0
    s_add_u32 m0, s3, 0
    s_add_u32 s69, s100, 640
    buffer_load_dwordx4 v148, s[4:7], s69 offen offset:0 lds
    v_mfma_f32_16x16x32_bf16 v[182:185], a[244:247], a[0:3], 0
    buffer_load_dwordx4 v149, s[4:7], s69 offen offset:1024 lds
    v_mfma_f32_16x16x32_bf16 v[178:181], a[8:11], a[8:11], v[178:181]
    buffer_load_dwordx4 v150, s[4:7], s69 offen offset:2048 lds
    v_mfma_f32_16x16x32_bf16 v[182:185], a[244:247], a[8:11], v[182:185]
    buffer_load_dwordx4 v151, s[4:7], s69 offen offset:3072 lds
    v_mfma_f32_16x16x32_bf16 v[178:181], a[16:19], a[16:19], v[178:181]
    s_add_u32 m0, s3, 4096
    s_nop 0
    buffer_load_dwordx4 v152, s[4:7], s69 offen offset:0 lds
    v_mfma_f32_16x16x32_bf16 v[182:185], a[244:247], a[16:19], v[182:185]
    buffer_load_dwordx4 v153, s[4:7], s69 offen offset:1024 lds
    v_mfma_f32_16x16x32_bf16 v[178:181], a[24:27], a[24:27], v[178:181]
    buffer_load_dwordx4 v154, s[4:7], s69 offen offset:2048 lds
    v_mfma_f32_16x16x32_bf16 v[182:185], a[244:247], a[24:27], v[182:185]
    buffer_load_dwordx4 v155, s[4:7], s69 offen offset:3072 lds
    v_mfma_f32_16x16x32_bf16 v[178:181], a[32:35], a[32:35], v[178:181]
    s_add_u32 m0, s3, 8192
    s_nop 0
    buffer_load_dwordx4 v156, s[4:7], s69 offen offset:0 lds
    v_mfma_f32_16x16x32_bf16 v[182:185], a[244:247], a[32:35], v[182:185]
    buffer_load_dwordx4 v157, s[4:7], s69 offen offset:1024 lds
    s_mov_b64 exec, 0xffff
    buffer_load_dwordx4 v158, s[4:7], s69 offen offset:2048 lds
    s_mov_b64 exec, -1
    v_mfma_f32_16x16x32_bf16 v[178:181], a[40:43], a[40:43], v[178:181]
    v_mfma_f32_16x16x32_bf16 v[182:185], a[244:247], a[40:43], v[182:185]
    v_mfma_f32_16x16x32_bf16 v[178:181], a[48:51], a[48:51], v[178:181]
    v_mfma_f32_16x16x32_bf16 v[182:185], a[244:247], a[48:51], v[182:185]
    v_mfma_f32_16x16x32_bf16 v[178:181], a[56:59], a[56:59], v[178:181]
    v_mfma_f32_16x16x32_bf16 v[182:185], a[244:247], a[56:59], v[182:185]
    v_mfma_f32_16x16x32_bf16 v[178:181], a[128:131], a[128:131], v[178:181]
    v_mfma_f32_16x16x32_bf16 v[182:185], a[244:247], a[128:131], v[182:185]
    v_mfma_f32_16x16x32_bf16 v[178:181], a[136:139], a[136:139], v[178:181]
    v_mfma_f32_16x16x32_bf16 v[182:185], a[244:247], a[136:139], v[182:185]
    s_waitcnt vmcnt(16)
    ds_read2_b64 a[4:7], v160 offset0:0 offset1:4
    ds_read2_b64 a[12:15], v160 offset0:10 offset1:14
    ds_read2_b64 a[20:23], v160 offset0:20 offset1:24
    ds_read2_b64 a[28:31], v160 offset0:30 offset1:34
    ds_read2_b64 a[36:39], v160 offset0:40 offset1:44
    ds_read2_b64 a[44:47], v160 offset0:50 offset1:54
    ds_read2_b64 a[52:55], v160 offset0:60 offset1:64
    ds_read2_b64 a[60:63], v160 offset0:70 offset1:74
    ds_read_b128 a[132:135], v162 offset:10496
    ds_read_b128 a[140:143], v162 offset:10816
    s_bitcmp0_b32 s41, 3
    s_cselect_b64 exec, -1, 0
    ds_read_b64 v[222:223], v163 offset:10496
    ds_read_b64 v[224:225], v163 offset:10528
    ds_read_b64 v[226:227], v164 offset:10496
    s_mov_b64 exec, -1
    s_waitcnt lgkmcnt(0)
    v_mfma_f32_16x16x32_bf16 v[186:189], a[4:7], a[4:7], 0
    v_mov_b32 v63, 0
    s_mov_b32 exec_lo, 0x100010
    s_mov_b32 exec_hi, 0x100010
    v_mov_b32 v63, 0x3f80
    s_mov_b32 exec_lo, 0x200020
    s_mov_b32 exec_hi, 0x200020
    v_mov_b32 v63, 0x3f800000
    s_mov_b32 exec_lo, 0xff00ff00
    s_mov_b32 exec_hi, 0xff00ff00
    v_mov_b32 v63, 0x3f803f80
    s_mov_b64 exec, -1
    v_accvgpr_write_b32 a242, v63
    v_mfma_f32_16x16x32_bf16 v[190:193], a[244:247], a[4:7], 0
    s_add_u32 m0, s3, 10496
    s_add_u32 s69, s101, 640
    buffer_load_dwordx4 v148, s[4:7], s69 offen offset:0 lds
    v_mov_b32 v63, 0
    s_mov_b32 exec_lo, 0x400040
    s_mov_b32 exec_hi, 0x400040
    v_mov_b32 v63, 0x3f80
    s_mov_b32 exec_lo, 0x800080
    s_mov_b32 exec_hi, 0x800080
    v_mov_b32 v63, 0x3f800000
    s_mov_b32 exec_lo, 0xff00ff00
    s_mov_b32 exec_hi, 0xff00ff00
    v_mov_b32 v63, 0x3f803f80
    s_mov_b64 exec, -1
    v_accvgpr_write_b32 a243, v63
    v_mov_b32 v63, 0
    buffer_load_dwordx4 v149, s[4:7], s69 offen offset:1024 lds
    v_mfma_f32_16x16x32_bf16 v[186:189], a[12:15], a[12:15], v[186:189]
    v_accvgpr_write_b32 a228, v63
    v_mov_b32 v63, 0
    v_accvgpr_write_b32 a229, v63
    v_mov_b32 v63, 0
    buffer_load_dwordx4 v150, s[4:7], s69 offen offset:2048 lds
    v_mfma_f32_16x16x32_bf16 v[190:193], a[244:247], a[12:15], v[190:193]
    v_accvgpr_write_b32 a232, v63
    v_mov_b32 v63, 0
    v_accvgpr_write_b32 a233, v63
    buffer_load_dwordx4 v151, s[4:7], s69 offen offset:3072 lds
    v_mov_b32 v63, 0
    v_mfma_f32_16x16x32_bf16 v[186:189], a[20:23], a[20:23], v[186:189]
    s_mov_b32 exec_lo, 0x0
    s_mov_b32 exec_hi, 0x10000100
    v_mov_b32 v63, 0x3f80
    s_mov_b32 exec_lo, 0x0
    s_mov_b32 exec_hi, 0x20000200
    v_mov_b32 v63, 0x3f800000
    s_mov_b64 exec, -1
    v_accvgpr_write_b32 a230, v63
    s_add_u32 m0, s3, 14592
    s_nop 0
    buffer_load_dwordx4 v152, s[4:7], s69 offen offset:0 lds
    v_mov_b32 v63, 0
    s_mov_b32 exec_lo, 0x0
    s_mov_b32 exec_hi, 0x40000400
    v_mov_b32 v63, 0x3f80
    s_mov_b32 exec_lo, 0x0
    s_mov_b32 exec_hi, 0x80000800
    v_mov_b32 v63, 0x3f800000
    s_mov_b64 exec, -1
    v_mfma_f32_16x16x32_bf16 v[190:193], a[244:247], a[20:23], v[190:193]
    v_accvgpr_write_b32 a231, v63
    v_add_u32 v8, 0xa000, v4
    buffer_load_dwordx4 v153, s[4:7], s69 offen offset:1024 lds
    s_mul_i32 s68, s42, 6720
    v_mul_u32_u24 v61, 0x50, v1
    v_mfma_f32_16x16x32_bf16 v[186:189], a[28:31], a[28:31], v[186:189]
    v_lshl_add_u32 v61, v2, 4, v61
    buffer_load_dwordx4 v154, s[4:7], s69 offen offset:2048 lds
    v_add_u32 v15, 0x0, v61
    v_add_u32 v15, s68, v15
    v_mfma_f32_16x16x32_bf16 v[190:193], a[244:247], a[28:31], v[190:193]
    s_mul_i32 s68, s42, 6720
    buffer_load_dwordx4 v155, s[4:7], s69 offen offset:3072 lds
    v_mul_u32_u24 v61, 0x50, v1
    v_lshl_add_u32 v61, v2, 4, v61
    v_add_u32 v16, 0x500, v61
    v_mfma_f32_16x16x32_bf16 v[186:189], a[36:39], a[36:39], v[186:189]
    v_add_u32 v16, s68, v16
    s_add_u32 m0, s3, 18688
    s_nop 0
    buffer_load_dwordx4 v156, s[4:7], s69 offen offset:0 lds
    s_mul_i32 s68, s42, 6720
    v_mul_u32_u24 v61, 0x50, v1
    v_add_u32 v17, 0x40, v61
    v_mfma_f32_16x16x32_bf16 v[190:193], a[244:247], a[36:39], v[190:193]
    buffer_load_dwordx4 v157, s[4:7], s69 offen offset:1024 lds
    v_add_u32 v17, s68, v17
    s_mul_i32 s68, s42, 6720
    v_mul_u32_u24 v61, 0x50, v1
    v_lshl_add_u32 v61, v2, 4, v61
    s_mov_b64 exec, 0xffff
    buffer_load_dwordx4 v158, s[4:7], s69 offen offset:2048 lds
    s_mov_b64 exec, -1
    v_mfma_f32_16x16x32_bf16 v[186:189], a[44:47], a[44:47], v[186:189]
    v_add_u32 v18, 0x540, v61
    v_add_u32 v18, s68, v18
    s_mul_i32 s68, s42, 6720
    v_mul_u32_u24 v61, 0x50, v1
    v_mfma_f32_16x16x32_bf16 v[190:193], a[244:247], a[44:47], v[190:193]
    v_lshl_add_u32 v61, v2, 4, v61
    v_add_u32 v19, 0x7c0, v61
    s_mov_b32 exec_lo, 0x10000
    s_mov_b32 exec_hi, 0x10001
    v_add_u32 v19, 0xcc0, v61
    s_mov_b64 exec, 0x1
    v_add_u32 v19, 0x680, v61
    s_mov_b64 exec, -1
    v_add_u32 v19, s68, v19
    v_mfma_f32_16x16x32_bf16 v[186:189], a[52:55], a[52:55], v[186:189]
    s_mul_i32 s68, s42, 6720
    v_mul_u32_u24 v61, 0x50, v1
    v_lshl_add_u32 v61, v2, 4, v61
    v_add_u32 v20, 0x580, v61
    v_mfma_f32_16x16x32_bf16 v[190:193], a[244:247], a[52:55], v[190:193]
    v_add_u32 v20, s68, v20
    s_mul_i32 s68, s42, 6720
    v_mul_u32_u24 v61, 0x50, v1
    v_mfma_f32_16x16x32_bf16 v[186:189], a[60:63], a[60:63], v[186:189]
    v_lshl_add_u32 v61, v2, 4, v61
    v_add_u32 v21, 0x800, v61
    s_mov_b64 exec, 0x10001
    v_add_u32 v21, 0xd00, v61
    s_mov_b64 exec, -1
    v_add_u32 v21, s68, v21
    v_mfma_f32_16x16x32_bf16 v[190:193], a[244:247], a[60:63], v[190:193]
    s_mul_i32 s68, s42, 6720
    v_lshl_add_u32 v61, v2, 4, s68
    v_add_u32 v22, 0x640, v61
    s_mul_i32 s68, s42, 6720
    v_mfma_f32_16x16x32_bf16 v[186:189], a[132:135], a[132:135], v[186:189]
    v_mul_u32_u24 v61, 0xa0, v1
    v_lshl_add_u32 v61, v2, 4, v61
    v_add_u32 v23, 0x0, v61
    v_add_u32 v23, s68, v23
    v_mfma_f32_16x16x32_bf16 v[190:193], a[244:247], a[132:135], v[190:193]
    s_mul_i32 s68, s42, 6720
    v_mul_u32_u24 v61, 0xa0, v1
    v_lshl_add_u32 v61, v2, 4, v61
    v_add_u32 v24, 0xa80, v61
    v_mfma_f32_16x16x32_bf16 v[186:189], a[140:143], a[140:143], v[186:189]
    s_mov_b64 exec, 0xf000f
    v_add_u32 v24, 0xa00, v61
    s_mov_b64 exec, -1
    v_add_u32 v24, s68, v24
    s_mul_i32 s68, s42, 6720
    v_mul_u32_u24 v61, 0xa0, v1
    v_mfma_f32_16x16x32_bf16 v[190:193], a[244:247], a[140:143], v[190:193]
    v_lshl_add_u32 v61, v2, 4, v61
    v_add_u32 v25, 0xf80, v61
    s_mov_b64 exec, 0x10001
    v_add_u32 v25, 0xc80, v61
    s_mov_b32 exec_lo, 0x0
    s_mov_b32 exec_hi, 0x10001
    v_add_u32 v25, 0x1980, v61
    s_mov_b64 exec, -1
    v_add_u32 v25, s68, v25
    s_mov_b32 s55, 131072
    s_nop 1
P0:
    buffer_load_dwordx2 v[228:229], v9, s[36:39], 0 offen sc1
    buffer_load_dword v230, v11, s[36:39], 0 offen sc1
    s_waitcnt vmcnt(0)
    v_min_u32 v230, v230, v228
    v_cmp_le_u32 vcc, 1, v230
    s_cmp_eq_u64 vcc, -1
    s_nop 3
    s_cbranch_scc1 P0_done
    s_sub_u32 s55, s55, 1
    s_cmp_eq_u32 s55, 0
    s_cbranch_scc1 ABORT
    s_branch P0
P0_done:
    s_add_u32 m0, s90, 0
    s_add_u32 s3, s91, 0
    buffer_load_dwordx4 v4, s[36:39], s3 offen lds
    s_add_u32 m0, s90, 4096
    s_add_u32 s3, s91, 4096
    buffer_load_dwordx4 v4, s[36:39], s3 offen lds
    s_add_u32 m0, s90, 8192
    s_add_u32 s3, s91, 8192
    buffer_load_dwordx4 v4, s[36:39], s3 offen lds
    v_cmp_eq_u32 vcc, s75, v229
    s_add_u32 s66, s88, 0x0
    buffer_load_dwordx4 v[128:131], v50, s[36:39], s66 offen offset:0 sc1
    buffer_load_dwordx4 v[132:135], v50, s[36:39], s66 offen offset:1024 sc1
    buffer_load_dwordx4 v[136:139], v50, s[36:39], s66 offen offset:2048 sc1
    buffer_load_dwordx4 v[140:143], v50, s[36:39], s66 offen offset:3072 sc1
    s_cmp_eq_u64 vcc, -1
    s_cselect_b32 s50, 1, 0
    s_add_u32 m0, s90, 12288
    s_add_u32 s3, s91, 12288
    buffer_load_dwordx4 v4, s[36:39], s3 offen lds
    s_add_u32 m0, s90, 16384
    s_add_u32 s3, s91, 16384
    buffer_load_dwordx4 v4, s[36:39], s3 offen lds
    s_add_u32 m0, s90, 20480
    s_add_u32 s3, s91, 20480
    buffer_load_dwordx4 v4, s[36:39], s3 offen lds
    s_add_u32 m0, s90, 24576
    s_add_u32 s3, s91, 24576
    buffer_load_dwordx4 v4, s[36:39], s3 offen lds
    s_add_u32 m0, s90, 28672
    s_add_u32 s3, s91, 28672
    buffer_load_dwordx4 v4, s[36:39], s3 offen lds
    s_add_u32 m0, s90, 32768
    s_add_u32 s3, s91, 32768
    buffer_load_dwordx4 v4, s[36:39], s3 offen lds
    s_add_u32 m0, s90, 36864
    s_add_u32 s3, s91, 36864
    buffer_load_dwordx4 v4, s[36:39], s3 offen lds
    ds_read2_b64 a[64:67], v159 offset0:0 offset1:4
    ds_read2_b64 a[72:75], v159 offset0:10 offset1:14
    ds_read2_b64 a[80:83], v159 offset0:20 offset1:24
    ds_read2_b64 a[88:91], v159 offset0:30 offset1:34
    ds_read2_b64 a[96:99], v159 offset0:40 offset1:44
    ds_read2_b64 a[104:107], v159 offset0:50 offset1:54
    ds_read2_b64 a[112:115], v159 offset0:60 offset1:64
    ds_read2_b64 a[120:123], v159 offset0:70 offset1:74
    ds_read_b128 a[144:147], v162 offset:0
    ds_read_b128 a[152:155], v162 offset:320
    s_bitcmp1_b32 s41, 3
    s_cselect_b64 exec, -1, 0
    ds_read_b64 v[216:217], v163 offset:0
    ds_read_b64 v[218:219], v163 offset:32
    ds_read_b64 v[220:221], v164 offset:0
    s_mov_b64 exec, -1
    ds_read2_b64 a[68:71], v160 offset0:0 offset1:4
    ds_read2_b64 a[76:79], v160 offset0:10 offset1:14
    ds_read2_b64 a[84:87], v160 offset0:20 offset1:24
    ds_read2_b64 a[92:95], v160 offset0:30 offset1:34
    ds_read2_b64 a[100:103], v160 offset0:40 offset1:44
    ds_read2_b64 a[108:111], v160 offset0:50 offset1:54
    ds_read2_b64 a[116:119], v160 offset0:60 offset1:64
    ds_read2_b64 a[124:127], v160 offset0:70 offset1:74
    ds_read_b128 a[148:151], v162 offset:10496
    ds_read_b128 a[156:159], v162 offset:10816
    s_bitcmp1_b32 s41, 3
    s_cselect_b64 exec, -1, 0
    ds_read_b64 v[222:223], v163 offset:10496
    ds_read_b64 v[224:225], v163 offset:10528
    ds_read_b64 v[226:227], v164 offset:10496
    s_mov_b64 exec, -1
    s_lshl_b32 s66, s42, 4
    v_add_u32 v61, s66, v1
    v_cmp_gt_u32 s[100:101], 41, v61
    v_cmp_gt_u32 s[84:85], 18, v61
    s_waitcnt lgkmcnt(0)
    v_lshlrev_b32 v64, 16, v216
    v_and_b32 v65, 0xffff0000, v216
    v_lshlrev_b32 v66, 16, v217
    v_and_b32 v67, 0xffff0000, v217
    v_lshlrev_b32 v68, 16, v218
    v_and_b32 v69, 0xffff0000, v218
    v_lshlrev_b32 v70, 16, v219
    v_and_b32 v71, 0xffff0000, v219
    v_lshlrev_b32 v72, 16, v220
    v_and_b32 v73, 0xffff0000, v220
    v_lshlrev_b32 v74, 16, v221
    v_and_b32 v75, 0xffff0000, v221
    v_lshlrev_b32 v76, 16, v222
    v_and_b32 v77, 0xffff0000, v222
    v_lshlrev_b32 v78, 16, v223
    v_and_b32 v79, 0xffff0000, v223
    v_lshlrev_b32 v80, 16, v224
    v_and_b32 v81, 0xffff0000, v224
    v_lshlrev_b32 v82, 16, v225
    v_and_b32 v83, 0xffff0000, v225
    v_lshlrev_b32 v84, 16, v226
    v_and_b32 v85, 0xffff0000, v226
    v_lshlrev_b32 v86, 16, v227
    v_and_b32 v87, 0xffff0000, v227
    s_mov_b64 s[92:93], s[36:37]
    s_mov_b64 s[94:95], s[38:39]
    v_add_u32 v13, s43, v4
    v_add_u32 v14, s44, v4
    s_waitcnt vmcnt(7)
    v_add_f32 v128, v128, v132
    v_add_f32 v136, v136, v140
    v_add_f32 v129, v129, v133
    v_add_f32 v137, v137, v141
    v_add_f32 v130, v130, v134
    v_add_f32 v138, v138, v142
    v_add_f32 v131, v131, v135
    v_add_f32 v139, v139, v143
    v_add_f32 v128, v128, v136
    v_add_f32 v129, v129, v137
    v_add_f32 v130, v130, v138
    v_add_f32 v131, v131, v139
    v_permlane32_swap_b32 v128, v129
    s_nop 0
    v_permlane32_swap_b32 v130, v131
    v_add_f32 v128, v128, v129
    v_add_f32 v130, v130, v131
    s_nop 1
    v_permlane16_swap_b32 v128, v130
    v_add_f32 v128, v128, v130
    s_mov_b32 exec_lo, 0xffffff
    s_mov_b32 exec_hi, 0xffff
    ds_write_b32 v51, v128 offset:0
    s_mov_b64 exec, -1
    v_mov_b32 v238, 2
    s_waitcnt lgkmcnt(0)
    s_barrier
    ds_read_b128 v[128:131], v13 offset:0
    ds_read_b128 v[132:135], v13 offset:1024
    ds_read_b128 v[136:139], v13 offset:2048
    ds_read_b128 v[140:143], v13 offset:3072
    ds_read_b128 v[144:147], v13 offset:4096
    ds_read_b128 v[204:207], v13 offset:5120
    ds_read_b128 v[208:211], v13 offset:6144
    ds_read_b128 v[212:215], v13 offset:7168
    s_waitcnt lgkmcnt(6)
    v_mfma_f32_16x16x32_bf16 v[88:91], a[0:3], v[128:131], 0
    s_add_u32 m0, s90, 40960
    s_add_u32 s3, s91, 40960
    buffer_load_dwordx4 v4, s[36:39], s3 offen lds
    v_mfma_f32_16x16x32_bf16 v[92:95], a[4:7], v[128:131], 0
    ds_read_b128 v[128:131], v13 offset:8192
    ds_read_b64_tr_b16 v[148:149], v236 offset:13312
    v_mfma_f32_16x16x32_bf16 v[96:99], a[0:3], v[132:135], 0
    v_mfma_f32_16x16x32_bf16 v[178:181], a[64:67], a[64:67], v[178:181]
    v_mfma_f32_16x16x32_bf16 v[100:103], a[4:7], v[132:135], 0
    ds_read_b128 v[132:135], v13 offset:9216
    v_mfma_f32_16x16x32_bf16 v[182:185], a[244:247], a[64:67], v[182:185]
    s_waitcnt lgkmcnt(6)
    v_mfma_f32_16x16x32_bf16 v[104:107], a[0:3], v[136:139], 0
    ds_read_b64_tr_b16 v[150:151], v236 offset:14592
    ds_read_b64_tr_b16 v[152:153], v236 offset:13344
    v_mfma_f32_16x16x32_bf16 v[108:111], a[4:7], v[136:139], 0
    ds_read_b128 v[136:139], v13 offset:10240
    v_mfma_f32_16x16x32_bf16 v[178:181], a[72:75], a[72:75], v[178:181]
    v_mfma_f32_16x16x32_bf16 v[112:115], a[0:3], v[140:143], 0
    s_add_u32 m0, s90, 45056
    s_add_u32 s3, s91, 45056
    buffer_load_dwordx4 v4, s[36:39], s3 offen lds
    v_mfma_f32_16x16x32_bf16 v[182:185], a[244:247], a[72:75], v[182:185]
    v_mfma_f32_16x16x32_bf16 v[116:119], a[4:7], v[140:143], 0
    ds_read_b128 v[140:143], v13 offset:11264
    ds_read_b64_tr_b16 v[154:155], v236 offset:14624
    v_mfma_f32_16x16x32_bf16 v[120:123], a[0:3], v[144:147], 0
    ds_read_b64_tr_b16 v[156:157], v236 offset:13376
    ds_read_b64_tr_b16 v[158:159], v236 offset:14656
    v_mfma_f32_16x16x32_bf16 v[178:181], a[80:83], a[80:83], v[178:181]
    v_mfma_f32_16x16x32_bf16 v[124:127], a[4:7], v[144:147], 0
    s_waitcnt vmcnt(6)
    s_barrier
    ds_read_b128 v[144:147], v13 offset:12288
    s_add_u32 m0, s90, 49152
    s_add_u32 s3, s91, 49152
    buffer_load_dwordx4 v4, s[36:39], s3 offen lds
    v_mfma_f32_16x16x32_bf16 v[182:185], a[244:247], a[80:83], v[182:185]
    s_waitcnt lgkmcnt(12)
    v_mfma_f32_16x16x32_bf16 v[88:91], a[8:11], v[204:207], v[88:91]
    ds_read_b64_tr_b16 v[160:161], v237 offset:13312
    ds_read_b64_tr_b16 v[162:163], v237 offset:13632
    v_mfma_f32_16x16x32_bf16 v[92:95], a[12:15], v[204:207], v[92:95]
    ds_read_b128 v[204:207], v13 offset:13312
    v_mfma_f32_16x16x32_bf16 v[178:181], a[88:91], a[88:91], v[178:181]
    v_mfma_f32_16x16x32_bf16 v[96:99], a[8:11], v[208:211], v[96:99]
    s_add_u32 m0, s90, 53248
    s_add_u32 s3, s91, 53248
    buffer_load_dwordx4 v4, s[36:39], s3 offen lds
    v_mfma_f32_16x16x32_bf16 v[182:185], a[244:247], a[88:91], v[182:185]
    v_mfma_f32_16x16x32_bf16 v[100:103], a[12:15], v[208:211], v[100:103]
    ds_read_b128 v[208:211], v13 offset:14336
    s_waitcnt lgkmcnt(12)
    v_mfma_f32_16x16x32_bf16 v[104:107], a[8:11], v[212:215], v[104:107]
    s_add_u32 m0, s90, 57344
    s_add_u32 s3, s91, 57344
    buffer_load_dwordx4 v4, s[36:39], s3 offen lds
    v_mfma_f32_16x16x32_bf16 v[178:181], a[96:99], a[96:99], v[178:181]
    v_mfma_f32_16x16x32_bf16 v[108:111], a[12:15], v[212:215], v[108:111]
    ds_read_b128 v[212:215], v13 offset:15360
    v_mfma_f32_16x16x32_bf16 v[182:185], a[244:247], a[96:99], v[182:185]
    v_mfma_f32_16x16x32_bf16 v[112:115], a[8:11], v[128:131], v[112:115]
    s_waitcnt lgkmcnt(12)
    v_mfma_f32_16x16x32_bf16 v[116:119], a[12:15], v[128:131], v[116:119]
    ds_read_b128 v[128:131], v13 offset:16384
    v_mfma_f32_16x16x32_bf16 v[164:167], a[160:163], v[148:151], 0
    s_add_u32 m0, s90, 61440
    s_add_u32 s3, s91, 61440
    buffer_load_dwordx4 v4, s[36:39], s3 offen lds
    v_mfma_f32_16x16x32_bf16 v[178:181], a[104:107], a[104:107], v[178:181]
    v_mfma_f32_16x16x32_bf16 v[120:123], a[8:11], v[132:135], v[120:123]
    s_waitcnt lgkmcnt(9)
    v_mfma_f32_16x16x32_bf16 v[182:185], a[244:247], a[104:107], v[182:185]
    v_mfma_f32_16x16x32_bf16 v[124:127], a[12:15], v[132:135], v[124:127]
    ds_read_b128 v[132:135], v13 offset:17408
    v_mfma_f32_16x16x32_bf16 v[88:91], a[16:19], v[136:139], v[88:91]
    s_add_u32 m0, s90, 65536
    s_add_u32 s3, s91, 65536
    buffer_load_dwordx4 v4, s[36:39], s3 offen lds
    v_mfma_f32_16x16x32_bf16 v[178:181], a[112:115], a[112:115], v[178:181]
    v_mfma_f32_16x16x32_bf16 v[92:95], a[20:23], v[136:139], v[92:95]
    ds_read_b128 v[136:139], v13 offset:18432
    v_mfma_f32_16x16x32_bf16 v[182:185], a[244:247], a[112:115], v[182:185]
    v_mfma_f32_16x16x32_bf16 v[96:99], a[16:19], v[140:143], v[96:99]
    v_mfma_f32_16x16x32_bf16 v[164:167], a[164:167], v[152:155], v[164:167]
    s_add_u32 m0, s90, 69632
    s_add_u32 s3, s91, 69632
    buffer_load_dwordx4 v4, s[36:39], s3 offen lds
    v_mfma_f32_16x16x32_bf16 v[100:103], a[20:23], v[140:143], v[100:103]
    ds_read_b128 v[140:143], v13 offset:19456
    v_mfma_f32_16x16x32_bf16 v[178:181], a[120:123], a[120:123], v[178:181]
    s_waitcnt lgkmcnt(5)
    v_mfma_f32_16x16x32_bf16 v[104:107], a[16:19], v[144:147], v[104:107]
    v_mfma_f32_16x16x32_bf16 v[182:185], a[244:247], a[120:123], v[182:185]
    v_mfma_f32_16x16x32_bf16 v[108:111], a[20:23], v[144:147], v[108:111]
    ds_read_b128 v[144:147], v13 offset:20480
    s_add_u32 m0, s90, 73728
    s_add_u32 s3, s91, 73728
    buffer_load_dwordx4 v4, s[36:39], s3 offen lds
    v_mfma_f32_16x16x32_bf16 v[112:115], a[16:19], v[204:207], v[112:115]
    v_mfma_f32_16x16x32_bf16 v[164:167], a[168:171], v[156:159], v[164:167]
    v_mfma_f32_16x16x32_bf16 v[178:181], a[144:147], a[144:147], v[178:181]
    v_mfma_f32_16x16x32_bf16 v[116:119], a[20:23], v[204:207], v[116:119]
    ds_read_b128 v[204:207], v13 offset:21504
    v_mfma_f32_16x16x32_bf16 v[182:185], a[244:247], a[144:147], v[182:185]
    v_mfma_f32_16x16x32_bf16 v[120:123], a[16:19], v[208:211], v[120:123]
    s_add_u32 m0, s90, 77824
    s_add_u32 s3, s91, 77824
    buffer_load_dwordx4 v4, s[36:39], s3 offen lds
    v_mfma_f32_16x16x32_bf16 v[124:127], a[20:23], v[208:211], v[124:127]
    ds_read_b128 v[208:211], v13 offset:22528
    v_mfma_f32_16x16x32_bf16 v[178:181], a[152:155], a[152:155], v[178:181]
    s_waitcnt lgkmcnt(6)
    v_mfma_f32_16x16x32_bf16 v[88:91], a[24:27], v[212:215], v[88:91]
    s_add_u32 m0, s90, 81920
    s_add_u32 s3, s91, 81920
    buffer_load_dwordx4 v4, s[36:39], s3 offen lds
    v_mfma_f32_16x16x32_bf16 v[182:185], a[244:247], a[152:155], v[182:185]
    v_mfma_f32_16x16x32_bf16 v[92:95], a[28:31], v[212:215], v[92:95]
    ds_read_b128 v[212:215], v13 offset:23552
    v_mfma_f32_16x16x32_bf16 v[164:167], a[172:175], v[160:163], v[164:167]
    v_mfma_f32_16x16x32_bf16 v[96:99], a[24:27], v[128:131], v[96:99]
    s_add_u32 m0, s90, 86016
    s_add_u32 s3, s91, 86016
    buffer_load_dwordx4 v4, s[36:39], s3 offen lds
    v_mfma_f32_16x16x32_bf16 v[186:189], a[68:71], a[68:71], v[186:189]
    v_mfma_f32_16x16x32_bf16 v[100:103], a[28:31], v[128:131], v[100:103]
    s_waitcnt vmcnt(12)
    s_barrier
    ds_read_b128 v[128:131], v13 offset:24576
    v_mfma_f32_16x16x32_bf16 v[190:193], a[244:247], a[68:71], v[190:193]
    s_waitcnt lgkmcnt(5)
    v_mfma_f32_16x16x32_bf16 v[104:107], a[24:27], v[132:135], v[104:107]
    s_add_u32 m0, s90, 90112
    s_add_u32 s3, s91, 90112
    buffer_load_dwordx4 v4, s[36:39], s3 offen lds
    v_mfma_f32_16x16x32_bf16 v[108:111], a[28:31], v[132:135], v[108:111]
    ds_read_b128 v[132:135], v13 offset:25600
    v_mfma_f32_16x16x32_bf16 v[186:189], a[76:79], a[76:79], v[186:189]
    v_mfma_f32_16x16x32_bf16 v[112:115], a[24:27], v[136:139], v[112:115]
    v_mfma_f32_16x16x32_bf16 v[190:193], a[244:247], a[76:79], v[190:193]
    v_mfma_f32_16x16x32_bf16 v[116:119], a[28:31], v[136:139], v[116:119]
    ds_read_b128 v[136:139], v13 offset:26624
    v_mfma_f32_16x16x32_bf16 v[120:123], a[24:27], v[140:143], v[120:123]
    s_add_u32 m0, s90, 94208
    s_add_u32 s3, s91, 94208
    buffer_load_dwordx4 v4, s[36:39], s3 offen lds
    v_mfma_f32_16x16x32_bf16 v[186:189], a[84:87], a[84:87], v[186:189]
    v_mfma_f32_16x16x32_bf16 v[124:127], a[28:31], v[140:143], v[124:127]
    ds_read_b128 v[140:143], v13 offset:27648
    s_add_u32 m0, s90, 98304
    s_add_u32 s3, s91, 98304
    buffer_load_dwordx4 v4, s[36:39], s3 offen lds
    v_mfma_f32_16x16x32_bf16 v[190:193], a[244:247], a[84:87], v[190:193]
    s_waitcnt lgkmcnt(6)
    v_mfma_f32_16x16x32_bf16 v[88:91], a[32:35], v[144:147], v[88:91]
    v_mfma_f32_16x16x32_bf16 v[186:189], a[92:95], a[92:95], v[186:189]
    v_mfma_f32_16x16x32_bf16 v[92:95], a[36:39], v[144:147], v[92:95]
    ds_read_b128 v[144:147], v13 offset:28672
    v_mfma_f32_16x16x32_bf16 v[96:99], a[32:35], v[204:207], v[96:99]
    buffer_store_dwordx4 v[148:151], v55, s[36:39], s47 offen sc1
    v_mfma_f32_16x16x32_bf16 v[190:193], a[244:247], a[92:95], v[190:193]
    v_mfma_f32_16x16x32_bf16 v[100:103], a[36:39], v[204:207], v[100:103]
    ds_read_b128 v[204:207], v13 offset:29696
    s_waitcnt lgkmcnt(5)
    v_mfma_f32_16x16x32_bf16 v[104:107], a[32:35], v[208:211], v[104:107]
    buffer_store_dwordx4 v[152:155], v55, s[36:39], s47 offen offset:1024 sc1
    v_mfma_f32_16x16x32_bf16 v[186:189], a[100:103], a[100:103], v[186:189]
    v_mfma_f32_16x16x32_bf16 v[108:111], a[36:39], v[208:211], v[108:111]
    ds_read_b128 v[208:211], v13 offset:30720
    s_mov_b32 exec_lo, 0xff00ff
    s_mov_b32 exec_hi, 0xff00ff
    buffer_store_dwordx4 v[156:159], v52, s[36:39], s47 offen sc1
    s_mov_b32 exec_lo, 0xffffffff
    s_mov_b32 exec_hi, 0xff
    buffer_store_dwordx4 v[160:163], v53, s[36:39], s47 offen sc1
    s_mov_b64 exec, 0xffff
    s_add_u32 s66, s89, 0x40000
    buffer_store_dwordx4 v[164:167], v4, s[36:39], s66 offen sc1
    s_mov_b64 exec, -1
    v_mfma_f32_16x16x32_bf16 v[190:193], a[244:247], a[100:103], v[190:193]
    v_mfma_f32_16x16x32_bf16 v[112:115], a[32:35], v[212:215], v[112:115]
    v_mfma_f32_16x16x32_bf16 v[186:189], a[108:111], a[108:111], v[186:189]
    v_mfma_f32_16x16x32_bf16 v[116:119], a[36:39], v[212:215], v[116:119]
    ds_read_b128 v[212:215], v13 offset:31744
    v_mfma_f32_16x16x32_bf16 v[120:123], a[32:35], v[128:131], v[120:123]
    v_mfma_f32_16x16x32_bf16 v[190:193], a[244:247], a[108:111], v[190:193]
    v_mfma_f32_16x16x32_bf16 v[124:127], a[36:39], v[128:131], v[124:127]
    ds_read_b128 v[128:131], v13 offset:32768
    s_waitcnt lgkmcnt(6)
    v_mfma_f32_16x16x32_bf16 v[88:91], a[40:43], v[132:135], v[88:91]
    v_mfma_f32_16x16x32_bf16 v[186:189], a[116:119], a[116:119], v[186:189]
    v_mfma_f32_16x16x32_bf16 v[92:95], a[44:47], v[132:135], v[92:95]
    ds_read_b128 v[132:135], v13 offset:33792
    v_mfma_f32_16x16x32_bf16 v[190:193], a[244:247], a[116:119], v[190:193]
    v_mfma_f32_16x16x32_bf16 v[96:99], a[40:43], v[136:139], v[96:99]
    s_add_u32 s66, s58, 0
    s_mov_b64 exec, s[64:65]
    buffer_store_dwordx2 a[236:237], v42, s[36:39], s66 offen sc1
    s_mov_b64 exec, -1
    v_mfma_f32_16x16x32_bf16 v[100:103], a[44:47], v[136:139], v[100:103]
    ds_read_b128 v[136:139], v13 offset:34816
    v_mfma_f32_16x16x32_bf16 v[186:189], a[124:127], a[124:127], v[186:189]
    s_waitcnt lgkmcnt(5)
    v_mfma_f32_16x16x32_bf16 v[104:107], a[40:43], v[140:143], v[104:107]
    s_add_u32 s66, s58, 65536
    s_mov_b64 exec, s[64:65]
    buffer_store_dwordx4 a[236:239], v41, s[36:39], s66 offen sc1
    s_mov_b64 exec, -1
    v_mfma_f32_16x16x32_bf16 v[190:193], a[244:247], a[124:127], v[190:193]
    v_mfma_f32_16x16x32_bf16 v[108:111], a[44:47], v[140:143], v[108:111]
    ds_read_b128 v[140:143], v13 offset:35840
    v_mfma_f32_16x16x32_bf16 v[112:115], a[40:43], v[144:147], v[112:115]
    v_mfma_f32_16x16x32_bf16 v[186:189], a[148:151], a[148:151], v[186:189]
    v_mfma_f32_16x16x32_bf16 v[116:119], a[44:47], v[144:147], v[116:119]
    ds_read_b128 v[144:147], v13 offset:36864
    s_add_u32 s66, s58, 131072
    s_mov_b64 exec, s[64:65]
    buffer_store_dwordx2 a[236:237], v42, s[36:39], s66 offen sc1
    s_mov_b64 exec, -1
    v_mfma_f32_16x16x32_bf16 v[190:193], a[244:247], a[148:151], v[190:193]
    v_mfma_f32_16x16x32_bf16 v[120:123], a[40:43], v[204:207], v[120:123]
    v_mfma_f32_16x16x32_bf16 v[186:189], a[156:159], a[156:159], v[186:189]
    v_mfma_f32_16x16x32_bf16 v[124:127], a[44:47], v[204:207], v[124:127]
    ds_read_b128 v[204:207], v13 offset:37888
    s_add_u32 s66, s58, 196608
    s_mov_b64 exec, s[64:65]
    buffer_store_dwordx4 a[236:239], v41, s[36:39], s66 offen sc1
    s_mov_b64 exec, -1
    v_mfma_f32_16x16x32_bf16 v[190:193], a[244:247], a[156:159], v[190:193]
    s_waitcnt lgkmcnt(6)
    v_mfma_f32_16x16x32_bf16 v[88:91], a[48:51], v[208:211], v[88:91]
    s_add_u32 s67, s45, s48
    s_add_u32 s68, s46, s48
    s_add_u32 m0, s67, 0
    s_add_u32 s69, s68, 102400
    buffer_load_dwordx4 v4, s[36:39], s69 offen offset:0 lds
    v_mfma_f32_16x16x32_bf16 v[92:95], a[52:55], v[208:211], v[92:95]
    ds_read_b128 v[208:211], v13 offset:38912
    v_mfma_f32_16x16x32_bf16 v[96:99], a[48:51], v[212:215], v[96:99]
    v_mfma_f32_16x16x32_bf16 v[100:103], a[52:55], v[212:215], v[100:103]
    ds_read_b128 v[212:215], v13 offset:39936
    s_waitcnt lgkmcnt(5)
    v_mfma_f32_16x16x32_bf16 v[104:107], a[48:51], v[128:131], v[104:107]
    v_mov_b32 v184, v190
    v_mfma_f32_16x16x32_bf16 v[108:111], a[52:55], v[128:131], v[108:111]
    s_waitcnt vmcnt(21)
    s_barrier
    ds_read_b128 v[128:131], v13 offset:40960
    v_mfma_f32_16x16x32_bf16 v[112:115], a[48:51], v[132:135], v[112:115]
    s_mov_b32 exec_lo, 0x11111111
    s_mov_b32 exec_hi, 0x11111111
    v_mov_b32 v183, v178
    v_mov_b32 v185, v186
    s_mov_b32 exec_lo, 0x22222222
    s_mov_b32 exec_hi, 0x22222222
    v_mov_b32 v183, v179
    v_mov_b32 v185, v187
    s_mov_b32 exec_lo, 0x44444444
    s_mov_b32 exec_hi, 0x44444444
    v_mov_b32 v183, v180
    v_mov_b32 v185, v188
    s_mov_b32 exec_lo, 0x88888888
    s_mov_b32 exec_hi, 0x88888888
    v_mov_b32 v183, v181
    v_mov_b32 v185, v189
    s_mov_b32 exec_lo, 0xf0000f
    s_mov_b32 exec_hi, 0xf0000f00
    ds_write_b128 v44, v[182:185]
    s_mov_b64 exec, -1
    v_mfma_f32_16x16x32_bf16 v[116:119], a[52:55], v[132:135], v[116:119]
    ds_read_b128 v[132:135], v13 offset:41984
    v_mfma_f32_16x16x32_bf16 v[120:123], a[48:51], v[136:139], v[120:123]
    s_add_u32 m0, s67, 0
    s_nop 0
    buffer_load_dwordx4 v4, s[36:39], s69 offen offset:1024 lds
    v_mfma_f32_16x16x32_bf16 v[124:127], a[52:55], v[136:139], v[124:127]
    ds_read_b128 v[136:139], v13 offset:43008
    s_waitcnt lgkmcnt(7)
    v_mfma_f32_16x16x32_bf16 v[88:91], a[56:59], v[140:143], v[88:91]
    v_mfma_f32_16x16x32_bf16 v[92:95], a[60:63], v[140:143], v[92:95]
    ds_read_b128 v[140:143], v13 offset:44032
    v_mfma_f32_16x16x32_bf16 v[96:99], a[56:59], v[144:147], v[96:99]
    s_add_u32 m0, s67, 0
    s_nop 0
    buffer_load_dwordx4 v4, s[36:39], s69 offen offset:2048 lds
    v_mfma_f32_16x16x32_bf16 v[100:103], a[60:63], v[144:147], v[100:103]
    ds_read_b128 v[144:147], v13 offset:45056
    s_waitcnt lgkmcnt(6)
    v_mfma_f32_16x16x32_bf16 v[104:107], a[56:59], v[204:207], v[104:107]
    v_mfma_f32_16x16x32_bf16 v[108:111], a[60:63], v[204:207], v[108:111]
    ds_read_b128 v[204:207], v13 offset:46080
    v_mfma_f32_16x16x32_bf16 v[112:115], a[56:59], v[208:211], v[112:115]
    s_add_u32 m0, s67, 0
    s_nop 0
    buffer_load_dwordx4 v4, s[36:39], s69 offen offset:3072 lds
    v_mfma_f32_16x16x32_bf16 v[116:119], a[60:63], v[208:211], v[116:119]
    ds_read_b128 v[208:211], v13 offset:47104
    v_mfma_f32_16x16x32_bf16 v[120:123], a[56:59], v[212:215], v[120:123]
    v_mfma_f32_16x16x32_bf16 v[124:127], a[60:63], v[212:215], v[124:127]
    ds_read_b128 v[212:215], v13 offset:48128
    s_waitcnt lgkmcnt(6)
    v_mfma_f32_16x16x32_bf16 v[88:91], a[64:67], v[128:131], v[88:91]
    s_add_u32 m0, s67, 4096
    s_add_u32 s69, s68, 106496
    buffer_load_dwordx4 v4, s[36:39], s69 offen offset:0 lds
    v_mfma_f32_16x16x32_bf16 v[92:95], a[68:71], v[128:131], v[92:95]
    ds_read_b128 v[128:131], v13 offset:49152
    v_mfma_f32_16x16x32_bf16 v[96:99], a[64:67], v[132:135], v[96:99]
    v_mfma_f32_16x16x32_bf16 v[100:103], a[68:71], v[132:135], v[100:103]
    ds_read_b128 v[132:135], v13 offset:50176
    s_waitcnt lgkmcnt(5)
    v_mfma_f32_16x16x32_bf16 v[104:107], a[64:67], v[136:139], v[104:107]
    v_mfma_f32_16x16x32_bf16 v[108:111], a[68:71], v[136:139], v[108:111]
    ds_read_b128 v[136:139], v14 offset:0
    v_mfma_f32_16x16x32_bf16 v[112:115], a[64:67], v[140:143], v[112:115]
    s_add_u32 m0, s67, 4096
    s_nop 0
    buffer_load_dwordx4 v4, s[36:39], s69 offen offset:1024 lds
    v_mfma_f32_16x16x32_bf16 v[116:119], a[68:71], v[140:143], v[116:119]
    ds_read_b128 v[140:143], v14 offset:1024
    v_mfma_f32_16x16x32_bf16 v[120:123], a[64:67], v[144:147], v[120:123]
    v_mfma_f32_16x16x32_bf16 v[124:127], a[68:71], v[144:147], v[124:127]
    ds_read_b128 v[144:147], v14 offset:2048
    s_waitcnt lgkmcnt(6)
    v_mfma_f32_16x16x32_bf16 v[88:91], a[72:75], v[204:207], v[88:91]
    s_add_u32 m0, s67, 4096
    s_nop 0
    buffer_load_dwordx4 v4, s[36:39], s69 offen offset:2048 lds
    v_mfma_f32_16x16x32_bf16 v[92:95], a[76:79], v[204:207], v[92:95]
    ds_read_b128 v[204:207], v14 offset:3072
    v_mfma_f32_16x16x32_bf16 v[96:99], a[72:75], v[208:211], v[96:99]
    v_mfma_f32_16x16x32_bf16 v[100:103], a[76:79], v[208:211], v[100:103]
    ds_read_b128 v[208:211], v14 offset:4096
    s_waitcnt lgkmcnt(5)
    v_mfma_f32_16x16x32_bf16 v[104:107], a[72:75], v[212:215], v[104:107]
    s_add_u32 m0, s67, 4096
    s_nop 0
    buffer_load_dwordx4 v4, s[36:39], s69 offen offset:3072 lds
    v_mfma_f32_16x16x32_bf16 v[108:111], a[76:79], v[212:215], v[108:111]
    ds_read_b128 v[212:215], v14 offset:5120
    ds_read_b128 v[216:219], v44
    v_mfma_f32_16x16x32_bf16 v[112:115], a[72:75], v[128:131], v[112:115]
    ds_read_b128 v[220:223], v45 offset:0
    v_mfma_f32_16x16x32_bf16 v[116:119], a[76:79], v[128:131], v[116:119]
    s_waitcnt vmcnt(24)
    s_barrier
    ds_read_b128 v[128:131], v14 offset:6144
    v_mfma_f32_16x16x32_bf16 v[120:123], a[72:75], v[132:135], v[120:123]
    ds_read_b128 v[224:227], v45 offset:16
    ds_read_b128 v[228:231], v45 offset:32
    v_mfma_f32_16x16x32_bf16 v[124:127], a[76:79], v[132:135], v[124:127]
    ds_read_b128 v[132:135], v14 offset:7168
    s_waitcnt lgkmcnt(10)
    v_mfma_f32_16x16x32_bf16 v[88:91], a[80:83], v[136:139], v[88:91]
    s_add_u32 m0, s67, 8192
    s_add_u32 s69, s68, 110592
    buffer_load_dwordx4 v4, s[36:39], s69 offen offset:0 lds
    v_mfma_f32_16x16x32_bf16 v[92:95], a[84:87], v[136:139], v[92:95]
    ds_read_b128 v[136:139], v14 offset:8192
    ds_read_b128 v[232:235], v45 offset:48
    v_mfma_f32_16x16x32_bf16 v[96:99], a[80:83], v[140:143], v[96:99]
    s_add_u32 m0, s67, 8192
    s_nop 0
    buffer_load_dwordx4 v4, s[36:39], s69 offen offset:1024 lds
    v_mfma_f32_16x16x32_bf16 v[100:103], a[84:87], v[140:143], v[100:103]
    ds_read_b128 v[140:143], v14 offset:9216
    s_waitcnt lgkmcnt(10)
    v_mfma_f32_16x16x32_bf16 v[104:107], a[80:83], v[144:147], v[104:107]
    v_mfma_f32_16x16x32_bf16 v[108:111], a[84:87], v[144:147], v[108:111]
    ds_read_b128 v[144:147], v14 offset:10240
    v_mfma_f32_16x16x32_bf16 v[112:115], a[80:83], v[204:207], v[112:115]
    s_add_u32 m0, s67, 8192
    s_nop 0
    buffer_load_dwordx4 v4, s[36:39], s69 offen offset:2048 lds
    v_mfma_f32_16x16x32_bf16 v[116:119], a[84:87], v[204:207], v[116:119]
    ds_read_b128 v[204:207], v14 offset:11264
    v_mfma_f32_16x16x32_bf16 v[120:123], a[80:83], v[208:211], v[120:123]
    v_mfma_f32_16x16x32_bf16 v[124:127], a[84:87], v[208:211], v[124:127]
    ds_read_b128 v[208:211], v14 offset:12288
    s_waitcnt lgkmcnt(9)
    v_mfma_f32_16x16x32_bf16 v[88:91], a[88:91], v[212:215], v[88:91]
    s_add_u32 m0, s67, 8192
    s_nop 0
    buffer_load_dwordx4 v4, s[36:39], s69 offen offset:3072 lds
    v_mfma_f32_16x16x32_bf16 v[92:95], a[92:95], v[212:215], v[92:95]
    ds_read_b128 v[212:215], v14 offset:13312
    s_waitcnt lgkmcnt(5)
    v_mul_f32 v172, 0xbacccccd, v216
    v_mul_f32 v217, 0x3acccccd, v217
    v_fma_f32 v217, -v172, v172, v217
    v_mfma_f32_16x16x32_bf16 v[96:99], a[88:91], v[128:131], v[96:99]
    v_max_f32 v217, 0, v217
    v_add_f32 v217, 0x3727c5ac, v217
    v_mfma_f32_16x16x32_bf16 v[100:103], a[92:95], v[128:131], v[100:103]
    ds_read_b128 v[128:131], v14 offset:14336
    s_waitcnt lgkmcnt(5)
    v_mfma_f32_16x16x32_bf16 v[104:107], a[88:91], v[132:135], v[104:107]
    v_rsq_f32 v173, v217
    v_mfma_f32_16x16x32_bf16 v[108:111], a[92:95], v[132:135], v[108:111]
    ds_read_b128 v[132:135], v14 offset:15360
    v_mul_f32 v176, s70, v173
    v_mfma_f32_16x16x32_bf16 v[112:115], a[88:91], v[136:139], v[112:115]
    v_mul_f32 v178, 0xbacccccd, v220
    v_mul_f32 v221, 0x3acccccd, v221
    v_mfma_f32_16x16x32_bf16 v[116:119], a[92:95], v[136:139], v[116:119]
    ds_read_b128 v[136:139], v14 offset:16384
    ds_read_b64_tr_b16 a[160:161], v240 offset:0
    v_mfma_f32_16x16x32_bf16 v[120:123], a[88:91], v[140:143], v[120:123]
    v_fma_f32 v221, -v178, v178, v221
    v_max_f32 v221, 0, v221
    v_mfma_f32_16x16x32_bf16 v[124:127], a[92:95], v[140:143], v[124:127]
    ds_read_b128 v[140:143], v14 offset:17408
    s_add_u32 m0, s67, 12288
    s_add_u32 s69, s68, 114688
    buffer_load_dwordx4 v4, s[36:39], s69 offen offset:0 lds
    s_waitcnt lgkmcnt(7)
    v_mfma_f32_16x16x32_bf16 v[88:91], a[96:99], v[144:147], v[88:91]
    ds_read_b64_tr_b16 a[164:165], v240 offset:8
    v_add_f32 v221, 0x3727c5ac, v221
    v_mfma_f32_16x16x32_bf16 v[92:95], a[100:103], v[144:147], v[92:95]
    ds_read_b128 v[144:147], v14 offset:18432
    ds_read_b64_tr_b16 a[168:169], v240 offset:16
    v_mfma_f32_16x16x32_bf16 v[96:99], a[96:99], v[204:207], v[96:99]
    v_rsq_f32 v186, v221
    v_mfma_f32_16x16x32_bf16 v[100:103], a[100:103], v[204:207], v[100:103]
    ds_read_b128 v[204:207], v14 offset:19456
    s_waitcnt lgkmcnt(8)
    v_mfma_f32_16x16x32_bf16 v[104:107], a[96:99], v[208:211], v[104:107]
    ds_read_b64_tr_b16 a[172:173], v240 offset:24
    v_mul_f32 v194, s70, v186
    v_mfma_f32_16x16x32_bf16 v[108:111], a[100:103], v[208:211], v[108:111]
    ds_read_b128 v[208:211], v14 offset:20480
    v_mul_f32 v179, 0xbacccccd, v224
    v_mfma_f32_16x16x32_bf16 v[112:115], a[96:99], v[212:215], v[112:115]
    ds_read_b64_tr_b16 a[176:177], v240 offset:32
    v_mul_f32 v225, 0x3acccccd, v225
    v_mfma_f32_16x16x32_bf16 v[116:119], a[100:103], v[212:215], v[116:119]
    ds_read_b128 v[212:215], v14 offset:21504
    v_fma_f32 v225, -v179, v179, v225
    v_mfma_f32_16x16x32_bf16 v[120:123], a[96:99], v[128:131], v[120:123]
    ds_read_b64_tr_b16 a[162:163], v241 offset:0
    v_max_f32 v225, 0, v225
    v_mfma_f32_16x16x32_bf16 v[124:127], a[100:103], v[128:131], v[124:127]
    s_waitcnt vmcnt(26)
    s_barrier
    ds_read_b128 v[128:131], v14 offset:22528
    s_waitcnt lgkmcnt(12)
    v_mfma_f32_16x16x32_bf16 v[88:91], a[104:107], v[132:135], v[88:91]
    v_add_f32 v225, 0x3727c5ac, v225
    v_mfma_f32_16x16x32_bf16 v[92:95], a[108:111], v[132:135], v[92:95]
    ds_read_b128 v[132:135], v14 offset:23552
    ds_read_b64_tr_b16 a[166:167], v241 offset:8
    v_mfma_f32_16x16x32_bf16 v[96:99], a[104:107], v[136:139], v[96:99]
    v_rsq_f32 v187, v225
    v_mfma_f32_16x16x32_bf16 v[100:103], a[108:111], v[136:139], v[100:103]
    ds_read_b128 v[136:139], v14 offset:24576
    s_waitcnt lgkmcnt(9)
    v_mfma_f32_16x16x32_bf16 v[104:107], a[104:107], v[140:143], v[104:107]
    ds_read_b64_tr_b16 a[170:171], v241 offset:16
    v_mul_f32 v195, s70, v187
    v_mfma_f32_16x16x32_bf16 v[108:111], a[108:111], v[140:143], v[108:111]
    ds_read_b128 v[140:143], v14 offset:25600
    v_mul_f32 v180, 0xbacccccd, v228
    v_mfma_f32_16x16x32_bf16 v[112:115], a[104:107], v[144:147], v[112:115]
    ds_read_b64_tr_b16 a[174:175], v241 offset:24
    v_mul_f32 v229, 0x3acccccd, v229
    v_mfma_f32_16x16x32_bf16 v[116:119], a[108:111], v[144:147], v[116:119]
    ds_read_b128 v[144:147], v14 offset:26624
    v_fma_f32 v229, -v180, v180, v229
    v_mfma_f32_16x16x32_bf16 v[120:123], a[104:107], v[204:207], v[120:123]
    ds_read_b64_tr_b16 a[178:179], v241 offset:32
    v_max_f32 v229, 0, v229
    v_mfma_f32_16x16x32_bf16 v[124:127], a[108:111], v[204:207], v[124:127]
    ds_read_b128 v[204:207], v14 offset:27648
    s_waitcnt lgkmcnt(11)
    v_mfma_f32_16x16x32_bf16 v[88:91], a[112:115], v[208:211], v[88:91]
    ds_read_b64_tr_b16 a[180:181], v242 offset:0
    v_add_f32 v229, 0x3727c5ac, v229
    v_mfma_f32_16x16x32_bf16 v[92:95], a[116:119], v[208:211], v[92:95]
    ds_read_b128 v[208:211], v14 offset:28672
    ds_read_b64_tr_b16 a[184:185], v242 offset:8
    v_mfma_f32_16x16x32_bf16 v[96:99], a[112:115], v[212:215], v[96:99]
    v_rsq_f32 v188, v229
    v_mfma_f32_16x16x32_bf16 v[100:103], a[116:119], v[212:215], v[100:103]
    ds_read_b128 v[212:215], v14 offset:29696
    s_waitcnt lgkmcnt(10)
    v_mfma_f32_16x16x32_bf16 v[104:107], a[112:115], v[128:131], v[104:107]
    v_mul_f32 v196, s70, v188
    v_mul_f32 v181, 0xbacccccd, v232
    v_mfma_f32_16x16x32_bf16 v[108:111], a[116:119], v[128:131], v[108:111]
    ds_read_b128 v[128:131], v14 offset:30720
    ds_read_b64_tr_b16 a[188:189], v242 offset:16
    v_mfma_f32_16x16x32_bf16 v[112:115], a[112:115], v[132:135], v[112:115]
    v_mul_f32 v233, 0x3acccccd, v233
    v_fma_f32 v233, -v181, v181, v233
    v_mfma_f32_16x16x32_bf16 v[116:119], a[116:119], v[132:135], v[116:119]
    ds_read_b128 v[132:135], v14 offset:31744
    ds_read_b64_tr_b16 a[192:193], v242 offset:24
    v_mfma_f32_16x16x32_bf16 v[120:123], a[112:115], v[136:139], v[120:123]
    v_max_f32 v233, 0, v233
    v_add_f32 v233, 0x3727c5ac, v233
    v_mfma_f32_16x16x32_bf16 v[124:127], a[116:119], v[136:139], v[124:127]
    ds_read_b128 v[136:139], v14 offset:32768
    s_waitcnt lgkmcnt(11)
    v_mfma_f32_16x16x32_bf16 v[88:91], a[120:123], v[140:143], v[88:91]
    ds_read_b64_tr_b16 a[196:197], v242 offset:32
    ds_read_b64_tr_b16 a[182:183], v243 offset:0
    v_mfma_f32_16x16x32_bf16 v[92:95], a[124:127], v[140:143], v[92:95]
    ds_read_b128 v[140:143], v14 offset:33792
    ds_read_b64_tr_b16 a[186:187], v243 offset:8
    v_mfma_f32_16x16x32_bf16 v[96:99], a[120:123], v[144:147], v[96:99]
    v_rsq_f32 v189, v233
    v_mfma_f32_16x16x32_bf16 v[100:103], a[124:127], v[144:147], v[100:103]
    s_waitcnt vmcnt(24)
    s_barrier
    ds_read_b128 v[144:147], v14 offset:34816
    s_waitcnt lgkmcnt(10)
    v_mfma_f32_16x16x32_bf16 v[104:107], a[120:123], v[204:207], v[104:107]
    v_mul_f32 v197, s70, v189
    v_mul_f32 v174, 0xbacccccd, v218
    v_mfma_f32_16x16x32_bf16 v[108:111], a[124:127], v[204:207], v[108:111]
    ds_read_b128 v[204:207], v14 offset:35840
    v_mul_f32 v219, 0x3acccccd, v219
    v_mfma_f32_16x16x32_bf16 v[112:115], a[120:123], v[208:211], v[112:115]
    ds_read_b64_tr_b16 a[190:191], v243 offset:16
    v_fma_f32 v219, -v174, v174, v219
    v_mfma_f32_16x16x32_bf16 v[116:119], a[124:127], v[208:211], v[116:119]
    ds_read_b128 v[208:211], v14 offset:36864
    v_max_f32 v219, 0, v219
    v_mfma_f32_16x16x32_bf16 v[120:123], a[120:123], v[212:215], v[120:123]
    buffer_load_dwordx4 a[248:251], v5, s[36:39], s57 offen offset:0
    v_mfma_f32_16x16x32_bf16 v[124:127], a[124:127], v[212:215], v[124:127]
    ds_read_b128 v[212:215], v14 offset:37888
    s_waitcnt lgkmcnt(11)
    v_mfma_f32_16x16x32_bf16 v[88:91], a[128:131], v[128:131], v[88:91]
    ds_read_b64_tr_b16 a[194:195], v243 offset:24
    v_add_f32 v219, 0x3727c5ac, v219
    v_mfma_f32_16x16x32_bf16 v[92:95], a[132:135], v[128:131], v[92:95]
    ds_read_b128 v[128:131], v14 offset:38912
    v_rsq_f32 v175, v219
    v_mfma_f32_16x16x32_bf16 v[96:99], a[128:131], v[132:135], v[96:99]
    ds_read_b64_tr_b16 a[198:199], v243 offset:32
    v_mul_f32 v177, s70, v175
    v_mfma_f32_16x16x32_bf16 v[100:103], a[132:135], v[132:135], v[100:103]
    ds_read_b128 v[132:135], v14 offset:39936
    s_waitcnt lgkmcnt(8)
    v_mfma_f32_16x16x32_bf16 v[104:107], a[128:131], v[136:139], v[104:107]
    buffer_load_dwordx4 a[252:255], v5, s[36:39], s57 offen offset:1024
    v_mfma_f32_16x16x32_bf16 v[108:111], a[132:135], v[136:139], v[108:111]
    ds_read_b128 v[136:139], v14 offset:40960
    ds_read_b64_tr_b16 a[200:201], v244 offset:0
    v_mul_f32 v182, 0xbacccccd, v222
    v_mfma_f32_16x16x32_bf16 v[112:115], a[128:131], v[140:143], v[112:115]
    v_mul_f32 v223, 0x3acccccd, v223
    v_fma_f32 v223, -v182, v182, v223
    v_mfma_f32_16x16x32_bf16 v[116:119], a[132:135], v[140:143], v[116:119]
    ds_read_b128 v[140:143], v14 offset:41984
    ds_read_b64_tr_b16 a[204:205], v244 offset:8
    v_mfma_f32_16x16x32_bf16 v[120:123], a[128:131], v[144:147], v[120:123]
    buffer_load_dwordx4 a[248:251], v5, s[36:39], s56 offen offset:0
    v_max_f32 v223, 0, v223
    v_mfma_f32_16x16x32_bf16 v[124:127], a[132:135], v[144:147], v[124:127]
    s_waitcnt vmcnt(25)
    s_waitcnt vmcnt(16)
    s_barrier
    s_cmp_eq_u32 s42, 0
    s_nop 3
    s_cbranch_scc1 OUT5
RET6:
    ds_read_b128 v[144:147], v14 offset:43008
    s_waitcnt lgkmcnt(10)
    v_mfma_f32_16x16x32_bf16 v[88:91], a[136:139], v[204:207], v[88:91]
    ds_read_b64_tr_b16 a[208:209], v244 offset:16
    v_add_f32 v223, 0x3727c5ac, v223
    v_mfma_f32_16x16x32_bf16 v[92:95], a[140:143], v[204:207], v[92:95]
    ds_read_b128 v[204:207], v14 offset:44032
    ds_read_b64_tr_b16 a[212:213], v244 offset:24
    v_rsq_f32 v190, v223
    v_mfma_f32_16x16x32_bf16 v[96:99], a[136:139], v[208:211], v[96:99]
    buffer_load_dwordx4 a[252:255], v5, s[36:39], s56 offen offset:1024
    v_mfma_f32_16x16x32_bf16 v[100:103], a[140:143], v[208:211], v[100:103]
    ds_read_b128 v[208:211], v14 offset:45056
    v_mul_f32 v198, s70, v190
    s_waitcnt lgkmcnt(9)
    v_mfma_f32_16x16x32_bf16 v[104:107], a[136:139], v[212:215], v[104:107]
    ds_read_b64_tr_b16 a[216:217], v244 offset:32
    v_mul_f32 v183, 0xbacccccd, v226
    v_mfma_f32_16x16x32_bf16 v[108:111], a[140:143], v[212:215], v[108:111]
    ds_read_b128 v[212:215], v14 offset:46080
    ds_read_b64_tr_b16 a[202:203], v245 offset:0
    v_mul_f32 v227, 0x3acccccd, v227
    v_mfma_f32_16x16x32_bf16 v[112:115], a[136:139], v[128:131], v[112:115]
    s_mov_b32 exec_hi, 0
    buffer_load_dwordx2 a[248:249], v6, s[36:39], s57 offen offset:0
    buffer_load_dwordx2 a[250:251], v6, s[36:39], s57 offen offset:1024
    buffer_load_dwordx2 a[248:249], v6, s[36:39], s56 offen offset:0
    buffer_load_dwordx2 a[250:251], v6, s[36:39], s56 offen offset:1024
    s_mov_b64 exec, -1
    v_mfma_f32_16x16x32_bf16 v[116:119], a[140:143], v[128:131], v[116:119]
    ds_read_b128 v[128:131], v14 offset:47104
    v_fma_f32 v227, -v183, v183, v227
    v_mfma_f32_16x16x32_bf16 v[120:123], a[136:139], v[132:135], v[120:123]
    ds_read_b64_tr_b16 a[206:207], v245 offset:8
    v_max_f32 v227, 0, v227
    v_mfma_f32_16x16x32_bf16 v[124:127], a[140:143], v[132:135], v[124:127]
    ds_read_b128 v[132:135], v14 offset:48128
    ds_read_b64_tr_b16 a[210:211], v245 offset:16
    ds_read_b64_tr_b16 a[214:215], v245 offset:24
    ds_read_b64_tr_b16 a[218:219], v245 offset:32
    v_add_f32 v227, 0x3727c5ac, v227
    s_waitcnt lgkmcnt(15)
    v_mfma_f32_16x16x32_bf16 v[88:91], a[144:147], v[136:139], v[88:91]
    v_rsq_f32 v191, v227
    v_mfma_f32_16x16x32_bf16 v[92:95], a[148:151], v[136:139], v[92:95]
    ds_read_b128 v[136:139], v14 offset:49152
    v_mul_f32 v199, s70, v191
    v_mfma_f32_16x16x32_bf16 v[96:99], a[144:147], v[140:143], v[96:99]
    v_mul_f32 v184, 0xbacccccd, v230
    v_mul_f32 v231, 0x3acccccd, v231
    v_mfma_f32_16x16x32_bf16 v[100:103], a[148:151], v[140:143], v[100:103]
    ds_read_b128 v[140:143], v14 offset:50176
    s_waitcnt lgkmcnt(11)
    v_mfma_f32_16x16x32_bf16 v[104:107], a[144:147], v[144:147], v[104:107]
    v_fma_f32 v231, -v184, v184, v231
    v_max_f32 v231, 0, v231
    v_mfma_f32_16x16x32_bf16 v[108:111], a[148:151], v[144:147], v[108:111]
    v_add_f32 v231, 0x3727c5ac, v231
    v_mfma_f32_16x16x32_bf16 v[112:115], a[144:147], v[204:207], v[112:115]
    v_rsq_f32 v192, v231
    v_mfma_f32_16x16x32_bf16 v[116:119], a[148:151], v[204:207], v[116:119]
    v_mul_f32 v200, s70, v192
    v_mul_f32 v185, 0xbacccccd, v234
    v_mfma_f32_16x16x32_bf16 v[120:123], a[144:147], v[208:211], v[120:123]
    v_mul_f32 v235, 0x3acccccd, v235
    v_fma_f32 v235, -v185, v185, v235
    v_mfma_f32_16x16x32_bf16 v[124:127], a[148:151], v[208:211], v[124:127]
    s_waitcnt lgkmcnt(7)
    v_mfma_f32_16x16x32_bf16 v[88:91], a[152:155], v[212:215], v[88:91]
    v_max_f32 v235, 0, v235
    v_mfma_f32_16x16x32_bf16 v[92:95], a[156:159], v[212:215], v[92:95]
    v_add_f32 v235, 0x3727c5ac, v235
    v_mfma_f32_16x16x32_bf16 v[96:99], a[152:155], v[128:131], v[96:99]
    buffer_load_dword a248, v7, s[36:39], s56 offen
    v_mfma_f32_16x16x32_bf16 v[100:103], a[156:159], v[128:131], v[100:103]
    s_waitcnt lgkmcnt(0)
    v_mfma_f32_16x16x32_bf16 v[104:107], a[152:155], v[132:135], v[104:107]
    v_rsq_f32 v193, v235
    v_mfma_f32_16x16x32_bf16 v[108:111], a[156:159], v[132:135], v[108:111]
    v_mul_f32 v201, s70, v193
    v_mfma_f32_16x16x32_bf16 v[112:115], a[152:155], v[136:139], v[112:115]
    v_mfma_f32_16x16x32_bf16 v[116:119], a[156:159], v[136:139], v[116:119]
    v_mfma_f32_16x16x32_bf16 v[120:123], a[152:155], v[140:143], v[120:123]
    v_mfma_f32_16x16x32_bf16 v[124:127], a[156:159], v[140:143], v[124:127]
    s_nop 7
    s_branch KVE
LOOP:
    v_add_u32 v13, s43, v4
    v_add_u32 v14, s44, v4
    ds_read_b128 v[128:131], v13 offset:0
    ds_read_b128 v[132:135], v13 offset:1024
    ds_read_b128 v[136:139], v13 offset:2048
    ds_read_b128 v[140:143], v13 offset:3072
    ds_read_b128 v[144:147], v13 offset:4096
    ds_read_b128 v[204:207], v13 offset:5120
    ds_read_b128 v[208:211], v13 offset:6144
    ds_read_b128 v[212:215], v13 offset:7168
    s_mov_b32 s55, 131072
PXA:
    buffer_load_dword v61, v9, s[36:39], 0 offen sc1
    s_waitcnt vmcnt(0)
    v_cmp_le_u32 vcc, s61, v61
    s_cmp_eq_u64 vcc, -1
    s_nop 3
    s_cbranch_scc1 PXA_done
    s_sub_u32 s55, s55, 1
    s_cmp_eq_u32 s55, 0
    s_cbranch_scc1 ABORT
    s_branch PXA
PXA_done:
    s_add_u32 s67, s56, 0
    buffer_load_dwordx4 a[0:3], v4, s[36:39], s67 offen offset:0 sc1
    buffer_load_dwordx4 a[4:7], v4, s[36:39], s67 offen offset:1024 sc1
    buffer_load_dwordx4 a[8:11], v4, s[36:39], s67 offen offset:2048 sc1
    buffer_load_dwordx4 a[12:15], v4, s[36:39], s67 offen offset:3072 sc1
    s_add_u32 s67, s56, 4096
    buffer_load_dwordx4 a[16:19], v4, s[36:39], s67 offen offset:0 sc1
    buffer_load_dwordx4 a[20:23], v4, s[36:39], s67 offen offset:1024 sc1
    buffer_load_dwordx4 a[24:27], v4, s[36:39], s67 offen offset:2048 sc1
    buffer_load_dwordx4 a[28:31], v4, s[36:39], s67 offen offset:3072 sc1
    s_waitcnt vmcnt(6) lgkmcnt(6)
    v_mfma_f32_16x16x32_bf16 v[88:91], a[0:3], v[128:131], 0
    s_add_u32 s67, s56, 8192
    v_mfma_f32_16x16x32_bf16 v[92:95], a[4:7], v[128:131], 0
    ds_read_b128 v[128:131], v13 offset:8192
    v_mfma_f32_16x16x32_bf16 v[96:99], a[0:3], v[132:135], 0
    buffer_load_dwordx4 a[32:35], v4, s[36:39], s67 offen offset:0 sc1
    v_mfma_f32_16x16x32_bf16 v[100:103], a[4:7], v[132:135], 0
    ds_read_b128 v[132:135], v13 offset:9216
    s_waitcnt lgkmcnt(5)
    v_mfma_f32_16x16x32_bf16 v[104:107], a[0:3], v[136:139], 0
    buffer_load_dwordx4 a[36:39], v4, s[36:39], s67 offen offset:1024 sc1
    v_mfma_f32_16x16x32_bf16 v[108:111], a[4:7], v[136:139], 0
    ds_read_b128 v[136:139], v13 offset:10240
    v_mfma_f32_16x16x32_bf16 v[112:115], a[0:3], v[140:143], 0
    v_mfma_f32_16x16x32_bf16 v[116:119], a[4:7], v[140:143], 0
    ds_read_b128 v[140:143], v13 offset:11264
    v_mfma_f32_16x16x32_bf16 v[120:123], a[0:3], v[144:147], 0
    buffer_load_dwordx4 v[216:219], v8, s[36:39], s56 offen offset:0 sc1
    v_mfma_f32_16x16x32_bf16 v[124:127], a[4:7], v[144:147], 0
    ds_read_b128 v[144:147], v13 offset:12288
    s_waitcnt vmcnt(7) lgkmcnt(6)
    v_mfma_f32_16x16x32_bf16 v[88:91], a[8:11], v[204:207], v[88:91]
    v_mfma_f32_16x16x32_bf16 v[92:95], a[12:15], v[204:207], v[92:95]
    ds_read_b128 v[204:207], v13 offset:13312
    v_mfma_f32_16x16x32_bf16 v[96:99], a[8:11], v[208:211], v[96:99]
    buffer_load_dwordx4 a[40:43], v4, s[36:39], s67 offen offset:2048 sc1
    v_mfma_f32_16x16x32_bf16 v[100:103], a[12:15], v[208:211], v[100:103]
    ds_read_b128 v[208:211], v13 offset:14336
    s_waitcnt lgkmcnt(5)
    v_mfma_f32_16x16x32_bf16 v[104:107], a[8:11], v[212:215], v[104:107]
    buffer_load_dwordx4 a[44:47], v4, s[36:39], s67 offen offset:3072 sc1
    v_mfma_f32_16x16x32_bf16 v[108:111], a[12:15], v[212:215], v[108:111]
    ds_read_b128 v[212:215], v13 offset:15360
    v_mfma_f32_16x16x32_bf16 v[112:115], a[8:11], v[128:131], v[112:115]
    v_mfma_f32_16x16x32_bf16 v[116:119], a[12:15], v[128:131], v[116:119]
    ds_read_b128 v[128:131], v13 offset:16384
    v_mfma_f32_16x16x32_bf16 v[120:123], a[8:11], v[132:135], v[120:123]
    buffer_load_dwordx4 v[220:223], v8, s[36:39], s56 offen offset:1024 sc1
    v_mfma_f32_16x16x32_bf16 v[124:127], a[12:15], v[132:135], v[124:127]
    ds_read_b128 v[132:135], v13 offset:17408
    s_waitcnt vmcnt(8) lgkmcnt(6)
    v_mfma_f32_16x16x32_bf16 v[88:91], a[16:19], v[136:139], v[88:91]
    v_mfma_f32_16x16x32_bf16 v[92:95], a[20:23], v[136:139], v[92:95]
    ds_read_b128 v[136:139], v13 offset:18432
    s_add_u32 s67, s56, 12288
    v_mfma_f32_16x16x32_bf16 v[96:99], a[16:19], v[140:143], v[96:99]
    v_mfma_f32_16x16x32_bf16 v[100:103], a[20:23], v[140:143], v[100:103]
    ds_read_b128 v[140:143], v13 offset:19456
    s_waitcnt lgkmcnt(5)
    v_mfma_f32_16x16x32_bf16 v[104:107], a[16:19], v[144:147], v[104:107]
    buffer_load_dwordx4 a[48:51], v4, s[36:39], s67 offen offset:0 sc1
    v_mfma_f32_16x16x32_bf16 v[108:111], a[20:23], v[144:147], v[108:111]
    ds_read_b128 v[144:147], v13 offset:20480
    v_mfma_f32_16x16x32_bf16 v[112:115], a[16:19], v[204:207], v[112:115]
    buffer_load_dwordx4 a[52:55], v4, s[36:39], s67 offen offset:1024 sc1
    v_mfma_f32_16x16x32_bf16 v[116:119], a[20:23], v[204:207], v[116:119]
    ds_read_b128 v[204:207], v13 offset:21504
    v_mfma_f32_16x16x32_bf16 v[120:123], a[16:19], v[208:211], v[120:123]
    v_mfma_f32_16x16x32_bf16 v[124:127], a[20:23], v[208:211], v[124:127]
    ds_read_b128 v[208:211], v13 offset:22528
    s_waitcnt vmcnt(8) lgkmcnt(6)
    v_mfma_f32_16x16x32_bf16 v[88:91], a[24:27], v[212:215], v[88:91]
    buffer_load_dwordx4 v[224:227], v8, s[36:39], s56 offen offset:2048 sc1
    v_mfma_f32_16x16x32_bf16 v[92:95], a[28:31], v[212:215], v[92:95]
    ds_read_b128 v[212:215], v13 offset:23552
    v_mfma_f32_16x16x32_bf16 v[96:99], a[24:27], v[128:131], v[96:99]
    v_mfma_f32_16x16x32_bf16 v[100:103], a[28:31], v[128:131], v[100:103]
    ds_read_b128 v[128:131], v13 offset:24576
    s_waitcnt lgkmcnt(5)
    v_mfma_f32_16x16x32_bf16 v[104:107], a[24:27], v[132:135], v[104:107]
    buffer_load_dwordx4 a[56:59], v4, s[36:39], s67 offen offset:2048 sc1
    v_mfma_f32_16x16x32_bf16 v[108:111], a[28:31], v[132:135], v[108:111]
    ds_read_b128 v[132:135], v13 offset:25600
    v_mfma_f32_16x16x32_bf16 v[112:115], a[24:27], v[136:139], v[112:115]
    buffer_load_dwordx4 a[60:63], v4, s[36:39], s67 offen offset:3072 sc1
    v_mfma_f32_16x16x32_bf16 v[116:119], a[28:31], v[136:139], v[116:119]
    ds_read_b128 v[136:139], v13 offset:26624
    v_mfma_f32_16x16x32_bf16 v[120:123], a[24:27], v[140:143], v[120:123]
    v_mfma_f32_16x16x32_bf16 v[124:127], a[28:31], v[140:143], v[124:127]
    ds_read_b128 v[140:143], v13 offset:27648
    s_waitcnt vmcnt(9) lgkmcnt(6)
    v_mfma_f32_16x16x32_bf16 v[88:91], a[32:35], v[144:147], v[88:91]
    buffer_load_dwordx4 v[228:231], v8, s[36:39], s56 offen offset:3072 sc1
    v_mfma_f32_16x16x32_bf16 v[92:95], a[36:39], v[144:147], v[92:95]
    ds_read_b128 v[144:147], v13 offset:28672
    v_mfma_f32_16x16x32_bf16 v[96:99], a[32:35], v[204:207], v[96:99]
    s_add_u32 s67, s56, 16384
    v_mfma_f32_16x16x32_bf16 v[100:103], a[36:39], v[204:207], v[100:103]
    ds_read_b128 v[204:207], v13 offset:29696
    s_waitcnt lgkmcnt(5)
    v_mfma_f32_16x16x32_bf16 v[104:107], a[32:35], v[208:211], v[104:107]
    buffer_load_dwordx4 a[64:67], v4, s[36:39], s67 offen offset:0 sc1
    v_mfma_f32_16x16x32_bf16 v[108:111], a[36:39], v[208:211], v[108:111]
    ds_read_b128 v[208:211], v13 offset:30720
    v_mfma_f32_16x16x32_bf16 v[112:115], a[32:35], v[212:215], v[112:115]
    v_mfma_f32_16x16x32_bf16 v[116:119], a[36:39], v[212:215], v[116:119]
    ds_read_b128 v[212:215], v13 offset:31744
    v_mfma_f32_16x16x32_bf16 v[120:123], a[32:35], v[128:131], v[120:123]
    buffer_load_dwordx4 a[68:71], v4, s[36:39], s67 offen offset:1024 sc1
    v_mfma_f32_16x16x32_bf16 v[124:127], a[36:39], v[128:131], v[124:127]
    ds_read_b128 v[128:131], v13 offset:32768
    s_waitcnt vmcnt(9) lgkmcnt(6)
    v_mfma_f32_16x16x32_bf16 v[88:91], a[40:43], v[132:135], v[88:91]
    s_waitcnt vmcnt(2)
    v_add_f32 v216, v216, v220
    v_mfma_f32_16x16x32_bf16 v[92:95], a[44:47], v[132:135], v[92:95]
    ds_read_b128 v[132:135], v13 offset:33792
    v_add_f32 v224, v224, v228
    v_mfma_f32_16x16x32_bf16 v[96:99], a[40:43], v[136:139], v[96:99]
    buffer_load_dwordx4 a[72:75], v4, s[36:39], s67 offen offset:2048 sc1
    v_mfma_f32_16x16x32_bf16 v[100:103], a[44:47], v[136:139], v[100:103]
    ds_read_b128 v[136:139], v13 offset:34816
    s_waitcnt lgkmcnt(5)
    v_mfma_f32_16x16x32_bf16 v[104:107], a[40:43], v[140:143], v[104:107]
    v_add_f32 v217, v217, v221
    v_add_f32 v225, v225, v229
    v_mfma_f32_16x16x32_bf16 v[108:111], a[44:47], v[140:143], v[108:111]
    ds_read_b128 v[140:143], v13 offset:35840
    v_add_f32 v218, v218, v222
    v_mfma_f32_16x16x32_bf16 v[112:115], a[40:43], v[144:147], v[112:115]
    buffer_load_dwordx4 a[76:79], v4, s[36:39], s67 offen offset:3072 sc1
    v_mfma_f32_16x16x32_bf16 v[116:119], a[44:47], v[144:147], v[116:119]
    ds_read_b128 v[144:147], v13 offset:36864
    v_add_f32 v226, v226, v230
    v_mfma_f32_16x16x32_bf16 v[120:123], a[40:43], v[204:207], v[120:123]
    v_add_f32 v219, v219, v223
    s_add_u32 s67, s56, 20480
    v_mfma_f32_16x16x32_bf16 v[124:127], a[44:47], v[204:207], v[124:127]
    ds_read_b128 v[204:207], v13 offset:37888
    s_waitcnt lgkmcnt(6)
    v_mfma_f32_16x16x32_bf16 v[88:91], a[48:51], v[208:211], v[88:91]
    v_add_f32 v227, v227, v231
    v_add_f32 v216, v216, v224
    v_mfma_f32_16x16x32_bf16 v[92:95], a[52:55], v[208:211], v[92:95]
    ds_read_b128 v[208:211], v13 offset:38912
    v_add_f32 v217, v217, v225
    v_mfma_f32_16x16x32_bf16 v[96:99], a[48:51], v[212:215], v[96:99]
    buffer_load_dwordx4 a[80:83], v4, s[36:39], s67 offen offset:0 sc1
    v_mfma_f32_16x16x32_bf16 v[100:103], a[52:55], v[212:215], v[100:103]
    ds_read_b128 v[212:215], v13 offset:39936
    s_waitcnt lgkmcnt(5)
    v_mfma_f32_16x16x32_bf16 v[104:107], a[48:51], v[128:131], v[104:107]
    buffer_load_dwordx4 a[84:87], v4, s[36:39], s67 offen offset:1024 sc1
    v_mfma_f32_16x16x32_bf16 v[108:111], a[52:55], v[128:131], v[108:111]
    ds_read_b128 v[128:131], v13 offset:40960
    v_add_f32 v218, v218, v226
    v_mfma_f32_16x16x32_bf16 v[112:115], a[48:51], v[132:135], v[112:115]
    v_add_f32 v219, v219, v227
    v_permlane32_swap_b32 v216, v217
    v_mfma_f32_16x16x32_bf16 v[116:119], a[52:55], v[132:135], v[116:119]
    ds_read_b128 v[132:135], v13 offset:41984
    v_permlane32_swap_b32 v218, v219
    v_mfma_f32_16x16x32_bf16 v[120:123], a[48:51], v[136:139], v[120:123]
    buffer_load_dwordx4 a[88:91], v4, s[36:39], s67 offen offset:2048 sc1
    v_mfma_f32_16x16x32_bf16 v[124:127], a[52:55], v[136:139], v[124:127]
    ds_read_b128 v[136:139], v13 offset:43008
    s_waitcnt lgkmcnt(6)
    v_mfma_f32_16x16x32_bf16 v[88:91], a[56:59], v[140:143], v[88:91]
    v_add_f32 v216, v216, v217
    v_add_f32 v218, v218, v219
    v_mfma_f32_16x16x32_bf16 v[92:95], a[60:63], v[140:143], v[92:95]
    ds_read_b128 v[140:143], v13 offset:44032
    v_permlane16_swap_b32 v216, v218
    v_mfma_f32_16x16x32_bf16 v[96:99], a[56:59], v[144:147], v[96:99]
    buffer_load_dwordx4 a[92:95], v4, s[36:39], s67 offen offset:3072 sc1
    v_mfma_f32_16x16x32_bf16 v[100:103], a[60:63], v[144:147], v[100:103]
    ds_read_b128 v[144:147], v13 offset:45056
    s_waitcnt lgkmcnt(5)
    v_mfma_f32_16x16x32_bf16 v[104:107], a[56:59], v[204:207], v[104:107]
    s_add_u32 s67, s56, 24576
    v_add_f32 v216, v216, v218
    v_mfma_f32_16x16x32_bf16 v[108:111], a[60:63], v[204:207], v[108:111]
    ds_read_b128 v[204:207], v13 offset:46080
    v_mfma_f32_16x16x32_bf16 v[112:115], a[56:59], v[208:211], v[112:115]
    ds_write_b32 v43, v216
    v_mfma_f32_16x16x32_bf16 v[116:119], a[60:63], v[208:211], v[116:119]
    ds_read_b128 v[208:211], v13 offset:47104
    v_mfma_f32_16x16x32_bf16 v[120:123], a[56:59], v[212:215], v[120:123]
    buffer_load_dwordx4 a[96:99], v4, s[36:39], s67 offen offset:0 sc1
    v_mfma_f32_16x16x32_bf16 v[124:127], a[60:63], v[212:215], v[124:127]
    ds_read_b128 v[212:215], v13 offset:48128
    s_waitcnt vmcnt(7) lgkmcnt(7)
    v_mfma_f32_16x16x32_bf16 v[88:91], a[64:67], v[128:131], v[88:91]
    buffer_load_dwordx4 a[100:103], v4, s[36:39], s67 offen offset:1024 sc1
    v_mfma_f32_16x16x32_bf16 v[92:95], a[68:71], v[128:131], v[92:95]
    ds_read_b128 v[128:131], v13 offset:49152
    ds_read_b128 v[216:219], v44
    v_mfma_f32_16x16x32_bf16 v[96:99], a[64:67], v[132:135], v[96:99]
    ds_read_b128 v[220:223], v45 offset:0
    ds_read_b128 v[224:227], v45 offset:16
    v_mfma_f32_16x16x32_bf16 v[100:103], a[68:71], v[132:135], v[100:103]
    ds_read_b128 v[132:135], v13 offset:50176
    s_waitcnt lgkmcnt(9)
    v_mfma_f32_16x16x32_bf16 v[104:107], a[64:67], v[136:139], v[104:107]
    buffer_load_dwordx4 a[104:107], v4, s[36:39], s67 offen offset:2048 sc1
    v_mfma_f32_16x16x32_bf16 v[108:111], a[68:71], v[136:139], v[108:111]
    ds_read_b128 v[136:139], v14 offset:0
    ds_read_b128 v[228:231], v45 offset:32
    v_mfma_f32_16x16x32_bf16 v[112:115], a[64:67], v[140:143], v[112:115]
    ds_read_b128 v[232:235], v45 offset:48
    v_mfma_f32_16x16x32_bf16 v[116:119], a[68:71], v[140:143], v[116:119]
    ds_read_b128 v[140:143], v14 offset:1024
    v_mfma_f32_16x16x32_bf16 v[120:123], a[64:67], v[144:147], v[120:123]
    buffer_load_dwordx4 a[108:111], v4, s[36:39], s67 offen offset:3072 sc1
    v_mfma_f32_16x16x32_bf16 v[124:127], a[68:71], v[144:147], v[124:127]
    ds_read_b128 v[144:147], v14 offset:2048
    s_waitcnt vmcnt(8) lgkmcnt(11)
    v_mfma_f32_16x16x32_bf16 v[88:91], a[72:75], v[204:207], v[88:91]
    s_add_u32 s67, s56, 28672
    v_mfma_f32_16x16x32_bf16 v[92:95], a[76:79], v[204:207], v[92:95]
    ds_read_b128 v[204:207], v14 offset:3072
    v_mfma_f32_16x16x32_bf16 v[96:99], a[72:75], v[208:211], v[96:99]
    buffer_load_dwordx4 a[112:115], v4, s[36:39], s67 offen offset:0 sc1
    v_mfma_f32_16x16x32_bf16 v[100:103], a[76:79], v[208:211], v[100:103]
    ds_read_b128 v[208:211], v14 offset:4096
    s_waitcnt lgkmcnt(7)
    v_mfma_f32_16x16x32_bf16 v[104:107], a[72:75], v[212:215], v[104:107]
    buffer_load_dwordx4 a[116:119], v4, s[36:39], s67 offen offset:1024 sc1
    v_mfma_f32_16x16x32_bf16 v[108:111], a[76:79], v[212:215], v[108:111]
    ds_read_b128 v[212:215], v14 offset:5120
    v_mfma_f32_16x16x32_bf16 v[112:115], a[72:75], v[128:131], v[112:115]
    s_waitcnt lgkmcnt(5)
    v_mul_f32 v172, 0xbacccccd, v216
    v_mul_f32 v217, 0x3acccccd, v217
    v_mfma_f32_16x16x32_bf16 v[116:119], a[76:79], v[128:131], v[116:119]
    ds_read_b128 v[128:131], v14 offset:6144
    v_fma_f32 v217, -v172, v172, v217
    v_mfma_f32_16x16x32_bf16 v[120:123], a[72:75], v[132:135], v[120:123]
    v_max_f32 v217, 0, v217
    v_add_f32 v217, 0x3727c5ac, v217
    v_mfma_f32_16x16x32_bf16 v[124:127], a[76:79], v[132:135], v[124:127]
    ds_read_b128 v[132:135], v14 offset:7168
    s_waitcnt vmcnt(8)
    s_barrier
    s_waitcnt lgkmcnt(6)
    v_mfma_f32_16x16x32_bf16 v[88:91], a[80:83], v[136:139], v[88:91]
    v_rsq_f32 v173, v217
    v_mfma_f32_16x16x32_bf16 v[92:95], a[84:87], v[136:139], v[92:95]
    ds_read_b128 v[136:139], v14 offset:8192
    v_mul_f32 v176, s70, v173
    v_mfma_f32_16x16x32_bf16 v[96:99], a[80:83], v[140:143], v[96:99]
    buffer_load_dwordx4 a[120:123], v4, s[36:39], s67 offen offset:2048 sc1
    v_mfma_f32_16x16x32_bf16 v[100:103], a[84:87], v[140:143], v[100:103]
    ds_read_b128 v[140:143], v14 offset:9216
    s_waitcnt lgkmcnt(5)
    v_mfma_f32_16x16x32_bf16 v[104:107], a[80:83], v[144:147], v[104:107]
    v_mul_f32 v178, 0xbacccccd, v220
    v_mul_f32 v221, 0x3acccccd, v221
    v_mfma_f32_16x16x32_bf16 v[108:111], a[84:87], v[144:147], v[108:111]
    ds_read_b128 v[144:147], v14 offset:10240
    v_fma_f32 v221, -v178, v178, v221
    v_mfma_f32_16x16x32_bf16 v[112:115], a[80:83], v[204:207], v[112:115]
    buffer_load_dwordx4 a[124:127], v4, s[36:39], s67 offen offset:3072 sc1
    v_mfma_f32_16x16x32_bf16 v[116:119], a[84:87], v[204:207], v[116:119]
    ds_read_b128 v[204:207], v14 offset:11264
    v_max_f32 v221, 0, v221
    v_mfma_f32_16x16x32_bf16 v[120:123], a[80:83], v[208:211], v[120:123]
    s_add_u32 s67, s56, 32768
    v_add_f32 v221, 0x3727c5ac, v221
    v_mfma_f32_16x16x32_bf16 v[124:127], a[84:87], v[208:211], v[124:127]
    ds_read_b128 v[208:211], v14 offset:12288
    s_waitcnt vmcnt(8) lgkmcnt(6)
    v_mfma_f32_16x16x32_bf16 v[88:91], a[88:91], v[212:215], v[88:91]
    buffer_load_dwordx4 a[128:131], v4, s[36:39], s67 offen offset:0 sc1
    v_mfma_f32_16x16x32_bf16 v[92:95], a[92:95], v[212:215], v[92:95]
    ds_read_b128 v[212:215], v14 offset:13312
    v_mfma_f32_16x16x32_bf16 v[96:99], a[88:91], v[128:131], v[96:99]
    v_rsq_f32 v186, v221
    v_mfma_f32_16x16x32_bf16 v[100:103], a[92:95], v[128:131], v[100:103]
    ds_read_b128 v[128:131], v14 offset:14336
    s_waitcnt lgkmcnt(5)
    v_mfma_f32_16x16x32_bf16 v[104:107], a[88:91], v[132:135], v[104:107]
    v_mul_f32 v194, s70, v186
    v_mul_f32 v179, 0xbacccccd, v224
    v_mfma_f32_16x16x32_bf16 v[108:111], a[92:95], v[132:135], v[108:111]
    ds_read_b128 v[132:135], v14 offset:15360
    v_mul_f32 v225, 0x3acccccd, v225
    v_mfma_f32_16x16x32_bf16 v[112:115], a[88:91], v[136:139], v[112:115]
    buffer_load_dwordx4 a[132:135], v4, s[36:39], s67 offen offset:1024 sc1
    v_mfma_f32_16x16x32_bf16 v[116:119], a[92:95], v[136:139], v[116:119]
    ds_read_b128 v[136:139], v14 offset:16384
    v_fma_f32 v225, -v179, v179, v225
    v_mfma_f32_16x16x32_bf16 v[120:123], a[88:91], v[140:143], v[120:123]
    buffer_load_dwordx4 a[136:139], v4, s[36:39], s67 offen offset:2048 sc1
    v_mfma_f32_16x16x32_bf16 v[124:127], a[92:95], v[140:143], v[124:127]
    ds_read_b128 v[140:143], v14 offset:17408
    s_waitcnt vmcnt(9) lgkmcnt(6)
    v_mfma_f32_16x16x32_bf16 v[88:91], a[96:99], v[144:147], v[88:91]
    v_max_f32 v225, 0, v225
    v_add_f32 v225, 0x3727c5ac, v225
    v_mfma_f32_16x16x32_bf16 v[92:95], a[100:103], v[144:147], v[92:95]
    ds_read_b128 v[144:147], v14 offset:18432
    v_mfma_f32_16x16x32_bf16 v[96:99], a[96:99], v[204:207], v[96:99]
    buffer_load_dwordx4 a[140:143], v4, s[36:39], s67 offen offset:3072 sc1
    v_mfma_f32_16x16x32_bf16 v[100:103], a[100:103], v[204:207], v[100:103]
    ds_read_b128 v[204:207], v14 offset:19456
    v_rsq_f32 v187, v225
    s_waitcnt lgkmcnt(5)
    v_mfma_f32_16x16x32_bf16 v[104:107], a[96:99], v[208:211], v[104:107]
    s_add_u32 s67, s56, 36864
    v_mul_f32 v195, s70, v187
    v_mfma_f32_16x16x32_bf16 v[108:111], a[100:103], v[208:211], v[108:111]
    ds_read_b128 v[208:211], v14 offset:20480
    v_mul_f32 v180, 0xbacccccd, v228
    v_mfma_f32_16x16x32_bf16 v[112:115], a[96:99], v[212:215], v[112:115]
    buffer_load_dwordx4 a[144:147], v4, s[36:39], s67 offen offset:0 sc1
    v_mfma_f32_16x16x32_bf16 v[116:119], a[100:103], v[212:215], v[116:119]
    ds_read_b128 v[212:215], v14 offset:21504
    v_mul_f32 v229, 0x3acccccd, v229
    v_mfma_f32_16x16x32_bf16 v[120:123], a[96:99], v[128:131], v[120:123]
    v_fma_f32 v229, -v180, v180, v229
    v_max_f32 v229, 0, v229
    v_mfma_f32_16x16x32_bf16 v[124:127], a[100:103], v[128:131], v[124:127]
    ds_read_b128 v[128:131], v14 offset:22528
    s_waitcnt vmcnt(9) lgkmcnt(6)
    v_mfma_f32_16x16x32_bf16 v[88:91], a[104:107], v[132:135], v[88:91]
    buffer_load_dwordx4 a[148:151], v4, s[36:39], s67 offen offset:1024 sc1
    v_mfma_f32_16x16x32_bf16 v[92:95], a[108:111], v[132:135], v[92:95]
    ds_read_b128 v[132:135], v14 offset:23552
    buffer_load_dwordx4 a[152:155], v4, s[36:39], s67 offen offset:2048 sc1
    buffer_load_dwordx4 a[156:159], v4, s[36:39], s67 offen offset:3072 sc1
    v_mfma_f32_16x16x32_bf16 v[96:99], a[104:107], v[136:139], v[96:99]
    v_add_f32 v229, 0x3727c5ac, v229
    s_add_u32 s90, s45, s48
    v_mfma_f32_16x16x32_bf16 v[100:103], a[108:111], v[136:139], v[100:103]
    ds_read_b128 v[136:139], v14 offset:24576
    s_waitcnt lgkmcnt(5)
    v_mfma_f32_16x16x32_bf16 v[104:107], a[104:107], v[140:143], v[104:107]
    v_rsq_f32 v188, v229
    v_mfma_f32_16x16x32_bf16 v[108:111], a[108:111], v[140:143], v[108:111]
    ds_read_b128 v[140:143], v14 offset:25600
    v_mul_f32 v196, s70, v188
    v_mfma_f32_16x16x32_bf16 v[112:115], a[104:107], v[144:147], v[112:115]
    v_mul_f32 v181, 0xbacccccd, v232
    v_mul_f32 v233, 0x3acccccd, v233
    v_mfma_f32_16x16x32_bf16 v[116:119], a[108:111], v[144:147], v[116:119]
    ds_read_b128 v[144:147], v14 offset:26624
    v_fma_f32 v233, -v181, v181, v233
    v_mfma_f32_16x16x32_bf16 v[120:123], a[104:107], v[204:207], v[120:123]
    s_add_u32 s91, s46, s48
    v_max_f32 v233, 0, v233
    v_mfma_f32_16x16x32_bf16 v[124:127], a[108:111], v[204:207], v[124:127]
    ds_read_b128 v[204:207], v14 offset:27648
    s_waitcnt vmcnt(10) lgkmcnt(6)
    v_mfma_f32_16x16x32_bf16 v[88:91], a[112:115], v[208:211], v[88:91]
    s_add_u32 m0, s90, 0
    v_add_f32 v233, 0x3727c5ac, v233
    v_mfma_f32_16x16x32_bf16 v[92:95], a[116:119], v[208:211], v[92:95]
    ds_read_b128 v[208:211], v14 offset:28672
    s_add_u32 s69, s91, 102400
    v_mfma_f32_16x16x32_bf16 v[96:99], a[112:115], v[212:215], v[96:99]
    v_rsq_f32 v189, v233
    v_mfma_f32_16x16x32_bf16 v[100:103], a[116:119], v[212:215], v[100:103]
    ds_read_b128 v[212:215], v14 offset:29696
    s_waitcnt lgkmcnt(5)
    v_mfma_f32_16x16x32_bf16 v[104:107], a[112:115], v[128:131], v[104:107]
    buffer_load_dwordx4 v4, s[36:39], s69 offen offset:0 lds
    v_mfma_f32_16x16x32_bf16 v[108:111], a[116:119], v[128:131], v[108:111]
    ds_read_b128 v[128:131], v14 offset:30720
    v_mul_f32 v197, s70, v189
    v_mfma_f32_16x16x32_bf16 v[112:115], a[112:115], v[132:135], v[112:115]
    v_mul_f32 v174, 0xbacccccd, v218
    v_mul_f32 v219, 0x3acccccd, v219
    v_mfma_f32_16x16x32_bf16 v[116:119], a[116:119], v[132:135], v[116:119]
    ds_read_b128 v[132:135], v14 offset:31744
    v_fma_f32 v219, -v174, v174, v219
    v_mfma_f32_16x16x32_bf16 v[120:123], a[112:115], v[136:139], v[120:123]
    buffer_load_dwordx4 v4, s[36:39], s69 offen offset:1024 lds
    v_mfma_f32_16x16x32_bf16 v[124:127], a[116:119], v[136:139], v[124:127]
    ds_read_b128 v[136:139], v14 offset:32768
    s_waitcnt vmcnt(10) lgkmcnt(6)
    v_mfma_f32_16x16x32_bf16 v[88:91], a[120:123], v[140:143], v[88:91]
    v_max_f32 v219, 0, v219
    v_add_f32 v219, 0x3727c5ac, v219
    v_mfma_f32_16x16x32_bf16 v[92:95], a[124:127], v[140:143], v[92:95]
    ds_read_b128 v[140:143], v14 offset:33792
    v_mfma_f32_16x16x32_bf16 v[96:99], a[120:123], v[144:147], v[96:99]
    buffer_load_dwordx4 v4, s[36:39], s69 offen offset:2048 lds
    v_mfma_f32_16x16x32_bf16 v[100:103], a[124:127], v[144:147], v[100:103]
    ds_read_b128 v[144:147], v14 offset:34816
    s_waitcnt lgkmcnt(5)
    v_mfma_f32_16x16x32_bf16 v[104:107], a[120:123], v[204:207], v[104:107]
    v_rsq_f32 v175, v219
    v_mfma_f32_16x16x32_bf16 v[108:111], a[124:127], v[204:207], v[108:111]
    ds_read_b128 v[204:207], v14 offset:35840
    v_mul_f32 v177, s70, v175
    v_mfma_f32_16x16x32_bf16 v[112:115], a[120:123], v[208:211], v[112:115]
    buffer_load_dwordx4 v4, s[36:39], s69 offen offset:3072 lds
    v_mfma_f32_16x16x32_bf16 v[116:119], a[124:127], v[208:211], v[116:119]
    ds_read_b128 v[208:211], v14 offset:36864
    v_mul_f32 v182, 0xbacccccd, v222
    v_mfma_f32_16x16x32_bf16 v[120:123], a[120:123], v[212:215], v[120:123]
    s_add_u32 m0, s90, 4096
    v_mul_f32 v223, 0x3acccccd, v223
    v_mfma_f32_16x16x32_bf16 v[124:127], a[124:127], v[212:215], v[124:127]
    ds_read_b128 v[212:215], v14 offset:37888
    s_waitcnt vmcnt(10) lgkmcnt(6)
    v_mfma_f32_16x16x32_bf16 v[88:91], a[128:131], v[128:131], v[88:91]
    v_fma_f32 v223, -v182, v182, v223
    s_add_u32 s69, s91, 106496
    v_mfma_f32_16x16x32_bf16 v[92:95], a[132:135], v[128:131], v[92:95]
    ds_read_b128 v[128:131], v14 offset:38912
    v_max_f32 v223, 0, v223
    v_mfma_f32_16x16x32_bf16 v[96:99], a[128:131], v[132:135], v[96:99]
    buffer_load_dwordx4 v4, s[36:39], s69 offen offset:0 lds
    v_mfma_f32_16x16x32_bf16 v[100:103], a[132:135], v[132:135], v[100:103]
    ds_read_b128 v[132:135], v14 offset:39936
    s_waitcnt lgkmcnt(5)
    v_mfma_f32_16x16x32_bf16 v[104:107], a[128:131], v[136:139], v[104:107]
    v_add_f32 v223, 0x3727c5ac, v223
    v_mfma_f32_16x16x32_bf16 v[108:111], a[132:135], v[136:139], v[108:111]
    ds_read_b128 v[136:139], v14 offset:40960
    v_mfma_f32_16x16x32_bf16 v[112:115], a[128:131], v[140:143], v[112:115]
    v_rsq_f32 v190, v223
    v_mfma_f32_16x16x32_bf16 v[116:119], a[132:135], v[140:143], v[116:119]
    ds_read_b128 v[140:143], v14 offset:41984
    v_mul_f32 v198, s70, v190
    v_mfma_f32_16x16x32_bf16 v[120:123], a[128:131], v[144:147], v[120:123]
    buffer_load_dwordx4 v4, s[36:39], s69 offen offset:1024 lds
    v_mfma_f32_16x16x32_bf16 v[124:127], a[132:135], v[144:147], v[124:127]
    ds_read_b128 v[144:147], v14 offset:43008
    s_waitcnt vmcnt(10) lgkmcnt(6)
    v_mfma_f32_16x16x32_bf16 v[88:91], a[136:139], v[204:207], v[88:91]
    v_mul_f32 v183, 0xbacccccd, v226
    v_mul_f32 v227, 0x3acccccd, v227
    v_mfma_f32_16x16x32_bf16 v[92:95], a[140:143], v[204:207], v[92:95]
    ds_read_b128 v[204:207], v14 offset:44032
    v_fma_f32 v227, -v183, v183, v227
    v_mfma_f32_16x16x32_bf16 v[96:99], a[136:139], v[208:211], v[96:99]
    buffer_load_dwordx4 v4, s[36:39], s69 offen offset:2048 lds
    v_mfma_f32_16x16x32_bf16 v[100:103], a[140:143], v[208:211], v[100:103]
    ds_read_b128 v[208:211], v14 offset:45056
    s_waitcnt lgkmcnt(5)
    v_mfma_f32_16x16x32_bf16 v[104:107], a[136:139], v[212:215], v[104:107]
    v_max_f32 v227, 0, v227
    v_add_f32 v227, 0x3727c5ac, v227
    v_mfma_f32_16x16x32_bf16 v[108:111], a[140:143], v[212:215], v[108:111]
    ds_read_b128 v[212:215], v14 offset:46080
    v_mfma_f32_16x16x32_bf16 v[112:115], a[136:139], v[128:131], v[112:115]
    buffer_load_dwordx4 v4, s[36:39], s69 offen offset:3072 lds
    v_mfma_f32_16x16x32_bf16 v[116:119], a[140:143], v[128:131], v[116:119]
    ds_read_b128 v[128:131], v14 offset:47104
    s_add_u32 m0, s90, 8192
    v_mfma_f32_16x16x32_bf16 v[120:123], a[136:139], v[132:135], v[120:123]
    v_rsq_f32 v191, v227
    v_mfma_f32_16x16x32_bf16 v[124:127], a[140:143], v[132:135], v[124:127]
    ds_read_b128 v[132:135], v14 offset:48128
    s_waitcnt vmcnt(10) lgkmcnt(6)
    v_mfma_f32_16x16x32_bf16 v[88:91], a[144:147], v[136:139], v[88:91]
    v_mul_f32 v199, s70, v191
    s_add_u32 s69, s91, 110592
    v_mfma_f32_16x16x32_bf16 v[92:95], a[148:151], v[136:139], v[92:95]
    ds_read_b128 v[136:139], v14 offset:49152
    v_mul_f32 v184, 0xbacccccd, v230
    v_mfma_f32_16x16x32_bf16 v[96:99], a[144:147], v[140:143], v[96:99]
    buffer_load_dwordx4 v4, s[36:39], s69 offen offset:0 lds
    v_mfma_f32_16x16x32_bf16 v[100:103], a[148:151], v[140:143], v[100:103]
    ds_read_b128 v[140:143], v14 offset:50176
    v_mul_f32 v231, 0x3acccccd, v231
    s_waitcnt lgkmcnt(5)
    v_mfma_f32_16x16x32_bf16 v[104:107], a[144:147], v[144:147], v[104:107]
    v_fma_f32 v231, -v184, v184, v231
    v_max_f32 v231, 0, v231
    v_mfma_f32_16x16x32_bf16 v[108:111], a[148:151], v[144:147], v[108:111]
    buffer_load_dwordx4 v4, s[36:39], s69 offen offset:1024 lds
    v_mfma_f32_16x16x32_bf16 v[112:115], a[144:147], v[204:207], v[112:115]
    v_add_f32 v231, 0x3727c5ac, v231
    v_mfma_f32_16x16x32_bf16 v[116:119], a[148:151], v[204:207], v[116:119]
    v_rsq_f32 v192, v231
    v_mfma_f32_16x16x32_bf16 v[120:123], a[144:147], v[208:211], v[120:123]
    buffer_load_dwordx4 v4, s[36:39], s69 offen offset:2048 lds
    v_mfma_f32_16x16x32_bf16 v[124:127], a[148:151], v[208:211], v[124:127]
    v_mul_f32 v200, s70, v192
    s_waitcnt vmcnt(11) lgkmcnt(3)
    v_mfma_f32_16x16x32_bf16 v[88:91], a[152:155], v[212:215], v[88:91]
    v_mul_f32 v185, 0xbacccccd, v234
    v_mul_f32 v235, 0x3acccccd, v235
    v_mfma_f32_16x16x32_bf16 v[92:95], a[156:159], v[212:215], v[92:95]
    buffer_load_dwordx4 v4, s[36:39], s69 offen offset:3072 lds
    v_mfma_f32_16x16x32_bf16 v[96:99], a[152:155], v[128:131], v[96:99]
    v_fma_f32 v235, -v185, v185, v235
    s_add_u32 m0, s90, 12288
    v_mfma_f32_16x16x32_bf16 v[100:103], a[156:159], v[128:131], v[100:103]
    v_max_f32 v235, 0, v235
    s_waitcnt lgkmcnt(0)
    v_mfma_f32_16x16x32_bf16 v[104:107], a[152:155], v[132:135], v[104:107]
    v_add_f32 v235, 0x3727c5ac, v235
    s_add_u32 s69, s91, 114688
    v_mfma_f32_16x16x32_bf16 v[108:111], a[156:159], v[132:135], v[108:111]
    v_rsq_f32 v193, v235
    buffer_load_dwordx4 v4, s[36:39], s69 offen offset:0 lds
    v_mul_f32 v201, s70, v193
    v_mfma_f32_16x16x32_bf16 v[112:115], a[152:155], v[136:139], v[112:115]
    v_mfma_f32_16x16x32_bf16 v[116:119], a[156:159], v[136:139], v[116:119]
    v_mfma_f32_16x16x32_bf16 v[120:123], a[152:155], v[140:143], v[120:123]
    v_mfma_f32_16x16x32_bf16 v[124:127], a[156:159], v[140:143], v[124:127]
    s_nop 7
KVE:
    ds_read_b32 v202, v46 offset:0
    ds_read_b32 v203, v46 offset:64
    ds_read_b32 v204, v46 offset:128
    ds_read_b32 v205, v46 offset:192
    ds_read_b32 v206, v46 offset:256
    s_waitcnt lgkmcnt(0)
    v_fma_f32 v112, v178, v205, v112
    v_mul_f32 v112, v186, v112
    v_fma_f32 v113, v179, v205, v113
    v_mul_f32 v113, v187, v113
    v_fma_f32 v114, v180, v205, v114
    v_mul_f32 v114, v188, v114
    v_fma_f32 v115, v181, v205, v115
    v_mul_f32 v115, v189, v115
    v_fma_f32 v116, v182, v205, v116
    v_mul_f32 v116, v190, v116
    v_fma_f32 v117, v183, v205, v117
    v_mul_f32 v117, v191, v117
    v_fma_f32 v118, v184, v205, v118
    v_mul_f32 v118, v192, v118
    v_fma_f32 v119, v185, v205, v119
    v_mul_f32 v119, v193, v119
    v_cvt_pk_bf16_f32 v140, v112, v113
    v_cvt_pk_bf16_f32 v141, v114, v115
    v_cvt_pk_bf16_f32 v142, v116, v117
    v_cvt_pk_bf16_f32 v143, v118, v119
    v_fma_f32 v120, v178, v206, v120
    v_mul_f32 v120, v186, v120
    v_fma_f32 v121, v179, v206, v121
    v_mul_f32 v121, v187, v121
    v_fma_f32 v122, v180, v206, v122
    v_mul_f32 v122, v188, v122
    v_fma_f32 v123, v181, v206, v123
    s_add_u32 s90, s43, s48
    s_add_u32 s91, s46, s48
    s_add_u32 m0, s90, 0
    s_add_u32 s69, s91, 153600
    buffer_load_dwordx4 v4, s[36:39], s69 offen offset:0 lds
    v_mul_f32 v123, v189, v123
    v_fma_f32 v124, v182, v206, v124
    v_mul_f32 v124, v190, v124
    v_fma_f32 v125, v183, v206, v125
    v_mul_f32 v125, v191, v125
    v_fma_f32 v126, v184, v206, v126
    v_mul_f32 v126, v192, v126
    v_fma_f32 v127, v185, v206, v127
    v_mul_f32 v127, v193, v127
    v_cvt_pk_bf16_f32 v144, v120, v121
    v_cvt_pk_bf16_f32 v145, v122, v123
    v_cvt_pk_bf16_f32 v146, v124, v125
    v_cvt_pk_bf16_f32 v147, v126, v127
    v_fma_f32 v88, v178, v202, v88
    v_min_f32 v216, 0, v88
    v_mul_f32 v216, v194, v216
    v_exp_f32 v216, v216
    v_max_f32 v217, 0, v88
    v_add_f32 v216, s71, v216
    v_fma_f32 v89, v179, v202, v89
    v_min_f32 v218, 0, v89
    v_mul_f32 v218, v195, v218
    v_exp_f32 v218, v218
    v_max_f32 v219, 0, v89
    v_add_f32 v218, s71, v218
    v_fma_f32 v90, v180, v202, v90
    v_min_f32 v220, 0, v90
    buffer_load_dwordx4 v4, s[36:39], s69 offen offset:1024 lds
    v_mul_f32 v220, v196, v220
    v_exp_f32 v220, v220
    v_max_f32 v221, 0, v90
    v_add_f32 v220, s71, v220
    v_fma_f32 v91, v181, v202, v91
    v_min_f32 v222, 0, v91
    v_mul_f32 v222, v197, v222
    v_exp_f32 v222, v222
    v_max_f32 v223, 0, v91
    v_add_f32 v222, s71, v222
    v_fma_f32 v88, v217, v186, v216
    v_fma_f32 v89, v219, v187, v218
    v_fma_f32 v90, v221, v188, v220
    v_fma_f32 v91, v223, v189, v222
    v_fma_f32 v92, v182, v202, v92
    v_min_f32 v216, 0, v92
    v_mul_f32 v216, v198, v216
    v_exp_f32 v216, v216
    v_max_f32 v217, 0, v92
    v_add_f32 v216, s71, v216
    v_fma_f32 v93, v183, v202, v93
    v_min_f32 v218, 0, v93
    v_mul_f32 v218, v199, v218
    v_exp_f32 v218, v218
    v_max_f32 v219, 0, v93
    v_add_f32 v218, s71, v218
    buffer_load_dwordx4 v4, s[36:39], s69 offen offset:2048 lds
    v_fma_f32 v94, v184, v202, v94
    v_min_f32 v220, 0, v94
    v_mul_f32 v220, v200, v220
    v_exp_f32 v220, v220
    v_max_f32 v221, 0, v94
    v_add_f32 v220, s71, v220
    v_fma_f32 v95, v185, v202, v95
    v_min_f32 v222, 0, v95
    v_mul_f32 v222, v201, v222
    v_exp_f32 v222, v222
    v_max_f32 v223, 0, v95
    v_add_f32 v222, s71, v222
    v_fma_f32 v92, v217, v190, v216
    v_fma_f32 v93, v219, v191, v218
    v_fma_f32 v94, v221, v192, v220
    v_fma_f32 v95, v223, v193, v222
    v_cvt_pk_bf16_f32 v128, v88, v89
    v_cvt_pk_bf16_f32 v129, v90, v91
    v_cvt_pk_bf16_f32 v130, v92, v93
    v_cvt_pk_bf16_f32 v131, v94, v95
    v_fma_f32 v96, v178, v203, v96
    v_min_f32 v216, 0, v96
    v_mul_f32 v216, v194, v216
    v_exp_f32 v216, v216
    v_max_f32 v217, 0, v96
    v_add_f32 v216, s71, v216
    v_fma_f32 v97, v179, v203, v97
    buffer_load_dwordx4 v4, s[36:39], s69 offen offset:3072 lds
    v_min_f32 v218, 0, v97
    v_mul_f32 v218, v195, v218
    v_exp_f32 v218, v218
    v_max_f32 v219, 0, v97
    v_add_f32 v218, s71, v218
    v_fma_f32 v98, v180, v203, v98
    v_min_f32 v220, 0, v98
    v_mul_f32 v220, v196, v220
    v_exp_f32 v220, v220
    v_max_f32 v221, 0, v98
    v_add_f32 v220, s71, v220
    v_fma_f32 v99, v181, v203, v99
    v_min_f32 v222, 0, v99
    v_mul_f32 v222, v197, v222
    v_exp_f32 v222, v222
    v_max_f32 v223, 0, v99
    v_add_f32 v222, s71, v222
    v_fma_f32 v96, v217, v186, v216
    v_fma_f32 v97, v219, v187, v218
    v_fma_f32 v98, v221, v188, v220
    v_fma_f32 v99, v223, v189, v222
    v_fma_f32 v100, v182, v203, v100
    v_min_f32 v216, 0, v100
    v_mul_f32 v216, v198, v216
    v_exp_f32 v216, v216
    v_max_f32 v217, 0, v100
    s_add_u32 m0, s90, 4096
    s_add_u32 s69, s91, 157696
    buffer_load_dwordx4 v4, s[36:39], s69 offen offset:0 lds
    v_add_f32 v216, s71, v216
    v_fma_f32 v101, v183, v203, v101
    v_min_f32 v218, 0, v101
    v_mul_f32 v218, v199, v218
    v_exp_f32 v218, v218
    v_max_f32 v219, 0, v101
    v_add_f32 v218, s71, v218
    v_fma_f32 v102, v184, v203, v102
    v_min_f32 v220, 0, v102
    v_mul_f32 v220, v200, v220
    v_exp_f32 v220, v220
    v_max_f32 v221, 0, v102
    v_add_f32 v220, s71, v220
    v_fma_f32 v103, v185, v203, v103
    v_min_f32 v222, 0, v103
    v_mul_f32 v222, v201, v222
    v_exp_f32 v222, v222
    v_max_f32 v223, 0, v103
    v_add_f32 v222, s71, v222
    v_fma_f32 v100, v217, v190, v216
    v_fma_f32 v101, v219, v191, v218
    v_fma_f32 v102, v221, v192, v220
    v_fma_f32 v103, v223, v193, v222
    v_cvt_pk_bf16_f32 v132, v96, v97
    v_cvt_pk_bf16_f32 v133, v98, v99
    v_cvt_pk_bf16_f32 v134, v100, v101
    v_cvt_pk_bf16_f32 v135, v102, v103
    buffer_load_dwordx4 v4, s[36:39], s69 offen offset:1024 lds
    v_fma_f32 v104, v178, v204, v104
    v_min_f32 v216, 0, v104
    v_mul_f32 v216, v194, v216
    v_exp_f32 v216, v216
    v_max_f32 v217, 0, v104
    v_add_f32 v216, s71, v216
    v_mul_f32 v224, v186, v104
    v_fma_f32 v105, v179, v204, v105
    v_min_f32 v218, 0, v105
    v_mul_f32 v218, v195, v218
    v_exp_f32 v218, v218
    v_max_f32 v219, 0, v105
    v_add_f32 v218, s71, v218
    v_mul_f32 v225, v187, v105
    v_fma_f32 v106, v180, v204, v106
    v_min_f32 v220, 0, v106
    v_mul_f32 v220, v196, v220
    v_exp_f32 v220, v220
    v_max_f32 v221, 0, v106
    v_add_f32 v220, s71, v220
    v_mul_f32 v226, v188, v106
    v_fma_f32 v107, v181, v204, v107
    v_min_f32 v222, 0, v107
    v_mul_f32 v222, v197, v222
    v_exp_f32 v222, v222
    v_max_f32 v223, 0, v107
    buffer_load_dwordx4 v4, s[36:39], s69 offen offset:2048 lds
    v_add_f32 v222, s71, v222
    v_mul_f32 v227, v189, v107
    v_fma_f32 v104, v217, v186, v216
    v_fma_f32 v105, v219, v187, v218
    v_fma_f32 v106, v221, v188, v220
    v_fma_f32 v107, v223, v189, v222
    v_fma_f32 v108, v182, v204, v108
    v_min_f32 v216, 0, v108
    v_mul_f32 v216, v198, v216
    v_exp_f32 v216, v216
    v_max_f32 v217, 0, v108
    v_add_f32 v216, s71, v216
    v_mul_f32 v228, v190, v108
    v_fma_f32 v109, v183, v204, v109
    v_min_f32 v218, 0, v109
    v_mul_f32 v218, v199, v218
    v_exp_f32 v218, v218
    v_max_f32 v219, 0, v109
    v_add_f32 v218, s71, v218
    v_mul_f32 v229, v191, v109
    v_fma_f32 v110, v184, v204, v110
    v_min_f32 v220, 0, v110
    v_mul_f32 v220, v200, v220
    v_exp_f32 v220, v220
    v_max_f32 v221, 0, v110
    v_add_f32 v220, s71, v220
    v_mul_f32 v230, v192, v110
    buffer_load_dwordx4 v4, s[36:39], s69 offen offset:3072 lds
    v_fma_f32 v111, v185, v204, v111
    v_min_f32 v222, 0, v111
    v_mul_f32 v222, v201, v222
    v_exp_f32 v222, v222
    v_max_f32 v223, 0, v111
    v_add_f32 v222, s71, v222
    v_mul_f32 v231, v193, v111
    v_fma_f32 v108, v217, v190, v216
    v_fma_f32 v109, v219, v191, v218
    v_fma_f32 v110, v221, v192, v220
    v_fma_f32 v111, v223, v193, v222
    v_cvt_pk_bf16_f32 v136, v104, v105
    v_cvt_pk_bf16_f32 v137, v106, v107
    v_cvt_pk_bf16_f32 v138, v108, v109
    v_cvt_pk_bf16_f32 v139, v110, v111
    v_cvt_pk_bf16_f32 v248, v224, v225
    v_cvt_pk_bf16_f32 v249, v226, v227
    v_cvt_pk_bf16_f32 v250, v228, v229
    v_cvt_pk_bf16_f32 v251, v230, v231
    s_mov_b32 exec_lo, 0xff00ff
    s_mov_b32 exec_hi, 0xff00ff
    v_mov_b32 v248, 0x3f803f80
    v_mov_b32 v249, 0x3f803f80
    v_mov_b32 v250, 0x3f803f80
    v_mov_b32 v251, 0x3f803f80
    s_mov_b64 exec, -1
    v_mfma_f32_16x16x32_bf16 v[88:91], v[128:131], v[140:143], 0
    v_mfma_f32_16x16x32_bf16 v[92:95], v[128:131], v[144:147], 0
    v_mfma_f32_16x16x32_bf16 v[96:99], v[132:135], v[140:143], 0
    v_mfma_f32_16x16x32_bf16 v[100:103], v[132:135], v[144:147], 0
    v_mfma_f32_16x16x32_bf16 v[104:107], v[132:135], v[248:251], 0
    v_mfma_f32_16x16x32_bf16 v[108:111], v[136:139], v[144:147], 0
    s_add_u32 m0, s90, 8192
    s_add_u32 s69, s91, 161792
    buffer_load_dwordx4 v4, s[36:39], s69 offen offset:0 lds
    v_mfma_f32_16x16x32_bf16 v[112:115], v[136:139], v[248:251], 0
    v_mfma_f32_16x16x32_bf16 v[116:119], v[128:131], v[248:251], 0
    v_add_u32 v216, s44, v15
    v_add_u32 v217, s44, v16
    v_add_u32 v218, s44, v17
    v_add_u32 v219, s44, v18
    v_add_u32 v220, s44, v19
    v_add_u32 v221, s44, v20
    v_add_u32 v222, s44, v21
    v_add_u32 v223, s44, v22
    v_add_u32 v13, s45, v4
    v_add_u32 v14, s45, v12
    v_add_u32 v63, s44, v41
    s_waitcnt vmcnt(9)
    buffer_load_dword v54, v11, s[36:39], 0 offen sc1
    s_barrier
    ds_read_b128 v[128:131], v13 offset:0
    ds_read_b128 v[132:135], v13 offset:1024
    ds_read_b128 v[136:139], v14 offset:0
    ds_read_b128 v[140:143], v13 offset:2560
    ds_read_b128 v[144:147], v13 offset:3584
    ds_read_b128 v[204:207], v14 offset:2560
    ds_read_b128 v[208:211], v13 offset:5120
    ds_read_b128 v[212:215], v13 offset:6144
    s_waitcnt lgkmcnt(5)
    v_mfma_f32_16x16x32_bf16 v[148:151], v[128:131], a[0:3], 0
    s_mov_b64 exec, -1
    v_mfma_f32_16x16x32_bf16 v[152:155], v[128:131], a[4:7], 0
    ds_read_b128 v[128:131], v14 offset:5120
    ds_write_b128 v216, v[88:91]
    v_mfma_f32_16x16x32_bf16 v[156:159], v[132:135], a[0:3], 0
    s_mov_b64 exec, -1
    v_mfma_f32_16x16x32_bf16 v[160:163], v[132:135], a[4:7], 0
    ds_read_b128 v[132:135], v13 offset:7680
    s_mov_b32 exec_lo, 0xf000f
    s_mov_b32 exec_hi, 0xf000f
    ds_write_b128 v217, v[92:95]
    s_mov_b64 exec, -1
    v_mfma_f32_16x16x32_bf16 v[164:167], v[136:139], a[0:3], 0
    buffer_load_dwordx4 v4, s[36:39], s69 offen offset:1024 lds
    v_mfma_f32_16x16x32_bf16 v[168:171], v[136:139], a[4:7], 0
    ds_read_b128 v[136:139], v13 offset:8704
    s_waitcnt lgkmcnt(7)
    v_mfma_f32_16x16x32_bf16 v[148:151], v[140:143], a[8:11], v[148:151]
    s_mov_b64 exec, 0xffff
    ds_write_b128 v218, v[96:99]
    s_mov_b64 exec, -1
    v_mfma_f32_16x16x32_bf16 v[152:155], v[140:143], a[12:15], v[152:155]
    ds_read_b128 v[140:143], v14 offset:7680
    v_mfma_f32_16x16x32_bf16 v[156:159], v[144:147], a[8:11], v[156:159]
    s_mov_b32 exec_lo, 0xfff0000f
    s_mov_b32 exec_hi, 0xfff0fff0
    ds_write_b128 v219, v[100:103]
    s_mov_b64 exec, -1
    v_mfma_f32_16x16x32_bf16 v[160:163], v[144:147], a[12:15], v[160:163]
    ds_read_b128 v[144:147], v13 offset:10240
    v_mfma_f32_16x16x32_bf16 v[164:167], v[204:207], a[8:11], v[164:167]
    buffer_load_dwordx4 v4, s[36:39], s69 offen offset:2048 lds
    v_mfma_f32_16x16x32_bf16 v[168:171], v[204:207], a[12:15], v[168:171]
    ds_read_b128 v[204:207], v13 offset:11264
    s_mov_b32 exec_lo, 0xff010001
    s_mov_b32 exec_hi, 0xff01ff01
    ds_write_b128 v220, v[104:107]
    s_mov_b64 exec, -1
    s_waitcnt lgkmcnt(10)
    v_mfma_f32_16x16x32_bf16 v[148:151], v[208:211], a[16:19], v[148:151]
    s_mov_b32 exec_lo, 0xfff0fff0
    s_mov_b32 exec_hi, 0x0
    ds_write_b128 v221, v[108:111]
    s_mov_b64 exec, -1
    v_mfma_f32_16x16x32_bf16 v[152:155], v[208:211], a[20:23], v[152:155]
    ds_read_b128 v[208:211], v14 offset:10240
    v_mfma_f32_16x16x32_bf16 v[156:159], v[212:215], a[16:19], v[156:159]
    s_mov_b32 exec_lo, 0xff01ff01
    s_mov_b32 exec_hi, 0x0
    ds_write_b128 v222, v[112:115]
    s_mov_b64 exec, -1
    v_mfma_f32_16x16x32_bf16 v[160:163], v[212:215], a[20:23], v[160:163]
    ds_read_b128 v[212:215], v13 offset:12800
    v_mfma_f32_16x16x32_bf16 v[164:167], v[128:131], a[16:19], v[164:167]
    buffer_load_dwordx4 v4, s[36:39], s69 offen offset:3072 lds
    v_mfma_f32_16x16x32_bf16 v[168:171], v[128:131], a[20:23], v[168:171]
    ds_read_b128 v[128:131], v13 offset:13824
    s_waitcnt lgkmcnt(9)
    v_mfma_f32_16x16x32_bf16 v[148:151], v[132:135], a[24:27], v[148:151]
    s_mov_b32 exec_lo, 0x10001
    s_mov_b32 exec_hi, 0x10001
    ds_write_b128 v223, v[116:119]
    s_mov_b64 exec, -1
    v_mfma_f32_16x16x32_bf16 v[152:155], v[132:135], a[28:31], v[152:155]
    ds_read_b128 v[132:135], v14 offset:12800
    s_waitcnt lgkmcnt(1)
    v_mfma_f32_16x16x32_bf16 v[156:159], v[136:139], a[24:27], v[156:159]
    s_barrier
    ds_read_b128 v[88:91], v63 offset:0
    v_mfma_f32_16x16x32_bf16 v[160:163], v[136:139], a[28:31], v[160:163]
    ds_read_b128 v[136:139], v13 offset:15360
    ds_read_b128 v[92:95], v63 offset:6720
    v_mfma_f32_16x16x32_bf16 v[164:167], v[140:143], a[24:27], v[164:167]
    s_add_u32 m0, s90, 12288
    s_add_u32 s69, s91, 165888
    buffer_load_dwordx4 v4, s[36:39], s69 offen offset:0 lds
    ds_read_b128 v[96:99], v63 offset:13440
    ds_read_b128 v[100:103], v63 offset:20160
    v_mfma_f32_16x16x32_bf16 v[168:171], v[140:143], a[28:31], v[168:171]
    ds_read_b128 v[140:143], v13 offset:16384
    v_mfma_f32_16x16x32_bf16 v[148:151], v[144:147], a[32:35], v[148:151]
    v_mfma_f32_16x16x32_bf16 v[152:155], v[144:147], a[36:39], v[152:155]
    ds_read_b128 v[144:147], v14 offset:15360
    v_mfma_f32_16x16x32_bf16 v[156:159], v[204:207], a[32:35], v[156:159]
    v_mfma_f32_16x16x32_bf16 v[160:163], v[204:207], a[36:39], v[160:163]
    ds_read_b128 v[204:207], v13 offset:17920
    s_waitcnt lgkmcnt(3)
    v_add_f32 v88, v88, v92
    v_add_f32 v96, v96, v100
    v_add_f32 v89, v89, v93
    v_add_f32 v97, v97, v101
    v_add_f32 v90, v90, v94
    v_add_f32 v98, v98, v102
    v_add_f32 v91, v91, v95
    v_add_f32 v99, v99, v103
    v_add_f32 v88, v88, v96
    v_add_f32 v89, v89, v97
    v_add_f32 v90, v90, v98
    v_add_f32 v91, v91, v99
    v_cvt_pk_bf16_f32 v216, v88, v89
    v_cvt_pk_bf16_f32 v217, v90, v91
    s_mov_b64 exec, s[64:65]
    buffer_store_dwordx2 v[216:217], v42, s[36:39], s58 offen sc1
    s_mov_b64 exec, -1
    s_barrier
    s_cmp_eq_u32 s52, 0
    s_cbranch_scc1 OUT7
RET8:
    v_mfma_f32_16x16x32_bf16 v[164:167], v[208:211], a[32:35], v[164:167]
    v_mfma_f32_16x16x32_bf16 v[168:171], v[208:211], a[36:39], v[168:171]
    ds_read_b128 v[208:211], v13 offset:18944
    v_mfma_f32_16x16x32_bf16 v[148:151], v[212:215], a[40:43], v[148:151]
    v_mfma_f32_16x16x32_bf16 v[152:155], v[212:215], a[44:47], v[152:155]
    ds_read_b128 v[212:215], v14 offset:17920
    v_mfma_f32_16x16x32_bf16 v[156:159], v[128:131], a[40:43], v[156:159]
    s_add_u32 s90, s44, s48
    v_mfma_f32_16x16x32_bf16 v[160:163], v[128:131], a[44:47], v[160:163]
    ds_read_b128 v[128:131], v13 offset:20480
    v_mfma_f32_16x16x32_bf16 v[164:167], v[132:135], a[40:43], v[164:167]
    s_add_u32 s91, s47, s48
    v_mfma_f32_16x16x32_bf16 v[168:171], v[132:135], a[44:47], v[168:171]
    ds_read_b128 v[132:135], v13 offset:21504
    s_waitcnt lgkmcnt(5)
    v_mfma_f32_16x16x32_bf16 v[148:151], v[136:139], a[48:51], v[148:151]
    s_add_u32 m0, s90, 0
    v_mfma_f32_16x16x32_bf16 v[152:155], v[136:139], a[52:55], v[152:155]
    ds_read_b128 v[136:139], v14 offset:20480
    v_mfma_f32_16x16x32_bf16 v[156:159], v[140:143], a[48:51], v[156:159]
    s_add_u32 s69, s91, 0
    v_mfma_f32_16x16x32_bf16 v[160:163], v[140:143], a[52:55], v[160:163]
    ds_read_b128 v[140:143], v13 offset:23040
    v_mfma_f32_16x16x32_bf16 v[164:167], v[144:147], a[48:51], v[164:167]
    buffer_load_dwordx4 v4, s[92:95], s69 offen offset:0 lds
    v_mfma_f32_16x16x32_bf16 v[168:171], v[144:147], a[52:55], v[168:171]
    ds_read_b128 v[144:147], v13 offset:24064
    s_waitcnt lgkmcnt(5)
    v_mfma_f32_16x16x32_bf16 v[148:151], v[204:207], a[56:59], v[148:151]
    v_mfma_f32_16x16x32_bf16 v[152:155], v[204:207], a[60:63], v[152:155]
    ds_read_b128 v[204:207], v14 offset:23040
    v_mfma_f32_16x16x32_bf16 v[156:159], v[208:211], a[56:59], v[156:159]
    v_mfma_f32_16x16x32_bf16 v[160:163], v[208:211], a[60:63], v[160:163]
    ds_read_b128 v[208:211], v13 offset:25600
    v_mfma_f32_16x16x32_bf16 v[164:167], v[212:215], a[56:59], v[164:167]
    buffer_load_dwordx4 v4, s[92:95], s69 offen offset:1024 lds
    v_mfma_f32_16x16x32_bf16 v[168:171], v[212:215], a[60:63], v[168:171]
    ds_read_b128 v[212:215], v13 offset:26624
    s_waitcnt lgkmcnt(5)
    v_mfma_f32_16x16x32_bf16 v[148:151], v[128:131], a[64:67], v[148:151]
    v_mfma_f32_16x16x32_bf16 v[152:155], v[128:131], a[68:71], v[152:155]
    ds_read_b128 v[128:131], v14 offset:25600
    v_mfma_f32_16x16x32_bf16 v[156:159], v[132:135], a[64:67], v[156:159]
    buffer_load_dwordx4 v4, s[92:95], s69 offen offset:2048 lds
    v_mfma_f32_16x16x32_bf16 v[160:163], v[132:135], a[68:71], v[160:163]
    ds_read_b128 v[132:135], v13 offset:28160
    v_mfma_f32_16x16x32_bf16 v[164:167], v[136:139], a[64:67], v[164:167]
    v_mfma_f32_16x16x32_bf16 v[168:171], v[136:139], a[68:71], v[168:171]
    ds_read_b128 v[136:139], v13 offset:29184
    s_waitcnt lgkmcnt(5)
    v_mfma_f32_16x16x32_bf16 v[148:151], v[140:143], a[72:75], v[148:151]
    buffer_load_dwordx4 v4, s[92:95], s69 offen offset:3072 lds
    v_mfma_f32_16x16x32_bf16 v[152:155], v[140:143], a[76:79], v[152:155]
    ds_read_b128 v[140:143], v14 offset:28160
    v_mfma_f32_16x16x32_bf16 v[156:159], v[144:147], a[72:75], v[156:159]
    v_mfma_f32_16x16x32_bf16 v[160:163], v[144:147], a[76:79], v[160:163]
    ds_read_b128 v[144:147], v13 offset:30720
    v_mfma_f32_16x16x32_bf16 v[164:167], v[204:207], a[72:75], v[164:167]
    s_add_u32 m0, s90, 4096
    v_mfma_f32_16x16x32_bf16 v[168:171], v[204:207], a[76:79], v[168:171]
    ds_read_b128 v[204:207], v13 offset:31744
    s_waitcnt lgkmcnt(5)
    v_mfma_f32_16x16x32_bf16 v[148:151], v[208:211], a[80:83], v[148:151]
    s_add_u32 s69, s91, 4096
    v_mfma_f32_16x16x32_bf16 v[152:155], v[208:211], a[84:87], v[152:155]
    ds_read_b128 v[208:211], v14 offset:30720
    v_mfma_f32_16x16x32_bf16 v[156:159], v[212:215], a[80:83], v[156:159]
    v_mfma_f32_16x16x32_bf16 v[160:163], v[212:215], a[84:87], v[160:163]
    ds_read_b128 v[212:215], v13 offset:33280
    v_mfma_f32_16x16x32_bf16 v[164:167], v[128:131], a[80:83], v[164:167]
    buffer_load_dwordx4 v4, s[92:95], s69 offen offset:0 lds
    v_mfma_f32_16x16x32_bf16 v[168:171], v[128:131], a[84:87], v[168:171]
    ds_read_b128 v[128:131], v13 offset:34304
    s_waitcnt lgkmcnt(5)
    v_mfma_f32_16x16x32_bf16 v[148:151], v[132:135], a[88:91], v[148:151]
    v_mfma_f32_16x16x32_bf16 v[152:155], v[132:135], a[92:95], v[152:155]
    ds_read_b128 v[132:135], v14 offset:33280
    v_mfma_f32_16x16x32_bf16 v[156:159], v[136:139], a[88:91], v[156:159]
    buffer_load_dwordx4 v4, s[92:95], s69 offen offset:1024 lds
    v_mfma_f32_16x16x32_bf16 v[160:163], v[136:139], a[92:95], v[160:163]
    ds_read_b128 v[136:139], v13 offset:35840
    v_mfma_f32_16x16x32_bf16 v[164:167], v[140:143], a[88:91], v[164:167]
    v_mfma_f32_16x16x32_bf16 v[168:171], v[140:143], a[92:95], v[168:171]
    ds_read_b128 v[140:143], v13 offset:36864
    s_waitcnt lgkmcnt(5)
    v_mfma_f32_16x16x32_bf16 v[148:151], v[144:147], a[96:99], v[148:151]
    buffer_load_dwordx4 v4, s[92:95], s69 offen offset:2048 lds
    v_mfma_f32_16x16x32_bf16 v[152:155], v[144:147], a[100:103], v[152:155]
    ds_read_b128 v[144:147], v14 offset:35840
    v_mfma_f32_16x16x32_bf16 v[156:159], v[204:207], a[96:99], v[156:159]
    v_mfma_f32_16x16x32_bf16 v[160:163], v[204:207], a[100:103], v[160:163]
    ds_read_b128 v[204:207], v13 offset:38400
    v_mfma_f32_16x16x32_bf16 v[164:167], v[208:211], a[96:99], v[164:167]
    buffer_load_dwordx4 v4, s[92:95], s69 offen offset:3072 lds
    v_mfma_f32_16x16x32_bf16 v[168:171], v[208:211], a[100:103], v[168:171]
    ds_read_b128 v[208:211], v13 offset:39424
    s_waitcnt lgkmcnt(5)
    v_mfma_f32_16x16x32_bf16 v[148:151], v[212:215], a[104:107], v[148:151]
    v_mfma_f32_16x16x32_bf16 v[152:155], v[212:215], a[108:111], v[152:155]
    ds_read_b128 v[212:215], v14 offset:38400
    v_mfma_f32_16x16x32_bf16 v[156:159], v[128:131], a[104:107], v[156:159]
    s_add_u32 m0, s90, 8192
    v_mfma_f32_16x16x32_bf16 v[160:163], v[128:131], a[108:111], v[160:163]
    ds_read_b128 v[128:131], v13 offset:40960
    v_mfma_f32_16x16x32_bf16 v[164:167], v[132:135], a[104:107], v[164:167]
    v_mfma_f32_16x16x32_bf16 v[168:171], v[132:135], a[108:111], v[168:171]
    ds_read_b128 v[132:135], v13 offset:41984
    s_waitcnt lgkmcnt(5)
    v_mfma_f32_16x16x32_bf16 v[148:151], v[136:139], a[112:115], v[148:151]
    s_add_u32 s69, s91, 8192
    v_mfma_f32_16x16x32_bf16 v[152:155], v[136:139], a[116:119], v[152:155]
    ds_read_b128 v[136:139], v14 offset:40960
    v_mfma_f32_16x16x32_bf16 v[156:159], v[140:143], a[112:115], v[156:159]
    buffer_load_dwordx4 v4, s[92:95], s69 offen offset:0 lds
    v_mfma_f32_16x16x32_bf16 v[160:163], v[140:143], a[116:119], v[160:163]
    ds_read_b128 v[140:143], v13 offset:43520
    v_mfma_f32_16x16x32_bf16 v[164:167], v[144:147], a[112:115], v[164:167]
    v_mfma_f32_16x16x32_bf16 v[168:171], v[144:147], a[116:119], v[168:171]
    ds_read_b128 v[144:147], v13 offset:44544
    s_waitcnt lgkmcnt(5)
    v_mfma_f32_16x16x32_bf16 v[148:151], v[204:207], a[120:123], v[148:151]
    buffer_load_dwordx4 v4, s[92:95], s69 offen offset:1024 lds
    v_mfma_f32_16x16x32_bf16 v[152:155], v[204:207], a[124:127], v[152:155]
    ds_read_b128 v[204:207], v14 offset:43520
    v_mfma_f32_16x16x32_bf16 v[156:159], v[208:211], a[120:123], v[156:159]
    v_mfma_f32_16x16x32_bf16 v[160:163], v[208:211], a[124:127], v[160:163]
    ds_read_b128 v[208:211], v13 offset:46080
    v_mfma_f32_16x16x32_bf16 v[164:167], v[212:215], a[120:123], v[164:167]
    buffer_load_dwordx4 v4, s[92:95], s69 offen offset:2048 lds
    v_mfma_f32_16x16x32_bf16 v[168:171], v[212:215], a[124:127], v[168:171]
    ds_read_b128 v[212:215], v13 offset:47104
    s_waitcnt lgkmcnt(5)
    v_mfma_f32_16x16x32_bf16 v[148:151], v[128:131], a[128:131], v[148:151]
    s_add_u32 s3, s59, 0
    v_mfma_f32_16x16x32_bf16 v[152:155], v[128:131], a[132:135], v[152:155]
    ds_read_b128 v[128:131], v14 offset:46080
    v_mfma_f32_16x16x32_bf16 v[156:159], v[132:135], a[128:131], v[156:159]
    buffer_load_dwordx4 a[0:3], v59, s[36:39], s3 offen offset:0
    v_mfma_f32_16x16x32_bf16 v[160:163], v[132:135], a[132:135], v[160:163]
    ds_read_b128 v[132:135], v13 offset:48640
    v_mfma_f32_16x16x32_bf16 v[164:167], v[136:139], a[128:131], v[164:167]
    buffer_load_dwordx4 v4, s[92:95], s69 offen offset:3072 lds
    v_mfma_f32_16x16x32_bf16 v[168:171], v[136:139], a[132:135], v[168:171]
    ds_read_b128 v[136:139], v13 offset:49664
    s_waitcnt lgkmcnt(5)
    v_mfma_f32_16x16x32_bf16 v[148:151], v[140:143], a[136:139], v[148:151]
    s_mov_b64 exec, s[100:101]
    buffer_load_dwordx4 a[4:7], v59, s[36:39], s3 offen offset:1024
    s_mov_b64 exec, -1
    v_mfma_f32_16x16x32_bf16 v[152:155], v[140:143], a[140:143], v[152:155]
    ds_read_b128 v[140:143], v14 offset:48640
    s_add_u32 m0, s90, 12288
    v_mfma_f32_16x16x32_bf16 v[156:159], v[144:147], a[136:139], v[156:159]
    v_mfma_f32_16x16x32_bf16 v[160:163], v[144:147], a[140:143], v[160:163]
    s_add_u32 s69, s91, 12288
    v_mfma_f32_16x16x32_bf16 v[164:167], v[204:207], a[136:139], v[164:167]
    v_mfma_f32_16x16x32_bf16 v[168:171], v[204:207], a[140:143], v[168:171]
    s_waitcnt lgkmcnt(3)
    v_mfma_f32_16x16x32_bf16 v[148:151], v[208:211], a[144:147], v[148:151]
    buffer_load_dwordx4 v4, s[92:95], s69 offen offset:0 lds
    v_mfma_f32_16x16x32_bf16 v[152:155], v[208:211], a[148:151], v[152:155]
    s_add_u32 s3, s59, 16384
    v_mfma_f32_16x16x32_bf16 v[156:159], v[212:215], a[144:147], v[156:159]
    buffer_load_dwordx4 a[8:11], v59, s[36:39], s3 offen offset:0
    v_mfma_f32_16x16x32_bf16 v[160:163], v[212:215], a[148:151], v[160:163]
    v_mfma_f32_16x16x32_bf16 v[164:167], v[128:131], a[144:147], v[164:167]
    v_mfma_f32_16x16x32_bf16 v[168:171], v[128:131], a[148:151], v[168:171]
    s_waitcnt lgkmcnt(0)
    v_mfma_f32_16x16x32_bf16 v[148:151], v[132:135], a[152:155], v[148:151]
    s_mov_b64 exec, s[100:101]
    buffer_load_dwordx4 a[12:15], v59, s[36:39], s3 offen offset:1024
    s_mov_b64 exec, -1
    v_mfma_f32_16x16x32_bf16 v[152:155], v[132:135], a[156:159], v[152:155]
    v_mfma_f32_16x16x32_bf16 v[156:159], v[136:139], a[152:155], v[156:159]
    v_mfma_f32_16x16x32_bf16 v[160:163], v[136:139], a[156:159], v[160:163]
    v_mfma_f32_16x16x32_bf16 v[164:167], v[140:143], a[152:155], v[164:167]
    v_mfma_f32_16x16x32_bf16 v[168:171], v[140:143], a[156:159], v[168:171]
    s_barrier
    s_cmp_eq_u32 s52, 0
    s_nop 5
    s_cbranch_scc1 OUT9
RET10:
    ds_read_b128 v[202:205], v47 offset:320
    ds_read_b128 v[206:209], v47 offset:384
    ds_read_b128 v[210:213], v47 offset:448
    s_waitcnt lgkmcnt(0)
    v_fma_f32 v148, v172, v202, v148
    v_min_f32 v216, 0, v148
    v_mul_f32 v216, v176, v216
    v_exp_f32 v216, v216
    v_max_f32 v217, 0, v148
    v_add_f32 v216, s71, v216
    s_add_u32 s3, s59, 32768
    v_fma_f32 v149, v172, v203, v149
    v_min_f32 v218, 0, v149
    v_mul_f32 v218, v176, v218
    v_exp_f32 v218, v218
    v_max_f32 v219, 0, v149
    v_add_f32 v218, s71, v218
    v_fma_f32 v150, v172, v204, v150
    v_min_f32 v220, 0, v150
    v_mul_f32 v220, v176, v220
    buffer_load_dwordx4 a[16:19], v59, s[36:39], s3 offen offset:0
    v_exp_f32 v220, v220
    v_max_f32 v221, 0, v150
    v_add_f32 v220, s71, v220
    v_fma_f32 v151, v172, v205, v151
    v_min_f32 v222, 0, v151
    v_mul_f32 v222, v176, v222
    v_exp_f32 v222, v222
    v_max_f32 v223, 0, v151
    v_add_f32 v222, s71, v222
    s_mov_b64 exec, s[100:101]
    buffer_load_dwordx4 a[20:23], v59, s[36:39], s3 offen offset:1024
    s_mov_b64 exec, -1
    v_fma_f32 v148, v217, v173, v216
    v_fma_f32 v149, v219, v173, v218
    v_fma_f32 v150, v221, v173, v220
    v_fma_f32 v151, v223, v173, v222
    v_cvt_pk_bf16_f32 v244, v148, v149
    v_cvt_pk_bf16_f32 v245, v150, v151
    v_fma_f32 v152, v174, v202, v152
    v_min_f32 v216, 0, v152
    v_mul_f32 v216, v177, v216
    s_add_u32 s3, s59, 49152
    v_exp_f32 v216, v216
    v_max_f32 v217, 0, v152
    v_add_f32 v216, s71, v216
    v_fma_f32 v153, v174, v203, v153
    v_min_f32 v218, 0, v153
    v_mul_f32 v218, v177, v218
    v_exp_f32 v218, v218
    v_max_f32 v219, 0, v153
    v_add_f32 v218, s71, v218
    buffer_load_dwordx4 a[24:27], v59, s[36:39], s3 offen offset:0
    v_fma_f32 v154, v174, v204, v154
    v_min_f32 v220, 0, v154
    v_mul_f32 v220, v177, v220
    v_exp_f32 v220, v220
    v_max_f32 v221, 0, v154
    v_add_f32 v220, s71, v220
    v_fma_f32 v155, v174, v205, v155
    v_min_f32 v222, 0, v155
    v_mul_f32 v222, v177, v222
    s_mov_b64 exec, s[100:101]
    buffer_load_dwordx4 a[28:31], v59, s[36:39], s3 offen offset:1024
    s_mov_b64 exec, -1
    v_exp_f32 v222, v222
    v_max_f32 v223, 0, v155
    v_add_f32 v222, s71, v222
    v_fma_f32 v152, v217, v175, v216
    v_fma_f32 v153, v219, v175, v218
    v_fma_f32 v154, v221, v175, v220
    v_fma_f32 v155, v223, v175, v222
    v_cvt_pk_bf16_f32 v248, v152, v153
    v_cvt_pk_bf16_f32 v249, v154, v155
    v_fma_f32 v156, v172, v206, v156
    s_add_u32 s90, s45, s48
    s_add_u32 s91, s47, s48
    s_add_u32 m0, s90, 0
    s_add_u32 s69, s91, 51200
    buffer_load_dwordx4 v4, s[92:95], s69 offen offset:0 lds
    v_min_f32 v216, 0, v156
    v_mul_f32 v216, v176, v216
    v_exp_f32 v216, v216
    v_max_f32 v217, 0, v156
    v_add_f32 v216, s71, v216
    v_fma_f32 v157, v172, v207, v157
    v_min_f32 v218, 0, v157
    v_mul_f32 v218, v176, v218
    v_exp_f32 v218, v218
    buffer_load_dwordx4 v4, s[92:95], s69 offen offset:1024 lds
    v_max_f32 v219, 0, v157
    v_add_f32 v218, s71, v218
    v_fma_f32 v158, v172, v208, v158
    v_min_f32 v220, 0, v158
    v_mul_f32 v220, v176, v220
    v_exp_f32 v220, v220
    v_max_f32 v221, 0, v158
    v_add_f32 v220, s71, v220
    v_fma_f32 v159, v172, v209, v159
    buffer_load_dwordx4 v4, s[92:95], s69 offen offset:2048 lds
    v_min_f32 v222, 0, v159
    v_mul_f32 v222, v176, v222
    v_exp_f32 v222, v222
    v_max_f32 v223, 0, v159
    v_add_f32 v222, s71, v222
    v_fma_f32 v156, v217, v173, v216
    v_fma_f32 v157, v219, v173, v218
    v_fma_f32 v158, v221, v173, v220
    v_fma_f32 v159, v223, v173, v222
    buffer_load_dwordx4 v4, s[92:95], s69 offen offset:3072 lds
    v_cvt_pk_bf16_f32 v246, v156, v157
    v_cvt_pk_bf16_f32 v247, v158, v159
    v_fma_f32 v160, v174, v206, v160
    v_min_f32 v216, 0, v160
    v_mul_f32 v216, v177, v216
    v_exp_f32 v216, v216
    v_max_f32 v217, 0, v160
    v_add_f32 v216, s71, v216
    v_fma_f32 v161, v174, v207, v161
    s_add_u32 m0, s90, 4096
    s_add_u32 s69, s91, 55296
    buffer_load_dwordx4 v4, s[92:95], s69 offen offset:0 lds
    v_min_f32 v218, 0, v161
    v_mul_f32 v218, v177, v218
    v_exp_f32 v218, v218
    v_max_f32 v219, 0, v161
    v_add_f32 v218, s71, v218
    v_fma_f32 v162, v174, v208, v162
    v_min_f32 v220, 0, v162
    v_mul_f32 v220, v177, v220
    v_exp_f32 v220, v220
    buffer_load_dwordx4 v4, s[92:95], s69 offen offset:1024 lds
    v_max_f32 v221, 0, v162
    v_add_f32 v220, s71, v220
    v_fma_f32 v163, v174, v209, v163
    v_min_f32 v222, 0, v163
    v_mul_f32 v222, v177, v222
    v_exp_f32 v222, v222
    v_max_f32 v223, 0, v163
    v_add_f32 v222, s71, v222
    v_fma_f32 v160, v217, v175, v216
    v_fma_f32 v161, v219, v175, v218
    buffer_load_dwordx4 v4, s[92:95], s69 offen offset:2048 lds
    v_fma_f32 v162, v221, v175, v220
    v_fma_f32 v163, v223, v175, v222
    v_cvt_pk_bf16_f32 v250, v160, v161
    v_cvt_pk_bf16_f32 v251, v162, v163
    v_fma_f32 v164, v172, v210, v164
    v_min_f32 v216, 0, v164
    v_mul_f32 v216, v176, v216
    v_exp_f32 v216, v216
    v_max_f32 v217, 0, v164
    buffer_load_dwordx4 v4, s[92:95], s69 offen offset:3072 lds
    v_add_f32 v216, s71, v216
    v_fma_f32 v165, v172, v211, v165
    v_min_f32 v218, 0, v165
    v_mul_f32 v218, v176, v218
    v_exp_f32 v218, v218
    v_max_f32 v219, 0, v165
    v_add_f32 v218, s71, v218
    v_fma_f32 v166, v172, v212, v166
    v_min_f32 v220, 0, v166
    s_add_u32 m0, s90, 8192
    s_add_u32 s69, s91, 59392
    buffer_load_dwordx4 v4, s[92:95], s69 offen offset:0 lds
    v_mul_f32 v220, v176, v220
    v_exp_f32 v220, v220
    v_max_f32 v221, 0, v166
    v_add_f32 v220, s71, v220
    v_fma_f32 v167, v172, v213, v167
    v_min_f32 v222, 0, v167
    v_mul_f32 v222, v176, v222
    v_exp_f32 v222, v222
    v_max_f32 v223, 0, v167
    buffer_load_dwordx4 v4, s[92:95], s69 offen offset:1024 lds
    v_add_f32 v222, s71, v222
    v_fma_f32 v164, v217, v173, v216
    v_fma_f32 v165, v219, v173, v218
    v_fma_f32 v166, v221, v173, v220
    v_fma_f32 v167, v223, v173, v222
    v_cvt_pk_bf16_f32 v252, v164, v165
    v_cvt_pk_bf16_f32 v253, v166, v167
    v_fma_f32 v168, v174, v210, v168
    v_min_f32 v216, 0, v168
    buffer_load_dwordx4 v4, s[92:95], s69 offen offset:2048 lds
    v_mul_f32 v216, v177, v216
    v_exp_f32 v216, v216
    v_max_f32 v217, 0, v168
    v_add_f32 v216, s71, v216
    v_fma_f32 v169, v174, v211, v169
    v_min_f32 v218, 0, v169
    v_mul_f32 v218, v177, v218
    v_exp_f32 v218, v218
    v_max_f32 v219, 0, v169
    buffer_load_dwordx4 v4, s[92:95], s69 offen offset:3072 lds
    v_add_f32 v218, s71, v218
    v_fma_f32 v170, v174, v212, v170
    v_min_f32 v220, 0, v170
    v_mul_f32 v220, v177, v220
    v_exp_f32 v220, v220
    v_max_f32 v221, 0, v170
    v_add_f32 v220, s71, v220
    v_fma_f32 v171, v174, v213, v171
    v_min_f32 v222, 0, v171
    s_add_u32 m0, s90, 12288
    s_add_u32 s69, s91, 63488
    buffer_load_dwordx4 v4, s[92:95], s69 offen offset:0 lds
    v_mul_f32 v222, v177, v222
    v_exp_f32 v222, v222
    v_max_f32 v223, 0, v171
    v_add_f32 v222, s71, v222
    v_fma_f32 v168, v217, v175, v216
    v_fma_f32 v169, v219, v175, v218
    v_fma_f32 v170, v221, v175, v220
    v_fma_f32 v171, v223, v175, v222
    v_cvt_pk_bf16_f32 v254, v168, v169
    v_cvt_pk_bf16_f32 v255, v170, v171
    s_cmp_eq_u32 s52, 0
    s_nop 1
    s_cbranch_scc1 OUT11
RET12:
    s_waitcnt vmcnt(20)
    v_mfma_f32_16x16x32_bf16 v[88:91], a[240:243], a[0:3], 0
    v_mfma_f32_16x16x32_bf16 v[92:95], a[240:243], a[4:7], 0
    s_waitcnt vmcnt(17)
    v_mfma_f32_16x16x32_bf16 v[88:91], a[240:243], a[8:11], v[88:91]
    v_mfma_f32_16x16x32_bf16 v[92:95], a[240:243], a[12:15], v[92:95]
    s_waitcnt vmcnt(15)
    v_mfma_f32_16x16x32_bf16 v[88:91], a[240:243], a[16:19], v[88:91]
    v_mfma_f32_16x16x32_bf16 v[92:95], a[240:243], a[20:23], v[92:95]
    s_waitcnt vmcnt(13)
    v_mfma_f32_16x16x32_bf16 v[88:91], a[240:243], a[24:27], v[88:91]
    v_mfma_f32_16x16x32_bf16 v[92:95], a[240:243], a[28:31], v[92:95]
    s_nop 7
    v_cmp_u_f32 s[86:87], v92, v92
    s_and_b64 s[86:87], s[86:87], s[100:101]
    v_cmp_u_f32 vcc, v88, v88
    s_or_b64 vcc, vcc, s[86:87]
    s_cmp_lg_u64 vcc, 0
    s_nop 2
    s_cbranch_scc1 REDO13
RBACK14:
    v_cvt_pk_bf16_f32 v88, v88, v89
    v_cvt_pk_bf16_f32 v89, v90, v91
    v_cvt_pk_bf16_f32 v92, v92, v93
    v_cvt_pk_bf16_f32 v93, v94, v95
    s_mov_b32 exec_hi, 0
    ds_write_b64 v60, v[88:89] offset:0
    s_mov_b32 exec_lo, s100
    ds_write_b64 v60, v[92:93] offset:1024
    s_mov_b64 exec, -1
    s_waitcnt lgkmcnt(0)
    s_barrier
    v_mov_b32 v132, 0
    v_mov_b32 v133, 0
    v_mov_b32 v136, 0
    v_mov_b32 v137, 0
    v_mov_b32 v140, 0
    v_mov_b32 v141, 0
    v_mov_b32 v144, 0
    v_mov_b32 v145, 0
    ds_read_b64 v[120:121], v26
    ds_read_b64 v[122:123], v27
    ds_read_b64 v[124:125], v28
    ds_read_b64 v[126:127], v29
    ds_read_b64 v[134:135], v30
    ds_read_b64 v[146:147], v31
    ds_read_b64 v[138:139], v32
    ds_read_b64 v[128:129], v33
    ds_read_b64 v[130:131], v34
    ds_read_b64 v[142:143], v35
    s_waitcnt lgkmcnt(0)
    v_mfma_f32_16x16x32_bf16 v[112:115], v[128:131], v[244:247], 0
    v_mfma_f32_16x16x32_bf16 v[116:119], v[128:131], v[248:251], 0
    v_mfma_f32_16x16x32_bf16 v[88:91], v[120:123], v[244:247], 0
    v_mfma_f32_16x16x32_bf16 v[92:95], v[120:123], v[248:251], 0
    v_mfma_f32_16x16x32_bf16 v[96:99], v[124:127], v[244:247], 0
    v_mfma_f32_16x16x32_bf16 v[100:103], v[124:127], v[248:251], 0
    v_mfma_f32_16x16x32_bf16 v[104:107], v[144:147], v[244:247], 0
    v_mfma_f32_16x16x32_bf16 v[108:111], v[144:147], v[248:251], 0
    v_mfma_f32_16x16x32_bf16 v[112:115], v[142:145], v[252:255], v[112:115]
    v_mfma_f32_16x16x32_bf16 v[116:119], v[140:143], v[252:255], v[116:119]
    v_mfma_f32_16x16x32_bf16 v[96:99], v[134:137], v[252:255], v[96:99]
    v_mfma_f32_16x16x32_bf16 v[100:103], v[132:135], v[252:255], v[100:103]
    v_mfma_f32_16x16x32_bf16 v[104:107], v[138:141], v[252:255], v[104:107]
    v_mfma_f32_16x16x32_bf16 v[108:111], v[136:139], v[252:255], v[108:111]
    s_nop 2
    v_add_f32 v112, s71, v112
    v_add_f32 v113, s71, v113
    v_rcp_f32 v112, v112
    v_rcp_f32 v113, v113
    s_nop 0
    v_cndmask_b32 v114, v113, v112, s[76:77]
    v_mul_f32 v88, v112, v88
    v_mul_f32 v89, v112, v89
    v_mul_f32 v90, v112, v90
    v_mul_f32 v91, v112, v91
    v_cvt_pk_bf16_f32 v240, v88, v89
    v_cvt_pk_bf16_f32 v241, v90, v91
    v_mul_f32 v96, v114, v96
    v_mul_f32 v97, v114, v97
    v_mul_f32 v98, v114, v98
    v_mul_f32 v99, v114, v99
    v_cvt_pk_bf16_f32 v242, v96, v97
    v_cvt_pk_bf16_f32 v243, v98, v99
    v_mul_f32 v104, v113, v104
    v_mul_f32 v105, v113, v105
    v_mul_f32 v106, v113, v106
    v_mul_f32 v107, v113, v107
    v_cvt_pk_bf16_f32 v244, v104, v105
    v_cvt_pk_bf16_f32 v245, v106, v107
    v_add_f32 v116, s71, v116
    v_add_f32 v117, s71, v117
    v_rcp_f32 v116, v116
    v_rcp_f32 v117, v117
    s_nop 0
    v_cndmask_b32 v118, v117, v116, s[76:77]
    v_mul_f32 v92, v116, v92
    v_mul_f32 v93, v116, v93
    v_mul_f32 v94, v116, v94
    v_mul_f32 v95, v116, v95
    v_cvt_pk_bf16_f32 v246, v92, v93
    v_cvt_pk_bf16_f32 v247, v94, v95
    v_mul_f32 v100, v118, v100
    v_mul_f32 v101, v118, v101
    v_mul_f32 v102, v118, v102
    v_mul_f32 v103, v118, v103
    v_cvt_pk_bf16_f32 v248, v100, v101
    v_cvt_pk_bf16_f32 v249, v102, v103
    v_mul_f32 v108, v117, v108
    v_mul_f32 v109, v117, v109
    v_mul_f32 v110, v117, v110
    v_mul_f32 v111, v117, v111
    v_cvt_pk_bf16_f32 v250, v108, v109
    v_cvt_pk_bf16_f32 v251, v110, v111
    s_cmp_eq_u32 s50, 0
    s_nop 1
    s_cbranch_scc1 SLOW15
    buffer_store_dwordx4 v[240:243], v5, s[36:39], s57 offen offset:0
    buffer_store_dwordx4 v[246:249], v5, s[36:39], s57 offen offset:1024
    s_mov_b32 exec_hi, 0
    buffer_store_dwordx2 v[244:245], v6, s[36:39], s57 offen offset:0
    buffer_store_dwordx2 v[250:251], v6, s[36:39], s57 offen offset:1024
    s_mov_b64 exec, -1
BACK16:
    s_add_u32 s61, s61, 1
    v_add_u32 v13, s43, v4
    v_add_u32 v14, s43, v12
    v_mov_b32 v61, s61
    s_waitcnt vmcnt(0)
    s_cmp_eq_u32 s50, 0
    s_nop 0
    s_cbranch_scc1 SLOW17
    s_mov_b64 exec, 1
    buffer_store_dword v61, off, s[36:39], s60
    s_mov_b64 exec, -1
BACK18:
    ds_read_b128 v[128:131], v13 offset:0
    ds_read_b128 v[132:135], v13 offset:1024
    ds_read_b128 v[136:139], v14 offset:0
    ds_read_b128 v[140:143], v13 offset:2560
    ds_read_b128 v[144:147], v13 offset:3584
    ds_read_b128 v[204:207], v14 offset:2560
    ds_read_b128 v[208:211], v13 offset:5120
    ds_read_b128 v[212:215], v13 offset:6144
    s_mov_b32 s55, 131072
POA:
    buffer_load_dword v61, v9, s[36:39], 0 offen sc1
    s_waitcnt vmcnt(0)
    v_cmp_le_u32 vcc, s61, v61
    s_cmp_eq_u64 vcc, -1
    s_nop 3
    s_cbranch_scc1 POA_done
    s_sub_u32 s55, s55, 1
    s_cmp_eq_u32 s55, 0
    s_cbranch_scc1 ABORT
    s_branch POA
POA_done:
    s_add_u32 s67, s57, 0
    buffer_load_dwordx4 a[0:3], v4, s[36:39], s67 offen offset:0 sc1
    buffer_load_dwordx4 a[4:7], v4, s[36:39], s67 offen offset:1024 sc1
    buffer_load_dwordx4 a[8:11], v4, s[36:39], s67 offen offset:2048 sc1
    buffer_load_dwordx4 a[12:15], v4, s[36:39], s67 offen offset:3072 sc1
    s_add_u32 s67, s57, 4096
    buffer_load_dwordx4 a[16:19], v4, s[36:39], s67 offen offset:0 sc1
    buffer_load_dwordx4 a[20:23], v4, s[36:39], s67 offen offset:1024 sc1
    buffer_load_dwordx4 a[24:27], v4, s[36:39], s67 offen offset:2048 sc1
    buffer_load_dwordx4 a[28:31], v4, s[36:39], s67 offen offset:3072 sc1
    s_add_u32 s67, s57, 8192
    buffer_load_dwordx4 a[32:35], v4, s[36:39], s67 offen offset:0 sc1
    buffer_load_dwordx4 a[36:39], v4, s[36:39], s67 offen offset:1024 sc1
    buffer_load_dwordx4 a[40:43], v4, s[36:39], s67 offen offset:2048 sc1
    buffer_load_dwordx4 a[44:47], v4, s[36:39], s67 offen offset:3072 sc1
    s_waitcnt vmcnt(10) lgkmcnt(5)
    v_mfma_f32_16x16x32_bf16 v[64:67], v[128:131], a[0:3], v[64:67]
    s_add_u32 s67, s57, 12288
    v_mfma_f32_16x16x32_bf16 v[76:79], v[128:131], a[4:7], v[76:79]
    ds_read_b128 v[128:131], v14 offset:5120
    v_mfma_f32_16x16x32_bf16 v[68:71], v[132:135], a[0:3], v[68:71]
    buffer_load_dwordx4 a[48:51], v4, s[36:39], s67 offen offset:0 sc1
    v_mfma_f32_16x16x32_bf16 v[80:83], v[132:135], a[4:7], v[80:83]
    ds_read_b128 v[132:135], v13 offset:7680
    v_mfma_f32_16x16x32_bf16 v[72:75], v[136:139], a[0:3], v[72:75]
    buffer_load_dwordx4 a[52:55], v4, s[36:39], s67 offen offset:1024 sc1
    v_mfma_f32_16x16x32_bf16 v[84:87], v[136:139], a[4:7], v[84:87]
    ds_read_b128 v[136:139], v13 offset:8704
    s_waitcnt vmcnt(10) lgkmcnt(5)
    v_mfma_f32_16x16x32_bf16 v[64:67], v[140:143], a[8:11], v[64:67]
    buffer_load_dwordx4 a[56:59], v4, s[36:39], s67 offen offset:2048 sc1
    v_mfma_f32_16x16x32_bf16 v[76:79], v[140:143], a[12:15], v[76:79]
    ds_read_b128 v[140:143], v14 offset:7680
    v_mfma_f32_16x16x32_bf16 v[68:71], v[144:147], a[8:11], v[68:71]
    v_mfma_f32_16x16x32_bf16 v[80:83], v[144:147], a[12:15], v[80:83]
    ds_read_b128 v[144:147], v13 offset:10240
    v_mfma_f32_16x16x32_bf16 v[72:75], v[204:207], a[8:11], v[72:75]
    buffer_load_dwordx4 a[60:63], v4, s[36:39], s67 offen offset:3072 sc1
    v_mfma_f32_16x16x32_bf16 v[84:87], v[204:207], a[12:15], v[84:87]
    ds_read_b128 v[204:207], v13 offset:11264
    s_waitcnt vmcnt(10) lgkmcnt(5)
    v_mfma_f32_16x16x32_bf16 v[64:67], v[208:211], a[16:19], v[64:67]
    s_add_u32 s67, s57, 16384
    v_mfma_f32_16x16x32_bf16 v[76:79], v[208:211], a[20:23], v[76:79]
    ds_read_b128 v[208:211], v14 offset:10240
    v_mfma_f32_16x16x32_bf16 v[68:71], v[212:215], a[16:19], v[68:71]
    buffer_load_dwordx4 a[64:67], v4, s[36:39], s67 offen offset:0 sc1
    v_mfma_f32_16x16x32_bf16 v[80:83], v[212:215], a[20:23], v[80:83]
    ds_read_b128 v[212:215], v13 offset:12800
    v_mfma_f32_16x16x32_bf16 v[72:75], v[128:131], a[16:19], v[72:75]
    buffer_load_dwordx4 a[68:71], v4, s[36:39], s67 offen offset:1024 sc1
    v_mfma_f32_16x16x32_bf16 v[84:87], v[128:131], a[20:23], v[84:87]
    ds_read_b128 v[128:131], v13 offset:13824
    s_waitcnt vmcnt(10) lgkmcnt(5)
    v_mfma_f32_16x16x32_bf16 v[64:67], v[132:135], a[24:27], v[64:67]
    buffer_load_dwordx4 a[72:75], v4, s[36:39], s67 offen offset:2048 sc1
    v_mfma_f32_16x16x32_bf16 v[76:79], v[132:135], a[28:31], v[76:79]
    ds_read_b128 v[132:135], v14 offset:12800
    v_mfma_f32_16x16x32_bf16 v[68:71], v[136:139], a[24:27], v[68:71]
    v_mfma_f32_16x16x32_bf16 v[80:83], v[136:139], a[28:31], v[80:83]
    ds_read_b128 v[136:139], v13 offset:15360
    v_mfma_f32_16x16x32_bf16 v[72:75], v[140:143], a[24:27], v[72:75]
    buffer_load_dwordx4 a[76:79], v4, s[36:39], s67 offen offset:3072 sc1
    v_mfma_f32_16x16x32_bf16 v[84:87], v[140:143], a[28:31], v[84:87]
    ds_read_b128 v[140:143], v13 offset:16384
    s_waitcnt vmcnt(10) lgkmcnt(5)
    v_mfma_f32_16x16x32_bf16 v[64:67], v[144:147], a[32:35], v[64:67]
    s_add_u32 s67, s57, 20480
    v_mfma_f32_16x16x32_bf16 v[76:79], v[144:147], a[36:39], v[76:79]
    ds_read_b128 v[144:147], v14 offset:15360
    v_mfma_f32_16x16x32_bf16 v[68:71], v[204:207], a[32:35], v[68:71]
    buffer_load_dwordx4 a[80:83], v4, s[36:39], s67 offen offset:0 sc1
    v_mfma_f32_16x16x32_bf16 v[80:83], v[204:207], a[36:39], v[80:83]
    ds_read_b128 v[204:207], v13 offset:17920
    v_mfma_f32_16x16x32_bf16 v[72:75], v[208:211], a[32:35], v[72:75]
    buffer_load_dwordx4 a[84:87], v4, s[36:39], s67 offen offset:1024 sc1
    v_mfma_f32_16x16x32_bf16 v[84:87], v[208:211], a[36:39], v[84:87]
    ds_read_b128 v[208:211], v13 offset:18944
    s_waitcnt vmcnt(10) lgkmcnt(5)
    v_mfma_f32_16x16x32_bf16 v[64:67], v[212:215], a[40:43], v[64:67]
    buffer_load_dwordx4 a[88:91], v4, s[36:39], s67 offen offset:2048 sc1
    v_mfma_f32_16x16x32_bf16 v[76:79], v[212:215], a[44:47], v[76:79]
    ds_read_b128 v[212:215], v14 offset:17920
    v_mfma_f32_16x16x32_bf16 v[68:71], v[128:131], a[40:43], v[68:71]
    v_mfma_f32_16x16x32_bf16 v[80:83], v[128:131], a[44:47], v[80:83]
    ds_read_b128 v[128:131], v13 offset:20480
    v_mfma_f32_16x16x32_bf16 v[72:75], v[132:135], a[40:43], v[72:75]
    buffer_load_dwordx4 a[92:95], v4, s[36:39], s67 offen offset:3072 sc1
    v_mfma_f32_16x16x32_bf16 v[84:87], v[132:135], a[44:47], v[84:87]
    ds_read_b128 v[132:135], v13 offset:21504
    s_waitcnt vmcnt(10) lgkmcnt(5)
    v_mfma_f32_16x16x32_bf16 v[64:67], v[136:139], a[48:51], v[64:67]
    s_add_u32 s67, s57, 24576
    v_mfma_f32_16x16x32_bf16 v[76:79], v[136:139], a[52:55], v[76:79]
    ds_read_b128 v[136:139], v14 offset:20480
    v_mfma_f32_16x16x32_bf16 v[68:71], v[140:143], a[48:51], v[68:71]
    buffer_load_dwordx4 a[96:99], v4, s[36:39], s67 offen offset:0 sc1
    v_mfma_f32_16x16x32_bf16 v[80:83], v[140:143], a[52:55], v[80:83]
    ds_read_b128 v[140:143], v13 offset:23040
    v_mfma_f32_16x16x32_bf16 v[72:75], v[144:147], a[48:51], v[72:75]
    buffer_load_dwordx4 a[100:103], v4, s[36:39], s67 offen offset:1024 sc1
    v_mfma_f32_16x16x32_bf16 v[84:87], v[144:147], a[52:55], v[84:87]
    ds_read_b128 v[144:147], v13 offset:24064
    s_waitcnt vmcnt(10) lgkmcnt(5)
    v_mfma_f32_16x16x32_bf16 v[64:67], v[204:207], a[56:59], v[64:67]
    buffer_load_dwordx4 a[104:107], v4, s[36:39], s67 offen offset:2048 sc1
    v_mfma_f32_16x16x32_bf16 v[76:79], v[204:207], a[60:63], v[76:79]
    ds_read_b128 v[204:207], v14 offset:23040
    v_mfma_f32_16x16x32_bf16 v[68:71], v[208:211], a[56:59], v[68:71]
    v_mfma_f32_16x16x32_bf16 v[80:83], v[208:211], a[60:63], v[80:83]
    ds_read_b128 v[208:211], v13 offset:25600
    v_mfma_f32_16x16x32_bf16 v[72:75], v[212:215], a[56:59], v[72:75]
    buffer_load_dwordx4 a[108:111], v4, s[36:39], s67 offen offset:3072 sc1
    v_mfma_f32_16x16x32_bf16 v[84:87], v[212:215], a[60:63], v[84:87]
    ds_read_b128 v[212:215], v13 offset:26624
    s_waitcnt vmcnt(10) lgkmcnt(5)
    v_mfma_f32_16x16x32_bf16 v[64:67], v[128:131], a[64:67], v[64:67]
    s_add_u32 s67, s57, 28672
    v_mfma_f32_16x16x32_bf16 v[76:79], v[128:131], a[68:71], v[76:79]
    ds_read_b128 v[128:131], v14 offset:25600
    v_mfma_f32_16x16x32_bf16 v[68:71], v[132:135], a[64:67], v[68:71]
    buffer_load_dwordx4 a[112:115], v4, s[36:39], s67 offen offset:0 sc1
    v_mfma_f32_16x16x32_bf16 v[80:83], v[132:135], a[68:71], v[80:83]
    ds_read_b128 v[132:135], v13 offset:28160
    v_mfma_f32_16x16x32_bf16 v[72:75], v[136:139], a[64:67], v[72:75]
    buffer_load_dwordx4 a[116:119], v4, s[36:39], s67 offen offset:1024 sc1
    v_mfma_f32_16x16x32_bf16 v[84:87], v[136:139], a[68:71], v[84:87]
    ds_read_b128 v[136:139], v13 offset:29184
    s_waitcnt vmcnt(10) lgkmcnt(5)
    v_mfma_f32_16x16x32_bf16 v[64:67], v[140:143], a[72:75], v[64:67]
    buffer_load_dwordx4 a[120:123], v4, s[36:39], s67 offen offset:2048 sc1
    v_mfma_f32_16x16x32_bf16 v[76:79], v[140:143], a[76:79], v[76:79]
    ds_read_b128 v[140:143], v14 offset:28160
    v_mfma_f32_16x16x32_bf16 v[68:71], v[144:147], a[72:75], v[68:71]
    v_mfma_f32_16x16x32_bf16 v[80:83], v[144:147], a[76:79], v[80:83]
    ds_read_b128 v[144:147], v13 offset:30720
    v_mfma_f32_16x16x32_bf16 v[72:75], v[204:207], a[72:75], v[72:75]
    buffer_load_dwordx4 a[124:127], v4, s[36:39], s67 offen offset:3072 sc1
    v_mfma_f32_16x16x32_bf16 v[84:87], v[204:207], a[76:79], v[84:87]
    ds_read_b128 v[204:207], v13 offset:31744
    s_waitcnt vmcnt(10) lgkmcnt(5)
    v_mfma_f32_16x16x32_bf16 v[64:67], v[208:211], a[80:83], v[64:67]
    s_add_u32 s67, s57, 32768
    v_mfma_f32_16x16x32_bf16 v[76:79], v[208:211], a[84:87], v[76:79]
    ds_read_b128 v[208:211], v14 offset:30720
    v_mfma_f32_16x16x32_bf16 v[68:71], v[212:215], a[80:83], v[68:71]
    buffer_load_dwordx4 a[128:131], v4, s[36:39], s67 offen offset:0 sc1
    v_mfma_f32_16x16x32_bf16 v[80:83], v[212:215], a[84:87], v[80:83]
    ds_read_b128 v[212:215], v13 offset:33280
    v_mfma_f32_16x16x32_bf16 v[72:75], v[128:131], a[80:83], v[72:75]
    buffer_load_dwordx4 a[132:135], v4, s[36:39], s67 offen offset:1024 sc1
    v_mfma_f32_16x16x32_bf16 v[84:87], v[128:131], a[84:87], v[84:87]
    ds_read_b128 v[128:131], v13 offset:34304
    s_waitcnt vmcnt(10) lgkmcnt(5)
    v_mfma_f32_16x16x32_bf16 v[64:67], v[132:135], a[88:91], v[64:67]
    buffer_load_dwordx4 a[136:139], v4, s[36:39], s67 offen offset:2048 sc1
    v_mfma_f32_16x16x32_bf16 v[76:79], v[132:135], a[92:95], v[76:79]
    ds_read_b128 v[132:135], v14 offset:33280
    v_mfma_f32_16x16x32_bf16 v[68:71], v[136:139], a[88:91], v[68:71]
    v_mfma_f32_16x16x32_bf16 v[80:83], v[136:139], a[92:95], v[80:83]
    ds_read_b128 v[136:139], v13 offset:35840
    v_mfma_f32_16x16x32_bf16 v[72:75], v[140:143], a[88:91], v[72:75]
    buffer_load_dwordx4 a[140:143], v4, s[36:39], s67 offen offset:3072 sc1
    v_mfma_f32_16x16x32_bf16 v[84:87], v[140:143], a[92:95], v[84:87]
    ds_read_b128 v[140:143], v13 offset:36864
    s_waitcnt vmcnt(10) lgkmcnt(5)
    v_mfma_f32_16x16x32_bf16 v[64:67], v[144:147], a[96:99], v[64:67]
    s_add_u32 s67, s57, 36864
    v_mfma_f32_16x16x32_bf16 v[76:79], v[144:147], a[100:103], v[76:79]
    ds_read_b128 v[144:147], v14 offset:35840
    v_mfma_f32_16x16x32_bf16 v[68:71], v[204:207], a[96:99], v[68:71]
    buffer_load_dwordx4 a[144:147], v4, s[36:39], s67 offen offset:0 sc1
    v_mfma_f32_16x16x32_bf16 v[80:83], v[204:207], a[100:103], v[80:83]
    ds_read_b128 v[204:207], v13 offset:38400
    v_mfma_f32_16x16x32_bf16 v[72:75], v[208:211], a[96:99], v[72:75]
    buffer_load_dwordx4 a[148:151], v4, s[36:39], s67 offen offset:1024 sc1
    v_mfma_f32_16x16x32_bf16 v[84:87], v[208:211], a[100:103], v[84:87]
    ds_read_b128 v[208:211], v13 offset:39424
    s_waitcnt vmcnt(10) lgkmcnt(5)
    v_mfma_f32_16x16x32_bf16 v[64:67], v[212:215], a[104:107], v[64:67]
    buffer_load_dwordx4 a[152:155], v4, s[36:39], s67 offen offset:2048 sc1
    v_mfma_f32_16x16x32_bf16 v[76:79], v[212:215], a[108:111], v[76:79]
    ds_read_b128 v[212:215], v14 offset:38400
    v_mfma_f32_16x16x32_bf16 v[68:71], v[128:131], a[104:107], v[68:71]
    v_mfma_f32_16x16x32_bf16 v[80:83], v[128:131], a[108:111], v[80:83]
    ds_read_b128 v[128:131], v13 offset:40960
    v_mfma_f32_16x16x32_bf16 v[72:75], v[132:135], a[104:107], v[72:75]
    buffer_load_dwordx4 a[156:159], v4, s[36:39], s67 offen offset:3072 sc1
    v_mfma_f32_16x16x32_bf16 v[84:87], v[132:135], a[108:111], v[84:87]
    ds_read_b128 v[132:135], v13 offset:41984
    s_waitcnt vmcnt(10) lgkmcnt(5)
    v_mfma_f32_16x16x32_bf16 v[64:67], v[136:139], a[112:115], v[64:67]
    v_mfma_f32_16x16x32_bf16 v[76:79], v[136:139], a[116:119], v[76:79]
    ds_read_b128 v[136:139], v14 offset:40960
    v_mfma_f32_16x16x32_bf16 v[68:71], v[140:143], a[112:115], v[68:71]
    v_mfma_f32_16x16x32_bf16 v[80:83], v[140:143], a[116:119], v[80:83]
    ds_read_b128 v[140:143], v13 offset:43520
    v_mfma_f32_16x16x32_bf16 v[72:75], v[144:147], a[112:115], v[72:75]
    v_mfma_f32_16x16x32_bf16 v[84:87], v[144:147], a[116:119], v[84:87]
    ds_read_b128 v[144:147], v13 offset:44544
    s_waitcnt vmcnt(8) lgkmcnt(5)
    v_mfma_f32_16x16x32_bf16 v[64:67], v[204:207], a[120:123], v[64:67]
    v_mfma_f32_16x16x32_bf16 v[76:79], v[204:207], a[124:127], v[76:79]
    ds_read_b128 v[204:207], v14 offset:43520
    v_mfma_f32_16x16x32_bf16 v[68:71], v[208:211], a[120:123], v[68:71]
    v_mfma_f32_16x16x32_bf16 v[80:83], v[208:211], a[124:127], v[80:83]
    ds_read_b128 v[208:211], v13 offset:46080
    v_mfma_f32_16x16x32_bf16 v[72:75], v[212:215], a[120:123], v[72:75]
    v_mfma_f32_16x16x32_bf16 v[84:87], v[212:215], a[124:127], v[84:87]
    ds_read_b128 v[212:215], v13 offset:47104
    s_waitcnt vmcnt(6) lgkmcnt(5)
    v_mfma_f32_16x16x32_bf16 v[64:67], v[128:131], a[128:131], v[64:67]
    v_mfma_f32_16x16x32_bf16 v[76:79], v[128:131], a[132:135], v[76:79]
    ds_read_b128 v[128:131], v14 offset:46080
    v_mfma_f32_16x16x32_bf16 v[68:71], v[132:135], a[128:131], v[68:71]
    v_mfma_f32_16x16x32_bf16 v[80:83], v[132:135], a[132:135], v[80:83]
    ds_read_b128 v[132:135], v13 offset:48640
    v_mfma_f32_16x16x32_bf16 v[72:75], v[136:139], a[128:131], v[72:75]
    v_mfma_f32_16x16x32_bf16 v[84:87], v[136:139], a[132:135], v[84:87]
    ds_read_b128 v[136:139], v13 offset:49664
    s_waitcnt vmcnt(4) lgkmcnt(5)
    v_mfma_f32_16x16x32_bf16 v[64:67], v[140:143], a[136:139], v[64:67]
    v_mfma_f32_16x16x32_bf16 v[76:79], v[140:143], a[140:143], v[76:79]
    ds_read_b128 v[140:143], v14 offset:48640
    v_mfma_f32_16x16x32_bf16 v[68:71], v[144:147], a[136:139], v[68:71]
    v_mfma_f32_16x16x32_bf16 v[80:83], v[144:147], a[140:143], v[80:83]
    v_mfma_f32_16x16x32_bf16 v[72:75], v[204:207], a[136:139], v[72:75]
    v_mfma_f32_16x16x32_bf16 v[84:87], v[204:207], a[140:143], v[84:87]
    s_waitcnt vmcnt(2) lgkmcnt(3)
    v_mfma_f32_16x16x32_bf16 v[64:67], v[208:211], a[144:147], v[64:67]
    v_mfma_f32_16x16x32_bf16 v[76:79], v[208:211], a[148:151], v[76:79]
    v_mfma_f32_16x16x32_bf16 v[68:71], v[212:215], a[144:147], v[68:71]
    v_mfma_f32_16x16x32_bf16 v[80:83], v[212:215], a[148:151], v[80:83]
    v_mfma_f32_16x16x32_bf16 v[72:75], v[128:131], a[144:147], v[72:75]
    v_mfma_f32_16x16x32_bf16 v[84:87], v[128:131], a[148:151], v[84:87]
    s_waitcnt vmcnt(0) lgkmcnt(0)
    v_mfma_f32_16x16x32_bf16 v[64:67], v[132:135], a[152:155], v[64:67]
    v_mfma_f32_16x16x32_bf16 v[76:79], v[132:135], a[156:159], v[76:79]
    v_mfma_f32_16x16x32_bf16 v[68:71], v[136:139], a[152:155], v[68:71]
    v_mfma_f32_16x16x32_bf16 v[80:83], v[136:139], a[156:159], v[80:83]
    v_mfma_f32_16x16x32_bf16 v[72:75], v[140:143], a[152:155], v[72:75]
    v_mfma_f32_16x16x32_bf16 v[84:87], v[140:143], a[156:159], v[84:87]
    s_add_u32 s58, s58, 0x10000
    s_add_u32 s59, s59, 0x10000
    s_mov_b32 s66, s43
    s_mov_b32 s43, s44
    s_mov_b32 s44, s45
    s_mov_b32 s45, s66
    s_mov_b32 s66, s46
    s_mov_b32 s46, s47
    s_mov_b32 s47, s66
    s_cmp_lg_u32 s52, 0
    s_cselect_b32 s94, 0, s94
    v_cvt_pk_bf16_f32 v216, v64, v65
    v_cvt_pk_bf16_f32 v217, v66, v67
    v_cvt_pk_bf16_f32 v218, v68, v69
    v_cvt_pk_bf16_f32 v219, v70, v71
    v_cvt_pk_bf16_f32 v220, v72, v73
    v_cvt_pk_bf16_f32 v221, v74, v75
    v_cvt_pk_bf16_f32 v222, v76, v77
    v_cvt_pk_bf16_f32 v223, v78, v79
    v_cvt_pk_bf16_f32 v224, v80, v81
    v_cvt_pk_bf16_f32 v225, v82, v83
    v_cvt_pk_bf16_f32 v226, v84, v85
    v_cvt_pk_bf16_f32 v227, v86, v87
    s_cmp_eq_u32 s50, 0
    s_nop 1
    s_cbranch_scc1 SLOW19
    buffer_store_dwordx4 v[216:219], v5, s[36:39], s56 offen offset:0
    buffer_store_dwordx4 v[222:225], v5, s[36:39], s56 offen offset:1024
    s_mov_b32 exec_hi, 0
    buffer_store_dwordx2 v[220:221], v6, s[36:39], s56 offen offset:0
    buffer_store_dwordx2 v[226:227], v6, s[36:39], s56 offen offset:1024
    s_mov_b64 exec, -1
BACK20:
    v_lshlrev_b32 v64, 16, v216
    v_and_b32 v65, 0xffff0000, v216
    v_lshlrev_b32 v66, 16, v217
    v_and_b32 v67, 0xffff0000, v217
    v_lshlrev_b32 v68, 16, v218
    v_and_b32 v69, 0xffff0000, v218
    v_lshlrev_b32 v70, 16, v219
    v_and_b32 v71, 0xffff0000, v219
    v_lshlrev_b32 v72, 16, v220
    v_and_b32 v73, 0xffff0000, v220
    v_lshlrev_b32 v74, 16, v221
    v_and_b32 v75, 0xffff0000, v221
    v_lshlrev_b32 v76, 16, v222
    v_and_b32 v77, 0xffff0000, v222
    v_lshlrev_b32 v78, 16, v223
    v_and_b32 v79, 0xffff0000, v223
    v_lshlrev_b32 v80, 16, v224
    v_and_b32 v81, 0xffff0000, v224
    v_lshlrev_b32 v82, 16, v225
    v_and_b32 v83, 0xffff0000, v225
    v_lshlrev_b32 v84, 16, v226
    v_and_b32 v85, 0xffff0000, v226
    v_lshlrev_b32 v86, 16, v227
    v_and_b32 v87, 0xffff0000, v227
    v_add_f32 v228, v72, v73
    v_mul_f32 v229, v72, v72
    v_add_f32 v228, v228, v74
    v_fmac_f32 v229, v73, v73
    v_add_f32 v228, v228, v75
    v_fmac_f32 v229, v74, v74
    v_fmac_f32 v229, v75, v75
    v_add_f32 v230, v84, v85
    v_mul_f32 v231, v84, v84
    v_add_f32 v230, v230, v86
    v_fmac_f32 v231, v85, v85
    v_add_f32 v230, v230, v87
    v_fmac_f32 v231, v86, v86
    v_fmac_f32 v231, v87, v87
    s_mov_b32 exec_lo, 0
    v_mov_b32 v228, 0
    v_mov_b32 v229, 0
    v_mov_b32 v230, 0
    v_mov_b32 v231, 0
    s_mov_b64 exec, -1
    v_add_f32 v228, v228, v64
    v_fmac_f32 v229, v64, v64
    v_add_f32 v228, v228, v65
    v_fmac_f32 v229, v65, v65
    v_add_f32 v228, v228, v66
    v_fmac_f32 v229, v66, v66
    v_add_f32 v228, v228, v67
    v_fmac_f32 v229, v67, v67
    v_add_f32 v228, v228, v68
    v_fmac_f32 v229, v68, v68
    v_add_f32 v228, v228, v69
    v_fmac_f32 v229, v69, v69
    v_add_f32 v228, v228, v70
    v_fmac_f32 v229, v70, v70
    v_add_f32 v228, v228, v71
    v_fmac_f32 v229, v71, v71
    v_add_f32 v230, v230, v76
    v_fmac_f32 v231, v76, v76
    v_add_f32 v230, v230, v77
    v_fmac_f32 v231, v77, v77
    v_add_f32 v230, v230, v78
    v_fmac_f32 v231, v78, v78
    v_add_f32 v230, v230, v79
    v_fmac_f32 v231, v79, v79
    v_add_f32 v230, v230, v80
    v_fmac_f32 v231, v80, v80
    v_add_f32 v230, v230, v81
    v_fmac_f32 v231, v81, v81
    v_add_f32 v230, v230, v82
    v_fmac_f32 v231, v82, v82
    v_add_f32 v230, v230, v83
    v_fmac_f32 v231, v83, v83
    v_permlane32_swap_b32 v228, v229
    s_nop 0
    v_permlane32_swap_b32 v230, v231
    v_add_f32 v228, v228, v229
    v_add_f32 v230, v230, v231
    s_nop 1
    v_permlane16_swap_b32 v228, v230
    v_add_f32 v228, v228, v230
    s_cmp_eq_u32 s50, 0
    s_nop 1
    s_cbranch_scc1 SLOW21
    buffer_store_dword v228, v7, s[36:39], s56 offen
BACK22:
    s_add_u32 s61, s61, 1
    v_mov_b32 v61, s61
    s_waitcnt vmcnt(0)
    s_cmp_eq_u32 s50, 0
    s_nop 0
    s_cbranch_scc1 SLOW23
    s_mov_b64 exec, 1
    buffer_store_dword v61, off, s[36:39], s60
    s_mov_b64 exec, -1
BACK24:
    v_add_u32 v13, s43, v4
    v_add_u32 v14, s44, v4
    ds_read_b128 v[128:131], v13 offset:0
    ds_read_b128 v[132:135], v13 offset:1024
    ds_read_b128 v[136:139], v13 offset:2048
    ds_read_b128 v[140:143], v13 offset:3072
    ds_read_b128 v[144:147], v13 offset:4096
    ds_read_b128 v[204:207], v13 offset:5120
    ds_read_b128 v[208:211], v13 offset:6144
    ds_read_b128 v[212:215], v13 offset:7168
    s_mov_b32 s55, 131072
PXB:
    buffer_load_dword v61, v9, s[36:39], 0 offen sc1
    s_waitcnt vmcnt(0)
    v_cmp_le_u32 vcc, s61, v61
    s_cmp_eq_u64 vcc, -1
    s_nop 3
    s_cbranch_scc1 PXB_done
    s_sub_u32 s55, s55, 1
    s_cmp_eq_u32 s55, 0
    s_cbranch_scc1 ABORT
    s_branch PXB
PXB_done:
    s_add_u32 s67, s56, 0
    buffer_load_dwordx4 a[0:3], v4, s[36:39], s67 offen offset:0 sc1
    buffer_load_dwordx4 a[4:7], v4, s[36:39], s67 offen offset:1024 sc1
    buffer_load_dwordx4 a[8:11], v4, s[36:39], s67 offen offset:2048 sc1
    buffer_load_dwordx4 a[12:15], v4, s[36:39], s67 offen offset:3072 sc1
    s_add_u32 s67, s56, 4096
    buffer_load_dwordx4 a[16:19], v4, s[36:39], s67 offen offset:0 sc1
    buffer_load_dwordx4 a[20:23], v4, s[36:39], s67 offen offset:1024 sc1
    buffer_load_dwordx4 a[24:27], v4, s[36:39], s67 offen offset:2048 sc1
    buffer_load_dwordx4 a[28:31], v4, s[36:39], s67 offen offset:3072 sc1
    s_waitcnt vmcnt(6) lgkmcnt(6)
    v_mfma_f32_16x16x32_bf16 v[88:91], v[128:131], a[0:3], 0
    s_add_u32 s67, s56, 8192
    v_mfma_f32_16x16x32_bf16 v[92:95], v[128:131], a[4:7], 0
    ds_read_b128 v[128:131], v13 offset:8192
    v_mfma_f32_16x16x32_bf16 v[96:99], v[132:135], a[0:3], 0
    buffer_load_dwordx4 a[32:35], v4, s[36:39], s67 offen offset:0 sc1
    v_mfma_f32_16x16x32_bf16 v[100:103], v[132:135], a[4:7], 0
    ds_read_b128 v[132:135], v13 offset:9216
    s_waitcnt lgkmcnt(5)
    v_mfma_f32_16x16x32_bf16 v[104:107], v[136:139], a[0:3], 0
    buffer_load_dwordx4 a[36:39], v4, s[36:39], s67 offen offset:1024 sc1
    v_mfma_f32_16x16x32_bf16 v[108:111], v[136:139], a[4:7], 0
    ds_read_b128 v[136:139], v13 offset:10240
    v_mfma_f32_16x16x32_bf16 v[112:115], a[0:3], v[140:143], 0
    v_mfma_f32_16x16x32_bf16 v[116:119], a[4:7], v[140:143], 0
    ds_read_b128 v[140:143], v13 offset:11264
    v_mfma_f32_16x16x32_bf16 v[120:123], a[0:3], v[144:147], 0
    buffer_load_dwordx4 v[216:219], v8, s[36:39], s56 offen offset:0 sc1
    v_mfma_f32_16x16x32_bf16 v[124:127], a[4:7], v[144:147], 0
    ds_read_b128 v[144:147], v13 offset:12288
    s_waitcnt vmcnt(7) lgkmcnt(6)
    v_mfma_f32_16x16x32_bf16 v[88:91], v[204:207], a[8:11], v[88:91]
    v_mfma_f32_16x16x32_bf16 v[92:95], v[204:207], a[12:15], v[92:95]
    ds_read_b128 v[204:207], v13 offset:13312
    v_mfma_f32_16x16x32_bf16 v[96:99], v[208:211], a[8:11], v[96:99]
    buffer_load_dwordx4 a[40:43], v4, s[36:39], s67 offen offset:2048 sc1
    v_mfma_f32_16x16x32_bf16 v[100:103], v[208:211], a[12:15], v[100:103]
    ds_read_b128 v[208:211], v13 offset:14336
    s_waitcnt lgkmcnt(5)
    v_mfma_f32_16x16x32_bf16 v[104:107], v[212:215], a[8:11], v[104:107]
    buffer_load_dwordx4 a[44:47], v4, s[36:39], s67 offen offset:3072 sc1
    v_mfma_f32_16x16x32_bf16 v[108:111], v[212:215], a[12:15], v[108:111]
    ds_read_b128 v[212:215], v13 offset:15360
    v_mfma_f32_16x16x32_bf16 v[112:115], a[8:11], v[128:131], v[112:115]
    v_mfma_f32_16x16x32_bf16 v[116:119], a[12:15], v[128:131], v[116:119]
    ds_read_b128 v[128:131], v13 offset:16384
    v_mfma_f32_16x16x32_bf16 v[120:123], a[8:11], v[132:135], v[120:123]
    buffer_load_dwordx4 v[220:223], v8, s[36:39], s56 offen offset:1024 sc1
    v_mfma_f32_16x16x32_bf16 v[124:127], a[12:15], v[132:135], v[124:127]
    ds_read_b128 v[132:135], v13 offset:17408
    s_waitcnt vmcnt(8) lgkmcnt(6)
    v_mfma_f32_16x16x32_bf16 v[88:91], v[136:139], a[16:19], v[88:91]
    v_mfma_f32_16x16x32_bf16 v[92:95], v[136:139], a[20:23], v[92:95]
    ds_read_b128 v[136:139], v13 offset:18432
    s_add_u32 s67, s56, 12288
    v_mfma_f32_16x16x32_bf16 v[96:99], v[140:143], a[16:19], v[96:99]
    v_mfma_f32_16x16x32_bf16 v[100:103], v[140:143], a[20:23], v[100:103]
    ds_read_b128 v[140:143], v13 offset:19456
    s_waitcnt lgkmcnt(5)
    v_mfma_f32_16x16x32_bf16 v[104:107], v[144:147], a[16:19], v[104:107]
    buffer_load_dwordx4 a[48:51], v4, s[36:39], s67 offen offset:0 sc1
    v_mfma_f32_16x16x32_bf16 v[108:111], v[144:147], a[20:23], v[108:111]
    ds_read_b128 v[144:147], v13 offset:20480
    v_mfma_f32_16x16x32_bf16 v[112:115], a[16:19], v[204:207], v[112:115]
    buffer_load_dwordx4 a[52:55], v4, s[36:39], s67 offen offset:1024 sc1
    v_mfma_f32_16x16x32_bf16 v[116:119], a[20:23], v[204:207], v[116:119]
    ds_read_b128 v[204:207], v13 offset:21504
    v_mfma_f32_16x16x32_bf16 v[120:123], a[16:19], v[208:211], v[120:123]
    v_mfma_f32_16x16x32_bf16 v[124:127], a[20:23], v[208:211], v[124:127]
    ds_read_b128 v[208:211], v13 offset:22528
    s_waitcnt vmcnt(8) lgkmcnt(6)
    v_mfma_f32_16x16x32_bf16 v[88:91], v[212:215], a[24:27], v[88:91]
    buffer_load_dwordx4 v[224:227], v8, s[36:39], s56 offen offset:2048 sc1
    v_mfma_f32_16x16x32_bf16 v[92:95], v[212:215], a[28:31], v[92:95]
    ds_read_b128 v[212:215], v13 offset:23552
    v_mfma_f32_16x16x32_bf16 v[96:99], v[128:131], a[24:27], v[96:99]
    v_mfma_f32_16x16x32_bf16 v[100:103], v[128:131], a[28:31], v[100:103]
    ds_read_b128 v[128:131], v13 offset:24576
    s_waitcnt lgkmcnt(5)
    v_mfma_f32_16x16x32_bf16 v[104:107], v[132:135], a[24:27], v[104:107]
    buffer_load_dwordx4 a[56:59], v4, s[36:39], s67 offen offset:2048 sc1
    v_mfma_f32_16x16x32_bf16 v[108:111], v[132:135], a[28:31], v[108:111]
    ds_read_b128 v[132:135], v13 offset:25600
    v_mfma_f32_16x16x32_bf16 v[112:115], a[24:27], v[136:139], v[112:115]
    buffer_load_dwordx4 a[60:63], v4, s[36:39], s67 offen offset:3072 sc1
    v_mfma_f32_16x16x32_bf16 v[116:119], a[28:31], v[136:139], v[116:119]
    ds_read_b128 v[136:139], v13 offset:26624
    v_mfma_f32_16x16x32_bf16 v[120:123], a[24:27], v[140:143], v[120:123]
    v_mfma_f32_16x16x32_bf16 v[124:127], a[28:31], v[140:143], v[124:127]
    ds_read_b128 v[140:143], v13 offset:27648
    s_waitcnt vmcnt(9) lgkmcnt(6)
    v_mfma_f32_16x16x32_bf16 v[88:91], v[144:147], a[32:35], v[88:91]
    buffer_load_dwordx4 v[228:231], v8, s[36:39], s56 offen offset:3072 sc1
    v_mfma_f32_16x16x32_bf16 v[92:95], v[144:147], a[36:39], v[92:95]
    ds_read_b128 v[144:147], v13 offset:28672
    v_mfma_f32_16x16x32_bf16 v[96:99], v[204:207], a[32:35], v[96:99]
    s_add_u32 s67, s56, 16384
    v_mfma_f32_16x16x32_bf16 v[100:103], v[204:207], a[36:39], v[100:103]
    ds_read_b128 v[204:207], v13 offset:29696
    s_waitcnt lgkmcnt(5)
    v_mfma_f32_16x16x32_bf16 v[104:107], v[208:211], a[32:35], v[104:107]
    buffer_load_dwordx4 a[64:67], v4, s[36:39], s67 offen offset:0 sc1
    v_mfma_f32_16x16x32_bf16 v[108:111], v[208:211], a[36:39], v[108:111]
    ds_read_b128 v[208:211], v13 offset:30720
    v_mfma_f32_16x16x32_bf16 v[112:115], a[32:35], v[212:215], v[112:115]
    v_mfma_f32_16x16x32_bf16 v[116:119], a[36:39], v[212:215], v[116:119]
    ds_read_b128 v[212:215], v13 offset:31744
    v_mfma_f32_16x16x32_bf16 v[120:123], a[32:35], v[128:131], v[120:123]
    buffer_load_dwordx4 a[68:71], v4, s[36:39], s67 offen offset:1024 sc1
    v_mfma_f32_16x16x32_bf16 v[124:127], a[36:39], v[128:131], v[124:127]
    ds_read_b128 v[128:131], v13 offset:32768
    s_waitcnt vmcnt(9) lgkmcnt(6)
    v_mfma_f32_16x16x32_bf16 v[88:91], v[132:135], a[40:43], v[88:91]
    s_waitcnt vmcnt(2)
    v_add_f32 v216, v216, v220
    v_mfma_f32_16x16x32_bf16 v[92:95], v[132:135], a[44:47], v[92:95]
    ds_read_b128 v[132:135], v13 offset:33792
    v_add_f32 v224, v224, v228
    v_mfma_f32_16x16x32_bf16 v[96:99], v[136:139], a[40:43], v[96:99]
    buffer_load_dwordx4 a[72:75], v4, s[36:39], s67 offen offset:2048 sc1
    v_mfma_f32_16x16x32_bf16 v[100:103], v[136:139], a[44:47], v[100:103]
    ds_read_b128 v[136:139], v13 offset:34816
    s_waitcnt lgkmcnt(5)
    v_mfma_f32_16x16x32_bf16 v[104:107], v[140:143], a[40:43], v[104:107]
    v_add_f32 v217, v217, v221
    v_add_f32 v225, v225, v229
    v_mfma_f32_16x16x32_bf16 v[108:111], v[140:143], a[44:47], v[108:111]
    ds_read_b128 v[140:143], v13 offset:35840
    v_add_f32 v218, v218, v222
    v_mfma_f32_16x16x32_bf16 v[112:115], a[40:43], v[144:147], v[112:115]
    buffer_load_dwordx4 a[76:79], v4, s[36:39], s67 offen offset:3072 sc1
    v_mfma_f32_16x16x32_bf16 v[116:119], a[44:47], v[144:147], v[116:119]
    ds_read_b128 v[144:147], v13 offset:36864
    v_add_f32 v226, v226, v230
    v_mfma_f32_16x16x32_bf16 v[120:123], a[40:43], v[204:207], v[120:123]
    v_add_f32 v219, v219, v223
    s_add_u32 s67, s56, 20480
    v_mfma_f32_16x16x32_bf16 v[124:127], a[44:47], v[204:207], v[124:127]
    ds_read_b128 v[204:207], v13 offset:37888
    s_waitcnt lgkmcnt(6)
    v_mfma_f32_16x16x32_bf16 v[88:91], v[208:211], a[48:51], v[88:91]
    v_add_f32 v227, v227, v231
    v_add_f32 v216, v216, v224
    v_mfma_f32_16x16x32_bf16 v[92:95], v[208:211], a[52:55], v[92:95]
    ds_read_b128 v[208:211], v13 offset:38912
    v_add_f32 v217, v217, v225
    v_mfma_f32_16x16x32_bf16 v[96:99], v[212:215], a[48:51], v[96:99]
    buffer_load_dwordx4 a[80:83], v4, s[36:39], s67 offen offset:0 sc1
    v_mfma_f32_16x16x32_bf16 v[100:103], v[212:215], a[52:55], v[100:103]
    ds_read_b128 v[212:215], v13 offset:39936
    s_waitcnt lgkmcnt(5)
    v_mfma_f32_16x16x32_bf16 v[104:107], v[128:131], a[48:51], v[104:107]
    buffer_load_dwordx4 a[84:87], v4, s[36:39], s67 offen offset:1024 sc1
    v_mfma_f32_16x16x32_bf16 v[108:111], v[128:131], a[52:55], v[108:111]
    ds_read_b128 v[128:131], v13 offset:40960
    v_add_f32 v218, v218, v226
    v_mfma_f32_16x16x32_bf16 v[112:115], a[48:51], v[132:135], v[112:115]
    v_add_f32 v219, v219, v227
    v_permlane32_swap_b32 v216, v217
    v_mfma_f32_16x16x32_bf16 v[116:119], a[52:55], v[132:135], v[116:119]
    ds_read_b128 v[132:135], v13 offset:41984
    v_permlane32_swap_b32 v218, v219
    v_mfma_f32_16x16x32_bf16 v[120:123], a[48:51], v[136:139], v[120:123]
    buffer_load_dwordx4 a[88:91], v4, s[36:39], s67 offen offset:2048 sc1
    v_mfma_f32_16x16x32_bf16 v[124:127], a[52:55], v[136:139], v[124:127]
    ds_read_b128 v[136:139], v13 offset:43008
    s_waitcnt lgkmcnt(6)
    v_mfma_f32_16x16x32_bf16 v[88:91], v[140:143], a[56:59], v[88:91]
    v_add_f32 v216, v216, v217
    v_add_f32 v218, v218, v219
    v_mfma_f32_16x16x32_bf16 v[92:95], v[140:143], a[60:63], v[92:95]
    ds_read_b128 v[140:143], v13 offset:44032
    v_permlane16_swap_b32 v216, v218
    v_mfma_f32_16x16x32_bf16 v[96:99], v[144:147], a[56:59], v[96:99]
    buffer_load_dwordx4 a[92:95], v4, s[36:39], s67 offen offset:3072 sc1
    v_mfma_f32_16x16x32_bf16 v[100:103], v[144:147], a[60:63], v[100:103]
    ds_read_b128 v[144:147], v13 offset:45056
    s_waitcnt lgkmcnt(5)
    v_mfma_f32_16x16x32_bf16 v[104:107], v[204:207], a[56:59], v[104:107]
    s_add_u32 s67, s56, 24576
    v_add_f32 v216, v216, v218
    v_mfma_f32_16x16x32_bf16 v[108:111], v[204:207], a[60:63], v[108:111]
    ds_read_b128 v[204:207], v13 offset:46080
    v_mfma_f32_16x16x32_bf16 v[112:115], a[56:59], v[208:211], v[112:115]
    ds_write_b32 v43, v216
    v_mfma_f32_16x16x32_bf16 v[116:119], a[60:63], v[208:211], v[116:119]
    ds_read_b128 v[208:211], v13 offset:47104
    v_mfma_f32_16x16x32_bf16 v[120:123], a[56:59], v[212:215], v[120:123]
    buffer_load_dwordx4 a[96:99], v4, s[36:39], s67 offen offset:0 sc1
    v_mfma_f32_16x16x32_bf16 v[124:127], a[60:63], v[212:215], v[124:127]
    ds_read_b128 v[212:215], v13 offset:48128
    s_waitcnt vmcnt(7) lgkmcnt(7)
    v_mfma_f32_16x16x32_bf16 v[88:91], v[128:131], a[64:67], v[88:91]
    buffer_load_dwordx4 a[100:103], v4, s[36:39], s67 offen offset:1024 sc1
    v_mfma_f32_16x16x32_bf16 v[92:95], v[128:131], a[68:71], v[92:95]
    ds_read_b128 v[128:131], v13 offset:49152
    ds_read_b128 v[216:219], v44
    v_mfma_f32_16x16x32_bf16 v[96:99], v[132:135], a[64:67], v[96:99]
    ds_read_b128 v[220:223], v45 offset:0
    ds_read_b128 v[224:227], v45 offset:16
    v_mfma_f32_16x16x32_bf16 v[100:103], v[132:135], a[68:71], v[100:103]
    ds_read_b128 v[132:135], v13 offset:50176
    s_waitcnt lgkmcnt(9)
    v_mfma_f32_16x16x32_bf16 v[104:107], v[136:139], a[64:67], v[104:107]
    buffer_load_dwordx4 a[104:107], v4, s[36:39], s67 offen offset:2048 sc1
    v_mfma_f32_16x16x32_bf16 v[108:111], v[136:139], a[68:71], v[108:111]
    ds_read_b128 v[136:139], v14 offset:0
    ds_read_b128 v[228:231], v45 offset:32
    v_mfma_f32_16x16x32_bf16 v[112:115], a[64:67], v[140:143], v[112:115]
    ds_read_b128 v[232:235], v45 offset:48
    v_mfma_f32_16x16x32_bf16 v[116:119], a[68:71], v[140:143], v[116:119]
    ds_read_b128 v[140:143], v14 offset:1024
    v_mfma_f32_16x16x32_bf16 v[120:123], a[64:67], v[144:147], v[120:123]
    buffer_load_dwordx4 a[108:111], v4, s[36:39], s67 offen offset:3072 sc1
    v_mfma_f32_16x16x32_bf16 v[124:127], a[68:71], v[144:147], v[124:127]
    ds_read_b128 v[144:147], v14 offset:2048
    s_waitcnt vmcnt(8) lgkmcnt(11)
    v_mfma_f32_16x16x32_bf16 v[88:91], v[204:207], a[72:75], v[88:91]
    s_add_u32 s67, s56, 28672
    v_mfma_f32_16x16x32_bf16 v[92:95], v[204:207], a[76:79], v[92:95]
    ds_read_b128 v[204:207], v14 offset:3072
    v_mfma_f32_16x16x32_bf16 v[96:99], v[208:211], a[72:75], v[96:99]
    buffer_load_dwordx4 a[112:115], v4, s[36:39], s67 offen offset:0 sc1
    v_mfma_f32_16x16x32_bf16 v[100:103], v[208:211], a[76:79], v[100:103]
    ds_read_b128 v[208:211], v14 offset:4096
    s_waitcnt lgkmcnt(7)
    v_mfma_f32_16x16x32_bf16 v[104:107], v[212:215], a[72:75], v[104:107]
    buffer_load_dwordx4 a[116:119], v4, s[36:39], s67 offen offset:1024 sc1
    v_mfma_f32_16x16x32_bf16 v[108:111], v[212:215], a[76:79], v[108:111]
    ds_read_b128 v[212:215], v14 offset:5120
    v_mfma_f32_16x16x32_bf16 v[112:115], a[72:75], v[128:131], v[112:115]
    s_waitcnt lgkmcnt(5)
    v_mul_f32 v172, 0xbacccccd, v216
    v_mul_f32 v217, 0x3acccccd, v217
    v_mfma_f32_16x16x32_bf16 v[116:119], a[76:79], v[128:131], v[116:119]
    ds_read_b128 v[128:131], v14 offset:6144
    v_fma_f32 v217, -v172, v172, v217
    v_mfma_f32_16x16x32_bf16 v[120:123], a[72:75], v[132:135], v[120:123]
    v_max_f32 v217, 0, v217
    v_add_f32 v217, 0x3727c5ac, v217
    v_mfma_f32_16x16x32_bf16 v[124:127], a[76:79], v[132:135], v[124:127]
    ds_read_b128 v[132:135], v14 offset:7168
    s_waitcnt vmcnt(8)
    s_barrier
    s_waitcnt lgkmcnt(6)
    v_mfma_f32_16x16x32_bf16 v[88:91], v[136:139], a[80:83], v[88:91]
    v_rsq_f32 v173, v217
    v_mfma_f32_16x16x32_bf16 v[92:95], v[136:139], a[84:87], v[92:95]
    ds_read_b128 v[136:139], v14 offset:8192
    v_mul_f32 v176, s70, v173
    v_mfma_f32_16x16x32_bf16 v[96:99], v[140:143], a[80:83], v[96:99]
    buffer_load_dwordx4 a[120:123], v4, s[36:39], s67 offen offset:2048 sc1
    v_mfma_f32_16x16x32_bf16 v[100:103], v[140:143], a[84:87], v[100:103]
    ds_read_b128 v[140:143], v14 offset:9216
    s_waitcnt lgkmcnt(5)
    v_mfma_f32_16x16x32_bf16 v[104:107], v[144:147], a[80:83], v[104:107]
    v_mul_f32 v178, 0xbacccccd, v220
    v_mul_f32 v221, 0x3acccccd, v221
    v_mfma_f32_16x16x32_bf16 v[108:111], v[144:147], a[84:87], v[108:111]
    ds_read_b128 v[144:147], v14 offset:10240
    v_fma_f32 v221, -v178, v178, v221
    v_mfma_f32_16x16x32_bf16 v[112:115], a[80:83], v[204:207], v[112:115]
    buffer_load_dwordx4 a[124:127], v4, s[36:39], s67 offen offset:3072 sc1
    v_mfma_f32_16x16x32_bf16 v[116:119], a[84:87], v[204:207], v[116:119]
    ds_read_b128 v[204:207], v14 offset:11264
    v_max_f32 v221, 0, v221
    v_mfma_f32_16x16x32_bf16 v[120:123], a[80:83], v[208:211], v[120:123]
    s_add_u32 s67, s56, 32768
    v_add_f32 v221, 0x3727c5ac, v221
    v_mfma_f32_16x16x32_bf16 v[124:127], a[84:87], v[208:211], v[124:127]
    ds_read_b128 v[208:211], v14 offset:12288
    s_waitcnt vmcnt(8) lgkmcnt(6)
    v_mfma_f32_16x16x32_bf16 v[88:91], v[212:215], a[88:91], v[88:91]
    buffer_load_dwordx4 a[128:131], v4, s[36:39], s67 offen offset:0 sc1
    v_mfma_f32_16x16x32_bf16 v[92:95], v[212:215], a[92:95], v[92:95]
    ds_read_b128 v[212:215], v14 offset:13312
    v_mfma_f32_16x16x32_bf16 v[96:99], v[128:131], a[88:91], v[96:99]
    v_rsq_f32 v186, v221
    v_mfma_f32_16x16x32_bf16 v[100:103], v[128:131], a[92:95], v[100:103]
    ds_read_b128 v[128:131], v14 offset:14336
    s_waitcnt lgkmcnt(5)
    v_mfma_f32_16x16x32_bf16 v[104:107], v[132:135], a[88:91], v[104:107]
    v_mul_f32 v194, s70, v186
    v_mul_f32 v179, 0xbacccccd, v224
    v_mfma_f32_16x16x32_bf16 v[108:111], v[132:135], a[92:95], v[108:111]
    ds_read_b128 v[132:135], v14 offset:15360
    v_mul_f32 v225, 0x3acccccd, v225
    v_mfma_f32_16x16x32_bf16 v[112:115], a[88:91], v[136:139], v[112:115]
    buffer_load_dwordx4 a[132:135], v4, s[36:39], s67 offen offset:1024 sc1
    v_mfma_f32_16x16x32_bf16 v[116:119], a[92:95], v[136:139], v[116:119]
    ds_read_b128 v[136:139], v14 offset:16384
    v_fma_f32 v225, -v179, v179, v225
    v_mfma_f32_16x16x32_bf16 v[120:123], a[88:91], v[140:143], v[120:123]
    buffer_load_dwordx4 a[136:139], v4, s[36:39], s67 offen offset:2048 sc1
    v_mfma_f32_16x16x32_bf16 v[124:127], a[92:95], v[140:143], v[124:127]
    ds_read_b128 v[140:143], v14 offset:17408
    s_waitcnt vmcnt(9) lgkmcnt(6)
    v_mfma_f32_16x16x32_bf16 v[88:91], v[144:147], a[96:99], v[88:91]
    v_max_f32 v225, 0, v225
    v_add_f32 v225, 0x3727c5ac, v225
    v_mfma_f32_16x16x32_bf16 v[92:95], v[144:147], a[100:103], v[92:95]
    ds_read_b128 v[144:147], v14 offset:18432
    v_mfma_f32_16x16x32_bf16 v[96:99], v[204:207], a[96:99], v[96:99]
    buffer_load_dwordx4 a[140:143], v4, s[36:39], s67 offen offset:3072 sc1
    v_mfma_f32_16x16x32_bf16 v[100:103], v[204:207], a[100:103], v[100:103]
    ds_read_b128 v[204:207], v14 offset:19456
    v_rsq_f32 v187, v225
    s_waitcnt lgkmcnt(5)
    v_mfma_f32_16x16x32_bf16 v[104:107], v[208:211], a[96:99], v[104:107]
    s_add_u32 s67, s56, 36864
    v_mul_f32 v195, s70, v187
    v_mfma_f32_16x16x32_bf16 v[108:111], v[208:211], a[100:103], v[108:111]
    ds_read_b128 v[208:211], v14 offset:20480
    v_mul_f32 v180, 0xbacccccd, v228
    v_mfma_f32_16x16x32_bf16 v[112:115], a[96:99], v[212:215], v[112:115]
    buffer_load_dwordx4 a[144:147], v4, s[36:39], s67 offen offset:0 sc1
    v_mfma_f32_16x16x32_bf16 v[116:119], a[100:103], v[212:215], v[116:119]
    ds_read_b128 v[212:215], v14 offset:21504
    v_mul_f32 v229, 0x3acccccd, v229
    v_mfma_f32_16x16x32_bf16 v[120:123], a[96:99], v[128:131], v[120:123]
    v_fma_f32 v229, -v180, v180, v229
    v_max_f32 v229, 0, v229
    v_mfma_f32_16x16x32_bf16 v[124:127], a[100:103], v[128:131], v[124:127]
    ds_read_b128 v[128:131], v14 offset:22528
    s_waitcnt vmcnt(9) lgkmcnt(6)
    v_mfma_f32_16x16x32_bf16 v[88:91], v[132:135], a[104:107], v[88:91]
    buffer_load_dwordx4 a[148:151], v4, s[36:39], s67 offen offset:1024 sc1
    v_mfma_f32_16x16x32_bf16 v[92:95], v[132:135], a[108:111], v[92:95]
    ds_read_b128 v[132:135], v14 offset:23552
    buffer_load_dwordx4 a[152:155], v4, s[36:39], s67 offen offset:2048 sc1
    buffer_load_dwordx4 a[156:159], v4, s[36:39], s67 offen offset:3072 sc1
    v_mfma_f32_16x16x32_bf16 v[96:99], v[136:139], a[104:107], v[96:99]
    v_add_f32 v229, 0x3727c5ac, v229
    s_add_u32 s90, s45, s48
    v_mfma_f32_16x16x32_bf16 v[100:103], v[136:139], a[108:111], v[100:103]
    ds_read_b128 v[136:139], v14 offset:24576
    s_waitcnt lgkmcnt(5)
    v_mfma_f32_16x16x32_bf16 v[104:107], v[140:143], a[104:107], v[104:107]
    v_rsq_f32 v188, v229
    v_mfma_f32_16x16x32_bf16 v[108:111], v[140:143], a[108:111], v[108:111]
    ds_read_b128 v[140:143], v14 offset:25600
    v_mul_f32 v196, s70, v188
    v_mfma_f32_16x16x32_bf16 v[112:115], a[104:107], v[144:147], v[112:115]
    v_mul_f32 v181, 0xbacccccd, v232
    v_mul_f32 v233, 0x3acccccd, v233
    v_mfma_f32_16x16x32_bf16 v[116:119], a[108:111], v[144:147], v[116:119]
    ds_read_b128 v[144:147], v14 offset:26624
    v_fma_f32 v233, -v181, v181, v233
    v_mfma_f32_16x16x32_bf16 v[120:123], a[104:107], v[204:207], v[120:123]
    s_add_u32 s91, s46, s48
    v_max_f32 v233, 0, v233
    v_mfma_f32_16x16x32_bf16 v[124:127], a[108:111], v[204:207], v[124:127]
    ds_read_b128 v[204:207], v14 offset:27648
    s_waitcnt vmcnt(10) lgkmcnt(6)
    v_mfma_f32_16x16x32_bf16 v[88:91], v[208:211], a[112:115], v[88:91]
    s_add_u32 m0, s90, 0
    v_add_f32 v233, 0x3727c5ac, v233
    v_mfma_f32_16x16x32_bf16 v[92:95], v[208:211], a[116:119], v[92:95]
    ds_read_b128 v[208:211], v14 offset:28672
    s_add_u32 s69, s91, 102400
    v_mfma_f32_16x16x32_bf16 v[96:99], v[212:215], a[112:115], v[96:99]
    v_rsq_f32 v189, v233
    v_mfma_f32_16x16x32_bf16 v[100:103], v[212:215], a[116:119], v[100:103]
    ds_read_b128 v[212:215], v14 offset:29696
    s_waitcnt lgkmcnt(5)
    v_mfma_f32_16x16x32_bf16 v[104:107], v[128:131], a[112:115], v[104:107]
    buffer_load_dwordx4 v4, s[36:39], s69 offen offset:0 lds
    v_mfma_f32_16x16x32_bf16 v[108:111], v[128:131], a[116:119], v[108:111]
    ds_read_b128 v[128:131], v14 offset:30720
    v_mul_f32 v197, s70, v189
    v_mfma_f32_16x16x32_bf16 v[112:115], a[112:115], v[132:135], v[112:115]
    v_mul_f32 v174, 0xbacccccd, v218
    v_mul_f32 v219, 0x3acccccd, v219
    v_mfma_f32_16x16x32_bf16 v[116:119], a[116:119], v[132:135], v[116:119]
    ds_read_b128 v[132:135], v14 offset:31744
    v_fma_f32 v219, -v174, v174, v219
    v_mfma_f32_16x16x32_bf16 v[120:123], a[112:115], v[136:139], v[120:123]
    buffer_load_dwordx4 v4, s[36:39], s69 offen offset:1024 lds
    v_mfma_f32_16x16x32_bf16 v[124:127], a[116:119], v[136:139], v[124:127]
    ds_read_b128 v[136:139], v14 offset:32768
    s_waitcnt vmcnt(10) lgkmcnt(6)
    v_mfma_f32_16x16x32_bf16 v[88:91], v[140:143], a[120:123], v[88:91]
    v_max_f32 v219, 0, v219
    v_add_f32 v219, 0x3727c5ac, v219
    v_mfma_f32_16x16x32_bf16 v[92:95], v[140:143], a[124:127], v[92:95]
    ds_read_b128 v[140:143], v14 offset:33792
    v_mfma_f32_16x16x32_bf16 v[96:99], v[144:147], a[120:123], v[96:99]
    buffer_load_dwordx4 v4, s[36:39], s69 offen offset:2048 lds
    v_mfma_f32_16x16x32_bf16 v[100:103], v[144:147], a[124:127], v[100:103]
    ds_read_b128 v[144:147], v14 offset:34816
    s_waitcnt lgkmcnt(5)
    v_mfma_f32_16x16x32_bf16 v[104:107], v[204:207], a[120:123], v[104:107]
    v_rsq_f32 v175, v219
    v_mfma_f32_16x16x32_bf16 v[108:111], v[204:207], a[124:127], v[108:111]
    ds_read_b128 v[204:207], v14 offset:35840
    v_mul_f32 v177, s70, v175
    v_mfma_f32_16x16x32_bf16 v[112:115], a[120:123], v[208:211], v[112:115]
    buffer_load_dwordx4 v4, s[36:39], s69 offen offset:3072 lds
    v_mfma_f32_16x16x32_bf16 v[116:119], a[124:127], v[208:211], v[116:119]
    ds_read_b128 v[208:211], v14 offset:36864
    v_mul_f32 v182, 0xbacccccd, v222
    v_mfma_f32_16x16x32_bf16 v[120:123], a[120:123], v[212:215], v[120:123]
    s_add_u32 m0, s90, 4096
    v_mul_f32 v223, 0x3acccccd, v223
    v_mfma_f32_16x16x32_bf16 v[124:127], a[124:127], v[212:215], v[124:127]
    ds_read_b128 v[212:215], v14 offset:37888
    s_waitcnt vmcnt(10) lgkmcnt(6)
    v_mfma_f32_16x16x32_bf16 v[88:91], v[128:131], a[128:131], v[88:91]
    v_fma_f32 v223, -v182, v182, v223
    s_add_u32 s69, s91, 106496
    v_mfma_f32_16x16x32_bf16 v[92:95], v[128:131], a[132:135], v[92:95]
    ds_read_b128 v[128:131], v14 offset:38912
    v_max_f32 v223, 0, v223
    v_mfma_f32_16x16x32_bf16 v[96:99], v[132:135], a[128:131], v[96:99]
    buffer_load_dwordx4 v4, s[36:39], s69 offen offset:0 lds
    v_mfma_f32_16x16x32_bf16 v[100:103], v[132:135], a[132:135], v[100:103]
    ds_read_b128 v[132:135], v14 offset:39936
    s_waitcnt lgkmcnt(5)
    v_mfma_f32_16x16x32_bf16 v[104:107], v[136:139], a[128:131], v[104:107]
    v_add_f32 v223, 0x3727c5ac, v223
    v_mfma_f32_16x16x32_bf16 v[108:111], v[136:139], a[132:135], v[108:111]
    ds_read_b128 v[136:139], v14 offset:40960
    v_mfma_f32_16x16x32_bf16 v[112:115], a[128:131], v[140:143], v[112:115]
    v_rsq_f32 v190, v223
    v_mfma_f32_16x16x32_bf16 v[116:119], a[132:135], v[140:143], v[116:119]
    ds_read_b128 v[140:143], v14 offset:41984
    v_mul_f32 v198, s70, v190
    v_mfma_f32_16x16x32_bf16 v[120:123], a[128:131], v[144:147], v[120:123]
    buffer_load_dwordx4 v4, s[36:39], s69 offen offset:1024 lds
    v_mfma_f32_16x16x32_bf16 v[124:127], a[132:135], v[144:147], v[124:127]
    ds_read_b128 v[144:147], v14 offset:43008
    s_waitcnt vmcnt(10) lgkmcnt(6)
    v_mfma_f32_16x16x32_bf16 v[88:91], v[204:207], a[136:139], v[88:91]
    v_mul_f32 v183, 0xbacccccd, v226
    v_mul_f32 v227, 0x3acccccd, v227
    v_mfma_f32_16x16x32_bf16 v[92:95], v[204:207], a[140:143], v[92:95]
    ds_read_b128 v[204:207], v14 offset:44032
    v_fma_f32 v227, -v183, v183, v227
    v_mfma_f32_16x16x32_bf16 v[96:99], v[208:211], a[136:139], v[96:99]
    buffer_load_dwordx4 v4, s[36:39], s69 offen offset:2048 lds
    v_mfma_f32_16x16x32_bf16 v[100:103], v[208:211], a[140:143], v[100:103]
    ds_read_b128 v[208:211], v14 offset:45056
    s_waitcnt lgkmcnt(5)
    v_mfma_f32_16x16x32_bf16 v[104:107], v[212:215], a[136:139], v[104:107]
    v_max_f32 v227, 0, v227
    v_add_f32 v227, 0x3727c5ac, v227
    v_mfma_f32_16x16x32_bf16 v[108:111], v[212:215], a[140:143], v[108:111]
    ds_read_b128 v[212:215], v14 offset:46080
    v_mfma_f32_16x16x32_bf16 v[112:115], a[136:139], v[128:131], v[112:115]
    buffer_load_dwordx4 v4, s[36:39], s69 offen offset:3072 lds
    v_mfma_f32_16x16x32_bf16 v[116:119], a[140:143], v[128:131], v[116:119]
    ds_read_b128 v[128:131], v14 offset:47104
    s_add_u32 m0, s90, 8192
    v_mfma_f32_16x16x32_bf16 v[120:123], a[136:139], v[132:135], v[120:123]
    v_rsq_f32 v191, v227
    v_mfma_f32_16x16x32_bf16 v[124:127], a[140:143], v[132:135], v[124:127]
    ds_read_b128 v[132:135], v14 offset:48128
    s_waitcnt vmcnt(10) lgkmcnt(6)
    v_mfma_f32_16x16x32_bf16 v[88:91], v[136:139], a[144:147], v[88:91]
    v_mul_f32 v199, s70, v191
    s_add_u32 s69, s91, 110592
    v_mfma_f32_16x16x32_bf16 v[92:95], v[136:139], a[148:151], v[92:95]
    ds_read_b128 v[136:139], v14 offset:49152
    v_mul_f32 v184, 0xbacccccd, v230
    v_mfma_f32_16x16x32_bf16 v[96:99], v[140:143], a[144:147], v[96:99]
    buffer_load_dwordx4 v4, s[36:39], s69 offen offset:0 lds
    v_mfma_f32_16x16x32_bf16 v[100:103], v[140:143], a[148:151], v[100:103]
    ds_read_b128 v[140:143], v14 offset:50176
    v_mul_f32 v231, 0x3acccccd, v231
    s_waitcnt lgkmcnt(5)
    v_mfma_f32_16x16x32_bf16 v[104:107], v[144:147], a[144:147], v[104:107]
    v_fma_f32 v231, -v184, v184, v231
    v_max_f32 v231, 0, v231
    v_mfma_f32_16x16x32_bf16 v[108:111], v[144:147], a[148:151], v[108:111]
    buffer_load_dwordx4 v4, s[36:39], s69 offen offset:1024 lds
    v_mfma_f32_16x16x32_bf16 v[112:115], a[144:147], v[204:207], v[112:115]
    v_add_f32 v231, 0x3727c5ac, v231
    v_mfma_f32_16x16x32_bf16 v[116:119], a[148:151], v[204:207], v[116:119]
    v_rsq_f32 v192, v231
    v_mfma_f32_16x16x32_bf16 v[120:123], a[144:147], v[208:211], v[120:123]
    buffer_load_dwordx4 v4, s[36:39], s69 offen offset:2048 lds
    v_mfma_f32_16x16x32_bf16 v[124:127], a[148:151], v[208:211], v[124:127]
    v_mul_f32 v200, s70, v192
    s_waitcnt vmcnt(11) lgkmcnt(3)
    v_mfma_f32_16x16x32_bf16 v[88:91], v[212:215], a[152:155], v[88:91]
    v_mul_f32 v185, 0xbacccccd, v234
    v_mul_f32 v235, 0x3acccccd, v235
    v_mfma_f32_16x16x32_bf16 v[92:95], v[212:215], a[156:159], v[92:95]
    buffer_load_dwordx4 v4, s[36:39], s69 offen offset:3072 lds
    v_mfma_f32_16x16x32_bf16 v[96:99], v[128:131], a[152:155], v[96:99]
    v_fma_f32 v235, -v185, v185, v235
    s_add_u32 m0, s90, 12288
    v_mfma_f32_16x16x32_bf16 v[100:103], v[128:131], a[156:159], v[100:103]
    v_max_f32 v235, 0, v235
    s_waitcnt lgkmcnt(0)
    v_mfma_f32_16x16x32_bf16 v[104:107], v[132:135], a[152:155], v[104:107]
    v_add_f32 v235, 0x3727c5ac, v235
    s_add_u32 s69, s91, 114688
    v_mfma_f32_16x16x32_bf16 v[108:111], v[132:135], a[156:159], v[108:111]
    v_rsq_f32 v193, v235
    buffer_load_dwordx4 v4, s[36:39], s69 offen offset:0 lds
    v_mul_f32 v201, s70, v193
    v_mfma_f32_16x16x32_bf16 v[112:115], a[152:155], v[136:139], v[112:115]
    v_mfma_f32_16x16x32_bf16 v[116:119], a[156:159], v[136:139], v[116:119]
    v_mfma_f32_16x16x32_bf16 v[120:123], a[152:155], v[140:143], v[120:123]
    v_mfma_f32_16x16x32_bf16 v[124:127], a[156:159], v[140:143], v[124:127]
    ds_read_b128 v[202:205], v47 offset:512
    ds_read_b128 v[206:209], v47 offset:576
    ds_read_b128 v[210:213], v47 offset:640
    ds_read_b32 v214, v46 offset:704
    ds_read_b32 v215, v46 offset:768
    s_waitcnt lgkmcnt(0)
    v_fma_f32 v88, v172, v202, v88
    v_mul_f32 v88, v173, v88
    v_fma_f32 v89, v172, v203, v89
    v_mul_f32 v89, v173, v89
    v_fma_f32 v90, v172, v204, v90
    v_mul_f32 v90, v173, v90
    v_fma_f32 v91, v172, v205, v91
    v_mul_f32 v91, v173, v91
    v_cvt_pk_bf16_f32 v128, v88, v89
    v_cvt_pk_bf16_f32 v129, v90, v91
    v_fma_f32 v92, v174, v202, v92
    v_mul_f32 v92, v175, v92
    v_fma_f32 v93, v174, v203, v93
    v_mul_f32 v93, v175, v93
    v_fma_f32 v94, v174, v204, v94
    v_mul_f32 v94, v175, v94
    v_fma_f32 v95, v174, v205, v95
    v_mul_f32 v95, v175, v95
    v_cvt_pk_bf16_f32 v132, v92, v93
    v_cvt_pk_bf16_f32 v133, v94, v95
    v_fma_f32 v96, v172, v206, v96
    v_mul_f32 v96, v173, v96
    v_fma_f32 v97, v172, v207, v97
    v_mul_f32 v97, v173, v97
    v_fma_f32 v98, v172, v208, v98
    v_mul_f32 v98, v173, v98
    v_fma_f32 v99, v172, v209, v99
    v_mul_f32 v99, v173, v99
    s_add_u32 s90, s43, s48
    s_add_u32 s91, s46, s48
    s_add_u32 m0, s90, 0
    s_add_u32 s69, s91, 153600
    buffer_load_dwordx4 v4, s[36:39], s69 offen offset:0 lds
    v_cvt_pk_bf16_f32 v130, v96, v97
    v_cvt_pk_bf16_f32 v131, v98, v99
    v_fma_f32 v100, v174, v206, v100
    v_mul_f32 v100, v175, v100
    v_fma_f32 v101, v174, v207, v101
    v_mul_f32 v101, v175, v101
    v_fma_f32 v102, v174, v208, v102
    v_mul_f32 v102, v175, v102
    v_fma_f32 v103, v174, v209, v103
    v_mul_f32 v103, v175, v103
    v_cvt_pk_bf16_f32 v134, v100, v101
    v_cvt_pk_bf16_f32 v135, v102, v103
    v_fma_f32 v104, v172, v210, v104
    v_mul_f32 v104, v173, v104
    v_fma_f32 v105, v172, v211, v105
    v_mul_f32 v105, v173, v105
    v_fma_f32 v106, v172, v212, v106
    v_mul_f32 v106, v173, v106
    v_fma_f32 v107, v172, v213, v107
    v_mul_f32 v107, v173, v107
    v_cvt_pk_bf16_f32 v136, v104, v105
    v_cvt_pk_bf16_f32 v137, v106, v107
    v_fma_f32 v108, v174, v210, v108
    v_mul_f32 v108, v175, v108
    v_fma_f32 v109, v174, v211, v109
    v_mul_f32 v109, v175, v109
    v_fma_f32 v110, v174, v212, v110
    v_mul_f32 v110, v175, v110
    buffer_load_dwordx4 v4, s[36:39], s69 offen offset:1024 lds
    v_fma_f32 v111, v174, v213, v111
    v_mul_f32 v111, v175, v111
    v_cvt_pk_bf16_f32 v138, v108, v109
    v_cvt_pk_bf16_f32 v139, v110, v111
    v_fma_f32 v112, v178, v214, v112
    v_mul_f32 v112, v186, v112
    v_fma_f32 v113, v179, v214, v113
    v_mul_f32 v113, v187, v113
    v_fma_f32 v114, v180, v214, v114
    v_mul_f32 v114, v188, v114
    v_fma_f32 v115, v181, v214, v115
    v_mul_f32 v115, v189, v115
    v_fma_f32 v116, v182, v214, v116
    v_mul_f32 v116, v190, v116
    v_fma_f32 v117, v183, v214, v117
    v_mul_f32 v117, v191, v117
    v_fma_f32 v118, v184, v214, v118
    v_mul_f32 v118, v192, v118
    v_fma_f32 v119, v185, v214, v119
    v_mul_f32 v119, v193, v119
    v_cvt_pk_bf16_f32 v140, v112, v113
    v_cvt_pk_bf16_f32 v141, v114, v115
    v_cvt_pk_bf16_f32 v142, v116, v117
    v_cvt_pk_bf16_f32 v143, v118, v119
    v_fma_f32 v120, v178, v215, v120
    v_mul_f32 v120, v186, v120
    v_fma_f32 v121, v179, v215, v121
    v_mul_f32 v121, v187, v121
    buffer_load_dwordx4 v4, s[36:39], s69 offen offset:2048 lds
    v_fma_f32 v122, v180, v215, v122
    v_mul_f32 v122, v188, v122
    v_fma_f32 v123, v181, v215, v123
    v_mul_f32 v123, v189, v123
    v_fma_f32 v124, v182, v215, v124
    v_mul_f32 v124, v190, v124
    v_fma_f32 v125, v183, v215, v125
    v_mul_f32 v125, v191, v125
    v_fma_f32 v126, v184, v215, v126
    v_mul_f32 v126, v192, v126
    v_fma_f32 v127, v185, v215, v127
    v_mul_f32 v127, v193, v127
    v_cvt_pk_bf16_f32 v144, v120, v121
    v_cvt_pk_bf16_f32 v145, v122, v123
    v_cvt_pk_bf16_f32 v146, v124, v125
    v_cvt_pk_bf16_f32 v147, v126, v127
    v_mfma_f32_16x16x32_bf16 v[148:151], v[136:139], a[230:233], 0
    v_mfma_f32_16x16x32_bf16 v[152:155], v[136:139], a[228:231], 0
    v_mfma_f32_16x16x32_bf16 v[88:91], a[160:163], v[128:131], 0
    v_mfma_f32_16x16x32_bf16 v[92:95], a[164:167], v[128:131], 0
    v_mfma_f32_16x16x32_bf16 v[96:99], a[168:171], v[128:131], 0
    v_mfma_f32_16x16x32_bf16 v[100:103], a[172:175], v[128:131], 0
    v_mfma_f32_16x16x32_bf16 v[104:107], a[176:179], v[128:131], 0
    v_mfma_f32_16x16x32_bf16 v[88:91], a[180:183], v[132:135], v[88:91]
    v_mfma_f32_16x16x32_bf16 v[92:95], a[184:187], v[132:135], v[92:95]
    v_mfma_f32_16x16x32_bf16 v[96:99], a[188:191], v[132:135], v[96:99]
    v_mfma_f32_16x16x32_bf16 v[100:103], a[192:195], v[132:135], v[100:103]
    v_mfma_f32_16x16x32_bf16 v[104:107], a[196:199], v[132:135], v[104:107]
    buffer_load_dwordx4 v4, s[36:39], s69 offen offset:3072 lds
    v_mfma_f32_16x16x32_bf16 v[88:91], a[200:203], v[136:139], v[88:91]
    v_mfma_f32_16x16x32_bf16 v[92:95], a[204:207], v[136:139], v[92:95]
    v_mfma_f32_16x16x32_bf16 v[96:99], a[208:211], v[136:139], v[96:99]
    v_mfma_f32_16x16x32_bf16 v[100:103], a[212:215], v[136:139], v[100:103]
    v_mfma_f32_16x16x32_bf16 v[104:107], a[216:219], v[136:139], v[104:107]
    s_nop 3
    v_max_f32 v61, v88, v89
    v_min_f32 v62, v88, v89
    v_max3_f32 v61, v61, v90, v91
    v_min3_f32 v62, v62, v90, v91
    v_max3_f32 v61, v61, v92, v93
    v_min3_f32 v62, v62, v92, v93
    v_max3_f32 v61, v61, v94, v95
    v_min3_f32 v62, v62, v94, v95
    v_max3_f32 v61, v61, v96, v97
    v_min3_f32 v62, v62, v96, v97
    v_max3_f32 v61, v61, v98, v99
    v_min3_f32 v62, v62, v98, v99
    v_max3_f32 v61, v61, v100, v101
    v_min3_f32 v62, v62, v100, v101
    v_max3_f32 v61, v61, v102, v103
    v_min3_f32 v62, v62, v102, v103
    v_max3_f32 v61, v61, v104, v105
    v_min3_f32 v62, v62, v104, v105
    v_max3_f32 v61, v61, v106, v107
    v_min3_f32 v62, v62, v106, v107
    v_mul_f32 v61, s74, v61
    v_mul_f32 v62, s70, v62
    v_fma_f32 v108, v88, s74, v62
    s_add_u32 m0, s90, 4096
    s_add_u32 s69, s91, 157696
    buffer_load_dwordx4 v4, s[36:39], s69 offen offset:0 lds
    v_fma_f32 v88, v88, s70, v61
    v_fma_f32 v109, v89, s74, v62
    v_fma_f32 v89, v89, s70, v61
    v_fma_f32 v110, v90, s74, v62
    v_fma_f32 v90, v90, s70, v61
    v_fma_f32 v111, v91, s74, v62
    v_fma_f32 v91, v91, s70, v61
    v_fma_f32 v112, v92, s74, v62
    v_fma_f32 v92, v92, s70, v61
    v_fma_f32 v113, v93, s74, v62
    v_fma_f32 v93, v93, s70, v61
    v_fma_f32 v114, v94, s74, v62
    v_fma_f32 v94, v94, s70, v61
    v_fma_f32 v115, v95, s74, v62
    v_fma_f32 v95, v95, s70, v61
    v_fma_f32 v116, v96, s74, v62
    v_fma_f32 v96, v96, s70, v61
    v_fma_f32 v117, v97, s74, v62
    v_fma_f32 v97, v97, s70, v61
    v_fma_f32 v118, v98, s74, v62
    v_fma_f32 v98, v98, s70, v61
    v_fma_f32 v119, v99, s74, v62
    v_fma_f32 v99, v99, s70, v61
    v_fma_f32 v120, v100, s74, v62
    v_fma_f32 v100, v100, s70, v61
    v_fma_f32 v121, v101, s74, v62
    v_fma_f32 v101, v101, s70, v61
    v_fma_f32 v122, v102, s74, v62
    buffer_load_dwordx4 v4, s[36:39], s69 offen offset:1024 lds
    v_fma_f32 v102, v102, s70, v61
    v_fma_f32 v123, v103, s74, v62
    v_fma_f32 v103, v103, s70, v61
    v_fma_f32 v124, v104, s74, v62
    v_fma_f32 v104, v104, s70, v61
    v_fma_f32 v125, v105, s74, v62
    v_fma_f32 v105, v105, s70, v61
    v_fma_f32 v126, v106, s74, v62
    v_fma_f32 v106, v106, s70, v61
    v_fma_f32 v127, v107, s74, v62
    v_fma_f32 v107, v107, s70, v61
    v_exp_f32 v88, v88
    v_exp_f32 v108, v108
    v_exp_f32 v89, v89
    v_exp_f32 v109, v109
    v_exp_f32 v90, v90
    v_exp_f32 v110, v110
    v_exp_f32 v91, v91
    v_exp_f32 v111, v111
    v_exp_f32 v92, v92
    v_exp_f32 v112, v112
    v_exp_f32 v93, v93
    v_exp_f32 v113, v113
    v_exp_f32 v94, v94
    v_exp_f32 v114, v114
    v_exp_f32 v95, v95
    v_exp_f32 v115, v115
    buffer_load_dwordx4 v4, s[36:39], s69 offen offset:2048 lds
    v_exp_f32 v96, v96
    v_exp_f32 v116, v116
    v_exp_f32 v97, v97
    v_exp_f32 v117, v117
    v_exp_f32 v98, v98
    v_exp_f32 v118, v118
    v_exp_f32 v99, v99
    v_exp_f32 v119, v119
    v_exp_f32 v100, v100
    v_exp_f32 v120, v120
    v_exp_f32 v101, v101
    v_exp_f32 v121, v121
    v_exp_f32 v102, v102
    v_exp_f32 v122, v122
    v_exp_f32 v103, v103
    v_exp_f32 v123, v123
    v_exp_f32 v104, v104
    v_exp_f32 v124, v124
    v_exp_f32 v105, v105
    v_exp_f32 v125, v125
    v_exp_f32 v106, v106
    v_exp_f32 v126, v126
    v_exp_f32 v107, v107
    v_exp_f32 v127, v127
    v_add_f32 v61, v88, v89
    v_add_f32 v62, v108, v109
    v_add_f32 v61, v61, v90
    v_add_f32 v62, v62, v110
    buffer_load_dwordx4 v4, s[36:39], s69 offen offset:3072 lds
    v_add_f32 v61, v61, v91
    v_add_f32 v62, v62, v111
    v_add_f32 v61, v61, v92
    v_add_f32 v62, v62, v112
    v_add_f32 v61, v61, v93
    v_add_f32 v62, v62, v113
    v_add_f32 v61, v61, v94
    v_add_f32 v62, v62, v114
    v_add_f32 v61, v61, v95
    v_add_f32 v62, v62, v115
    v_add_f32 v61, v61, v96
    v_add_f32 v62, v62, v116
    v_add_f32 v61, v61, v97
    v_add_f32 v62, v62, v117
    v_add_f32 v61, v61, v98
    v_add_f32 v62, v62, v118
    v_add_f32 v61, v61, v99
    v_add_f32 v62, v62, v119
    v_add_f32 v61, v61, v100
    v_add_f32 v62, v62, v120
    v_add_f32 v61, v61, v101
    v_add_f32 v62, v62, v121
    v_add_f32 v61, v61, v102
    v_add_f32 v62, v62, v122
    v_add_f32 v61, v61, v103
    v_add_f32 v62, v62, v123
    v_add_f32 v61, v61, v104
    v_add_f32 v62, v62, v124
    s_add_u32 m0, s90, 8192
    s_add_u32 s69, s91, 161792
    buffer_load_dwordx4 v4, s[36:39], s69 offen offset:0 lds
    v_add_f32 v61, v61, v105
    v_add_f32 v62, v62, v125
    v_add_f32 v61, v61, v106
    v_add_f32 v62, v62, v126
    v_add_f32 v61, v61, v107
    v_add_f32 v62, v62, v127
    v_rcp_f32 v61, v61
    v_rcp_f32 v62, v62
    v_mul_f32 v88, v61, v88
    v_mul_f32 v108, v62, v108
    v_mul_f32 v89, v61, v89
    v_mul_f32 v109, v62, v109
    v_mul_f32 v90, v61, v90
    v_mul_f32 v110, v62, v110
    v_mul_f32 v91, v61, v91
    v_mul_f32 v111, v62, v111
    v_mul_f32 v92, v61, v92
    v_mul_f32 v112, v62, v112
    v_mul_f32 v93, v61, v93
    v_mul_f32 v113, v62, v113
    v_mul_f32 v94, v61, v94
    v_mul_f32 v114, v62, v114
    v_mul_f32 v95, v61, v95
    v_mul_f32 v115, v62, v115
    v_mul_f32 v96, v61, v96
    v_mul_f32 v116, v62, v116
    v_mul_f32 v97, v61, v97
    v_mul_f32 v117, v62, v117
    buffer_load_dwordx4 v4, s[36:39], s69 offen offset:1024 lds
    v_mul_f32 v98, v61, v98
    v_mul_f32 v118, v62, v118
    v_mul_f32 v99, v61, v99
    v_mul_f32 v119, v62, v119
    v_mul_f32 v100, v61, v100
    v_mul_f32 v120, v62, v120
    v_mul_f32 v101, v61, v101
    v_mul_f32 v121, v62, v121
    v_mul_f32 v102, v61, v102
    v_mul_f32 v122, v62, v122
    v_mul_f32 v103, v61, v103
    v_mul_f32 v123, v62, v123
    v_mul_f32 v104, v61, v104
    v_mul_f32 v124, v62, v124
    v_mul_f32 v105, v61, v105
    v_mul_f32 v125, v62, v125
    v_mul_f32 v106, v61, v106
    v_mul_f32 v126, v62, v126
    v_mul_f32 v107, v61, v107
    v_mul_f32 v127, v62, v127
    v_cvt_pk_bf16_f32 v216, v88, v89
    v_cvt_pk_bf16_f32 v226, v108, v109
    v_cvt_pk_bf16_f32 v217, v90, v91
    v_cvt_pk_bf16_f32 v227, v110, v111
    v_cvt_pk_bf16_f32 v218, v92, v93
    v_cvt_pk_bf16_f32 v228, v112, v113
    v_cvt_pk_bf16_f32 v219, v94, v95
    v_cvt_pk_bf16_f32 v229, v114, v115
    buffer_load_dwordx4 v4, s[36:39], s69 offen offset:2048 lds
    v_cvt_pk_bf16_f32 v220, v96, v97
    v_cvt_pk_bf16_f32 v230, v116, v117
    v_cvt_pk_bf16_f32 v221, v98, v99
    v_cvt_pk_bf16_f32 v231, v118, v119
    v_cvt_pk_bf16_f32 v222, v100, v101
    v_cvt_pk_bf16_f32 v232, v120, v121
    v_cvt_pk_bf16_f32 v223, v102, v103
    v_cvt_pk_bf16_f32 v233, v122, v123
    v_cvt_pk_bf16_f32 v224, v104, v105
    v_cvt_pk_bf16_f32 v234, v124, v125
    v_cvt_pk_bf16_f32 v225, v106, v107
    v_cvt_pk_bf16_f32 v235, v126, v127
    v_cvt_pk_bf16_f32 v156, v148, v149
    v_cvt_pk_bf16_f32 v157, v150, v151
    v_cvt_pk_bf16_f32 v158, v152, v153
    v_cvt_pk_bf16_f32 v159, v154, v155
    s_mov_b32 exec_lo, 0xff00ff
    s_mov_b32 exec_hi, 0xff00ff
    v_mov_b32 v156, 0x3f803f80
    v_mov_b32 v157, 0x3f803f80
    v_mov_b32 v158, 0x3f803f80
    v_mov_b32 v159, 0x3f803f80
    s_mov_b64 exec, -1
    v_mfma_f32_16x16x32_bf16 v[88:91], v[216:219], a[220:223], 0
    v_mfma_f32_16x16x32_bf16 v[92:95], v[216:219], a[224:227], 0
    v_mfma_f32_16x16x32_bf16 v[96:99], v[220:223], a[220:223], 0
    v_mfma_f32_16x16x32_bf16 v[100:103], v[220:223], a[224:227], 0
    v_mfma_f32_16x16x32_bf16 v[104:107], v[224:227], a[220:223], 0
    v_mfma_f32_16x16x32_bf16 v[108:111], v[224:227], a[224:227], 0
    v_mfma_f32_16x16x32_bf16 v[112:115], v[228:231], a[220:223], 0
    v_mfma_f32_16x16x32_bf16 v[116:119], v[228:231], a[224:227], 0
    v_mfma_f32_16x16x32_bf16 v[120:123], v[232:235], a[220:223], 0
    v_mfma_f32_16x16x32_bf16 v[124:127], v[232:235], a[224:227], 0
    v_cvt_pk_bf16_f32 v236, v88, v89
    buffer_load_dwordx4 v4, s[36:39], s69 offen offset:3072 lds
    v_cvt_pk_bf16_f32 v237, v90, v91
    v_cvt_pk_bf16_f32 v238, v92, v93
    v_cvt_pk_bf16_f32 v239, v94, v95
    v_cvt_pk_bf16_f32 v240, v96, v97
    v_cvt_pk_bf16_f32 v241, v98, v99
    v_cvt_pk_bf16_f32 v242, v100, v101
    v_cvt_pk_bf16_f32 v243, v102, v103
    v_cvt_pk_bf16_f32 v244, v104, v105
    v_cvt_pk_bf16_f32 v245, v106, v107
    v_cvt_pk_bf16_f32 v246, v108, v109
    v_cvt_pk_bf16_f32 v247, v110, v111
    v_cvt_pk_bf16_f32 v248, v112, v113
    v_cvt_pk_bf16_f32 v249, v114, v115
    v_cvt_pk_bf16_f32 v250, v116, v117
    v_cvt_pk_bf16_f32 v251, v118, v119
    v_cvt_pk_bf16_f32 v252, v120, v121
    v_cvt_pk_bf16_f32 v253, v122, v123
    v_cvt_pk_bf16_f32 v254, v124, v125
    v_cvt_pk_bf16_f32 v255, v126, v127
    v_mfma_f32_16x16x32_bf16 v[88:91], v[236:239], v[140:143], 0
    v_mfma_f32_16x16x32_bf16 v[92:95], v[240:243], v[140:143], 0
    v_mfma_f32_16x16x32_bf16 v[96:99], v[244:247], v[140:143], 0
    v_mfma_f32_16x16x32_bf16 v[100:103], v[248:251], v[140:143], 0
    v_mfma_f32_16x16x32_bf16 v[104:107], v[252:255], v[140:143], 0
    v_mfma_f32_16x16x32_bf16 v[108:111], v[236:239], v[144:147], 0
    v_mfma_f32_16x16x32_bf16 v[112:115], v[240:243], v[144:147], 0
    v_mfma_f32_16x16x32_bf16 v[116:119], v[244:247], v[144:147], 0
    s_add_u32 m0, s90, 12288
    s_add_u32 s69, s91, 165888
    buffer_load_dwordx4 v4, s[36:39], s69 offen offset:0 lds
    v_mfma_f32_16x16x32_bf16 v[120:123], v[248:251], v[144:147], 0
    v_mfma_f32_16x16x32_bf16 v[124:127], v[252:255], v[144:147], 0
    v_mfma_f32_16x16x32_bf16 v[216:219], v[236:239], v[156:159], 0
    v_mfma_f32_16x16x32_bf16 v[220:223], v[240:243], v[156:159], 0
    v_mfma_f32_16x16x32_bf16 v[224:227], v[244:247], v[156:159], 0
    v_mfma_f32_16x16x32_bf16 v[228:231], v[248:251], v[156:159], 0
    v_mfma_f32_16x16x32_bf16 v[232:235], v[252:255], v[156:159], 0
    v_add_u32 v194, s44, v23
    v_add_u32 v195, s44, v24
    v_add_u32 v196, s44, v25
    v_add_u32 v13, s45, v4
    v_add_u32 v14, s45, v12
    v_add_u32 v63, s44, v40
    s_waitcnt vmcnt(13)
    s_barrier
    ds_read_b128 v[128:131], v13 offset:0
    ds_read_b128 v[132:135], v13 offset:1024
    ds_read_b128 v[136:139], v14 offset:0
    ds_read_b128 v[140:143], v13 offset:2560
    ds_read_b128 v[144:147], v13 offset:3584
    ds_read_b128 v[204:207], v14 offset:2560
    ds_read_b128 v[208:211], v13 offset:5120
    ds_read_b128 v[212:215], v13 offset:6144
    s_waitcnt lgkmcnt(5)
    v_mfma_f32_16x16x32_bf16 v[148:151], v[128:131], a[0:3], 0
    s_mov_b32 exec_lo, 0xffffffff
    s_mov_b32 exec_hi, 0x0
    ds_write_b128 v194, v[88:91] offset:0
    ds_write_b128 v194, v[92:95] offset:32
    s_mov_b64 exec, -1
    v_mfma_f32_16x16x32_bf16 v[152:155], v[128:131], a[4:7], 0
    ds_read_b128 v[128:131], v14 offset:5120
    v_mfma_f32_16x16x32_bf16 v[156:159], v[132:135], a[0:3], 0
    v_mfma_f32_16x16x32_bf16 v[160:163], v[132:135], a[4:7], 0
    ds_read_b128 v[132:135], v13 offset:7680
    v_mfma_f32_16x16x32_bf16 v[164:167], v[136:139], a[0:3], 0
    s_mov_b32 exec_lo, 0xffffffff
    s_mov_b32 exec_hi, 0x0
    ds_write_b128 v194, v[96:99] offset:64
    ds_write_b128 v194, v[100:103] offset:96
    ds_write_b128 v194, v[104:107] offset:128
    s_mov_b64 exec, -1
    v_mfma_f32_16x16x32_bf16 v[168:171], v[136:139], a[4:7], 0
    ds_read_b128 v[136:139], v13 offset:8704
    s_waitcnt lgkmcnt(10)
    v_mfma_f32_16x16x32_bf16 v[148:151], v[140:143], a[8:11], v[148:151]
    v_mfma_f32_16x16x32_bf16 v[152:155], v[140:143], a[12:15], v[152:155]
    ds_read_b128 v[140:143], v14 offset:7680
    v_mfma_f32_16x16x32_bf16 v[156:159], v[144:147], a[8:11], v[156:159]
    v_mfma_f32_16x16x32_bf16 v[160:163], v[144:147], a[12:15], v[160:163]
    ds_read_b128 v[144:147], v13 offset:10240
    v_mfma_f32_16x16x32_bf16 v[164:167], v[204:207], a[8:11], v[164:167]
    s_mov_b32 exec_lo, 0xf000f
    s_mov_b32 exec_hi, 0xfff0fff0
    ds_write_b128 v195, v[108:111] offset:0
    ds_write_b128 v195, v[112:115] offset:32
    s_mov_b64 exec, -1
    v_mfma_f32_16x16x32_bf16 v[168:171], v[204:207], a[12:15], v[168:171]
    ds_read_b128 v[204:207], v13 offset:11264
    s_waitcnt lgkmcnt(10)
    v_mfma_f32_16x16x32_bf16 v[148:151], v[208:211], a[16:19], v[148:151]
    v_mfma_f32_16x16x32_bf16 v[152:155], v[208:211], a[20:23], v[152:155]
    ds_read_b128 v[208:211], v14 offset:10240
    v_mfma_f32_16x16x32_bf16 v[156:159], v[212:215], a[16:19], v[156:159]
    s_mov_b32 exec_lo, 0xf000f
    s_mov_b32 exec_hi, 0xfff0fff0
    ds_write_b128 v195, v[116:119] offset:64
    ds_write_b128 v195, v[120:123] offset:96
    ds_write_b128 v195, v[124:127] offset:128
    s_mov_b64 exec, -1
    v_mfma_f32_16x16x32_bf16 v[160:163], v[212:215], a[20:23], v[160:163]
    ds_read_b128 v[212:215], v13 offset:12800
    v_mfma_f32_16x16x32_bf16 v[164:167], v[128:131], a[16:19], v[164:167]
    v_mfma_f32_16x16x32_bf16 v[168:171], v[128:131], a[20:23], v[168:171]
    ds_read_b128 v[128:131], v13 offset:13824
    s_waitcnt lgkmcnt(10)
    v_mfma_f32_16x16x32_bf16 v[148:151], v[132:135], a[24:27], v[148:151]
    v_mfma_f32_16x16x32_bf16 v[152:155], v[132:135], a[28:31], v[152:155]
    ds_read_b128 v[132:135], v14 offset:12800
    v_mfma_f32_16x16x32_bf16 v[156:159], v[136:139], a[24:27], v[156:159]
    s_mov_b32 exec_lo, 0x10001
    s_mov_b32 exec_hi, 0xff01ff01
    ds_write_b128 v196, v[216:219] offset:0
    ds_write_b128 v196, v[220:223] offset:32
    s_mov_b64 exec, -1
    v_mfma_f32_16x16x32_bf16 v[160:163], v[136:139], a[28:31], v[160:163]
    ds_read_b128 v[136:139], v13 offset:15360
    v_mfma_f32_16x16x32_bf16 v[164:167], v[140:143], a[24:27], v[164:167]
    v_mfma_f32_16x16x32_bf16 v[168:171], v[140:143], a[28:31], v[168:171]
    ds_read_b128 v[140:143], v13 offset:16384
    s_waitcnt lgkmcnt(10)
    v_mfma_f32_16x16x32_bf16 v[148:151], v[144:147], a[32:35], v[148:151]
    v_mfma_f32_16x16x32_bf16 v[152:155], v[144:147], a[36:39], v[152:155]
    ds_read_b128 v[144:147], v14 offset:15360
    v_mfma_f32_16x16x32_bf16 v[156:159], v[204:207], a[32:35], v[156:159]
    s_mov_b32 exec_lo, 0x10001
    s_mov_b32 exec_hi, 0xff01ff01
    ds_write_b128 v196, v[224:227] offset:64
    ds_write_b128 v196, v[228:231] offset:96
    ds_write_b128 v196, v[232:235] offset:128
    s_mov_b64 exec, -1
    v_mfma_f32_16x16x32_bf16 v[160:163], v[204:207], a[36:39], v[160:163]
    ds_read_b128 v[204:207], v13 offset:17920
    v_mfma_f32_16x16x32_bf16 v[164:167], v[208:211], a[32:35], v[164:167]
    v_mfma_f32_16x16x32_bf16 v[168:171], v[208:211], a[36:39], v[168:171]
    ds_read_b128 v[208:211], v13 offset:18944
    s_waitcnt lgkmcnt(10)
    v_mfma_f32_16x16x32_bf16 v[148:151], v[212:215], a[40:43], v[148:151]
    v_mfma_f32_16x16x32_bf16 v[152:155], v[212:215], a[44:47], v[152:155]
    ds_read_b128 v[212:215], v14 offset:17920
    s_waitcnt lgkmcnt(3)
    v_mfma_f32_16x16x32_bf16 v[156:159], v[128:131], a[40:43], v[156:159]
    s_barrier
    ds_read_b128 v[88:91], v63 offset:0
    v_mfma_f32_16x16x32_bf16 v[160:163], v[128:131], a[44:47], v[160:163]
    ds_read_b128 v[128:131], v13 offset:20480
    ds_read_b128 v[92:95], v63 offset:16
    v_mfma_f32_16x16x32_bf16 v[164:167], v[132:135], a[40:43], v[164:167]
    ds_read_b128 v[96:99], v63 offset:6720
    ds_read_b128 v[100:103], v63 offset:6736
    ds_read_b128 v[104:107], v63 offset:13440
    v_mfma_f32_16x16x32_bf16 v[168:171], v[132:135], a[44:47], v[168:171]
    ds_read_b128 v[132:135], v13 offset:21504
    ds_read_b128 v[108:111], v63 offset:13456
    ds_read_b128 v[112:115], v63 offset:20160
    ds_read_b128 v[116:119], v63 offset:20176
    v_mfma_f32_16x16x32_bf16 v[148:151], v[136:139], a[48:51], v[148:151]
    v_mfma_f32_16x16x32_bf16 v[152:155], v[136:139], a[52:55], v[152:155]
    ds_read_b128 v[136:139], v14 offset:20480
    v_mfma_f32_16x16x32_bf16 v[156:159], v[140:143], a[48:51], v[156:159]
    v_mfma_f32_16x16x32_bf16 v[160:163], v[140:143], a[52:55], v[160:163]
    ds_read_b128 v[140:143], v13 offset:23040
    v_mfma_f32_16x16x32_bf16 v[164:167], v[144:147], a[48:51], v[164:167]
    v_mfma_f32_16x16x32_bf16 v[168:171], v[144:147], a[52:55], v[168:171]
    ds_read_b128 v[144:147], v13 offset:24064
    s_waitcnt lgkmcnt(3)
    v_add_f32 v88, v88, v96
    v_add_f32 v104, v104, v112
    v_add_f32 v89, v89, v97
    v_add_f32 v105, v105, v113
    v_add_f32 v90, v90, v98
    v_add_f32 v106, v106, v114
    v_add_f32 v91, v91, v99
    v_add_f32 v107, v107, v115
    v_add_f32 v92, v92, v100
    v_add_f32 v108, v108, v116
    v_add_f32 v93, v93, v101
    v_add_f32 v109, v109, v117
    v_add_f32 v94, v94, v102
    v_add_f32 v110, v110, v118
    v_add_f32 v95, v95, v103
    v_add_f32 v111, v111, v119
    v_add_f32 v88, v88, v104
    v_add_f32 v89, v89, v105
    v_add_f32 v90, v90, v106
    v_add_f32 v91, v91, v107
    v_add_f32 v92, v92, v108
    v_mfma_f32_16x16x32_bf16 v[148:151], v[204:207], a[56:59], v[148:151]
    v_add_f32 v93, v93, v109
    v_add_f32 v94, v94, v110
    v_add_f32 v95, v95, v111
    v_mfma_f32_16x16x32_bf16 v[152:155], v[204:207], a[60:63], v[152:155]
    ds_read_b128 v[204:207], v14 offset:23040
    v_cvt_pk_bf16_f32 v216, v88, v89
    v_cvt_pk_bf16_f32 v217, v90, v91
    v_cvt_pk_bf16_f32 v218, v92, v93
    v_cvt_pk_bf16_f32 v219, v94, v95
    s_mov_b64 exec, s[64:65]
    buffer_store_dwordx4 v[216:219], v41, s[36:39], s58 offen sc1
    s_mov_b64 exec, -1
    s_barrier
    v_mfma_f32_16x16x32_bf16 v[156:159], v[208:211], a[56:59], v[156:159]
    s_add_u32 s90, s44, s48
    v_mfma_f32_16x16x32_bf16 v[160:163], v[208:211], a[60:63], v[160:163]
    ds_read_b128 v[208:211], v13 offset:25600
    s_add_u32 s91, s47, s48
    v_mfma_f32_16x16x32_bf16 v[164:167], v[212:215], a[56:59], v[164:167]
    v_mfma_f32_16x16x32_bf16 v[168:171], v[212:215], a[60:63], v[168:171]
    ds_read_b128 v[212:215], v13 offset:26624
    s_waitcnt lgkmcnt(5)
    v_mfma_f32_16x16x32_bf16 v[148:151], v[128:131], a[64:67], v[148:151]
    s_add_u32 m0, s90, 0
    v_mfma_f32_16x16x32_bf16 v[152:155], v[128:131], a[68:71], v[152:155]
    ds_read_b128 v[128:131], v14 offset:25600
    s_add_u32 s69, s91, 0
    v_mfma_f32_16x16x32_bf16 v[156:159], v[132:135], a[64:67], v[156:159]
    v_mfma_f32_16x16x32_bf16 v[160:163], v[132:135], a[68:71], v[160:163]
    ds_read_b128 v[132:135], v13 offset:28160
    v_mfma_f32_16x16x32_bf16 v[164:167], v[136:139], a[64:67], v[164:167]
    buffer_load_dwordx4 v4, s[92:95], s69 offen offset:0 lds
    v_mfma_f32_16x16x32_bf16 v[168:171], v[136:139], a[68:71], v[168:171]
    ds_read_b128 v[136:139], v13 offset:29184
    s_waitcnt lgkmcnt(5)
    v_mfma_f32_16x16x32_bf16 v[148:151], v[140:143], a[72:75], v[148:151]
    v_mfma_f32_16x16x32_bf16 v[152:155], v[140:143], a[76:79], v[152:155]
    ds_read_b128 v[140:143], v14 offset:28160
    v_mfma_f32_16x16x32_bf16 v[156:159], v[144:147], a[72:75], v[156:159]
    buffer_load_dwordx4 v4, s[92:95], s69 offen offset:1024 lds
    v_mfma_f32_16x16x32_bf16 v[160:163], v[144:147], a[76:79], v[160:163]
    ds_read_b128 v[144:147], v13 offset:30720
    v_mfma_f32_16x16x32_bf16 v[164:167], v[204:207], a[72:75], v[164:167]
    v_mfma_f32_16x16x32_bf16 v[168:171], v[204:207], a[76:79], v[168:171]
    ds_read_b128 v[204:207], v13 offset:31744
    s_waitcnt lgkmcnt(5)
    v_mfma_f32_16x16x32_bf16 v[148:151], v[208:211], a[80:83], v[148:151]
    buffer_load_dwordx4 v4, s[92:95], s69 offen offset:2048 lds
    v_mfma_f32_16x16x32_bf16 v[152:155], v[208:211], a[84:87], v[152:155]
    ds_read_b128 v[208:211], v14 offset:30720
    v_mfma_f32_16x16x32_bf16 v[156:159], v[212:215], a[80:83], v[156:159]
    buffer_load_dwordx4 v4, s[92:95], s69 offen offset:3072 lds
    v_mfma_f32_16x16x32_bf16 v[160:163], v[212:215], a[84:87], v[160:163]
    ds_read_b128 v[212:215], v13 offset:33280
    v_mfma_f32_16x16x32_bf16 v[164:167], v[128:131], a[80:83], v[164:167]
    v_mfma_f32_16x16x32_bf16 v[168:171], v[128:131], a[84:87], v[168:171]
    ds_read_b128 v[128:131], v13 offset:34304
    s_waitcnt lgkmcnt(5)
    v_mfma_f32_16x16x32_bf16 v[148:151], v[132:135], a[88:91], v[148:151]
    s_add_u32 m0, s90, 4096
    v_mfma_f32_16x16x32_bf16 v[152:155], v[132:135], a[92:95], v[152:155]
    ds_read_b128 v[132:135], v14 offset:33280
    v_mfma_f32_16x16x32_bf16 v[156:159], v[136:139], a[88:91], v[156:159]
    s_add_u32 s69, s91, 4096
    v_mfma_f32_16x16x32_bf16 v[160:163], v[136:139], a[92:95], v[160:163]
    ds_read_b128 v[136:139], v13 offset:35840
    v_mfma_f32_16x16x32_bf16 v[164:167], v[140:143], a[88:91], v[164:167]
    buffer_load_dwordx4 v4, s[92:95], s69 offen offset:0 lds
    v_mfma_f32_16x16x32_bf16 v[168:171], v[140:143], a[92:95], v[168:171]
    ds_read_b128 v[140:143], v13 offset:36864
    s_waitcnt lgkmcnt(5)
    v_mfma_f32_16x16x32_bf16 v[148:151], v[144:147], a[96:99], v[148:151]
    v_mfma_f32_16x16x32_bf16 v[152:155], v[144:147], a[100:103], v[152:155]
    ds_read_b128 v[144:147], v14 offset:35840
    v_mfma_f32_16x16x32_bf16 v[156:159], v[204:207], a[96:99], v[156:159]
    buffer_load_dwordx4 v4, s[92:95], s69 offen offset:1024 lds
    v_mfma_f32_16x16x32_bf16 v[160:163], v[204:207], a[100:103], v[160:163]
    ds_read_b128 v[204:207], v13 offset:38400
    v_mfma_f32_16x16x32_bf16 v[164:167], v[208:211], a[96:99], v[164:167]
    v_mfma_f32_16x16x32_bf16 v[168:171], v[208:211], a[100:103], v[168:171]
    ds_read_b128 v[208:211], v13 offset:39424
    s_waitcnt lgkmcnt(5)
    v_mfma_f32_16x16x32_bf16 v[148:151], v[212:215], a[104:107], v[148:151]
    buffer_load_dwordx4 v4, s[92:95], s69 offen offset:2048 lds
    v_mfma_f32_16x16x32_bf16 v[152:155], v[212:215], a[108:111], v[152:155]
    ds_read_b128 v[212:215], v14 offset:38400
    v_mfma_f32_16x16x32_bf16 v[156:159], v[128:131], a[104:107], v[156:159]
    v_mfma_f32_16x16x32_bf16 v[160:163], v[128:131], a[108:111], v[160:163]
    ds_read_b128 v[128:131], v13 offset:40960
    v_mfma_f32_16x16x32_bf16 v[164:167], v[132:135], a[104:107], v[164:167]
    buffer_load_dwordx4 v4, s[92:95], s69 offen offset:3072 lds
    v_mfma_f32_16x16x32_bf16 v[168:171], v[132:135], a[108:111], v[168:171]
    ds_read_b128 v[132:135], v13 offset:41984
    s_waitcnt lgkmcnt(5)
    v_mfma_f32_16x16x32_bf16 v[148:151], v[136:139], a[112:115], v[148:151]
    v_mfma_f32_16x16x32_bf16 v[152:155], v[136:139], a[116:119], v[152:155]
    ds_read_b128 v[136:139], v14 offset:40960
    s_add_u32 m0, s90, 8192
    v_mfma_f32_16x16x32_bf16 v[156:159], v[140:143], a[112:115], v[156:159]
    v_mfma_f32_16x16x32_bf16 v[160:163], v[140:143], a[116:119], v[160:163]
    ds_read_b128 v[140:143], v13 offset:43520
    s_add_u32 s69, s91, 8192
    v_mfma_f32_16x16x32_bf16 v[164:167], v[144:147], a[112:115], v[164:167]
    v_mfma_f32_16x16x32_bf16 v[168:171], v[144:147], a[116:119], v[168:171]
    ds_read_b128 v[144:147], v13 offset:44544
    s_waitcnt lgkmcnt(5)
    v_mfma_f32_16x16x32_bf16 v[148:151], v[204:207], a[120:123], v[148:151]
    buffer_load_dwordx4 v4, s[92:95], s69 offen offset:0 lds
    v_mfma_f32_16x16x32_bf16 v[152:155], v[204:207], a[124:127], v[152:155]
    ds_read_b128 v[204:207], v14 offset:43520
    v_mfma_f32_16x16x32_bf16 v[156:159], v[208:211], a[120:123], v[156:159]
    s_add_u32 s3, s59, 0
    v_mfma_f32_16x16x32_bf16 v[160:163], v[208:211], a[124:127], v[160:163]
    ds_read_b128 v[208:211], v13 offset:46080
    v_mfma_f32_16x16x32_bf16 v[164:167], v[212:215], a[120:123], v[164:167]
    buffer_load_dwordx4 v4, s[92:95], s69 offen offset:1024 lds
    v_mfma_f32_16x16x32_bf16 v[168:171], v[212:215], a[124:127], v[168:171]
    ds_read_b128 v[212:215], v13 offset:47104
    s_waitcnt lgkmcnt(5)
    v_mfma_f32_16x16x32_bf16 v[148:151], v[128:131], a[128:131], v[148:151]
    buffer_load_dwordx4 a[0:3], v59, s[36:39], s3 offen offset:0
    v_mfma_f32_16x16x32_bf16 v[152:155], v[128:131], a[132:135], v[152:155]
    ds_read_b128 v[128:131], v14 offset:46080
    v_mfma_f32_16x16x32_bf16 v[156:159], v[132:135], a[128:131], v[156:159]
    buffer_load_dwordx4 v4, s[92:95], s69 offen offset:2048 lds
    v_mfma_f32_16x16x32_bf16 v[160:163], v[132:135], a[132:135], v[160:163]
    ds_read_b128 v[132:135], v13 offset:48640
    v_mfma_f32_16x16x32_bf16 v[164:167], v[136:139], a[128:131], v[164:167]
    buffer_load_dwordx4 a[4:7], v59, s[36:39], s3 offen offset:1024
    v_mfma_f32_16x16x32_bf16 v[168:171], v[136:139], a[132:135], v[168:171]
    ds_read_b128 v[136:139], v13 offset:49664
    s_waitcnt lgkmcnt(5)
    v_mfma_f32_16x16x32_bf16 v[148:151], v[140:143], a[136:139], v[148:151]
    buffer_load_dwordx4 v4, s[92:95], s69 offen offset:3072 lds
    v_mfma_f32_16x16x32_bf16 v[152:155], v[140:143], a[140:143], v[152:155]
    ds_read_b128 v[140:143], v14 offset:48640
    v_mfma_f32_16x16x32_bf16 v[156:159], v[144:147], a[136:139], v[156:159]
    buffer_load_dwordx4 a[8:11], v59, s[36:39], s3 offen offset:2048
    v_mfma_f32_16x16x32_bf16 v[160:163], v[144:147], a[140:143], v[160:163]
    s_mov_b64 exec, s[84:85]
    buffer_load_dwordx4 a[12:15], v59, s[36:39], s3 offen offset:3072
    s_mov_b64 exec, -1
    v_mfma_f32_16x16x32_bf16 v[164:167], v[204:207], a[136:139], v[164:167]
    s_add_u32 m0, s90, 12288
    s_add_u32 s69, s91, 12288
    v_mfma_f32_16x16x32_bf16 v[168:171], v[204:207], a[140:143], v[168:171]
    s_waitcnt lgkmcnt(3)
    v_mfma_f32_16x16x32_bf16 v[148:151], v[208:211], a[144:147], v[148:151]
    buffer_load_dwordx4 v4, s[92:95], s69 offen offset:0 lds
    v_mfma_f32_16x16x32_bf16 v[152:155], v[208:211], a[148:151], v[152:155]
    v_mfma_f32_16x16x32_bf16 v[156:159], v[212:215], a[144:147], v[156:159]
    v_mfma_f32_16x16x32_bf16 v[160:163], v[212:215], a[148:151], v[160:163]
    s_add_u32 s3, s59, 16384
    v_mfma_f32_16x16x32_bf16 v[164:167], v[128:131], a[144:147], v[164:167]
    v_mfma_f32_16x16x32_bf16 v[168:171], v[128:131], a[148:151], v[168:171]
    s_waitcnt lgkmcnt(0)
    v_mfma_f32_16x16x32_bf16 v[148:151], v[132:135], a[152:155], v[148:151]
    buffer_load_dwordx4 a[16:19], v59, s[36:39], s3 offen offset:0
    v_mfma_f32_16x16x32_bf16 v[152:155], v[132:135], a[156:159], v[152:155]
    v_mfma_f32_16x16x32_bf16 v[156:159], v[136:139], a[152:155], v[156:159]
    buffer_load_dwordx4 a[20:23], v59, s[36:39], s3 offen offset:1024
    v_mfma_f32_16x16x32_bf16 v[160:163], v[136:139], a[156:159], v[160:163]
    v_mfma_f32_16x16x32_bf16 v[164:167], v[140:143], a[152:155], v[164:167]
    v_mfma_f32_16x16x32_bf16 v[168:171], v[140:143], a[156:159], v[168:171]
    s_barrier
    ds_read_b128 v[202:205], v47 offset:832
    ds_read_b128 v[206:209], v47 offset:896
    ds_read_b128 v[210:213], v47 offset:960
    s_waitcnt lgkmcnt(0)
    v_fma_f32 v148, v172, v202, v148
    v_mul_f32 v148, v173, v148
    v_fma_f32 v149, v172, v203, v149
    v_mul_f32 v149, v173, v149
    v_fma_f32 v150, v172, v204, v150
    v_mul_f32 v150, v173, v150
    buffer_load_dwordx4 a[24:27], v59, s[36:39], s3 offen offset:2048
    v_fma_f32 v151, v172, v205, v151
    v_mul_f32 v151, v173, v151
    v_cvt_pk_bf16_f32 v244, v148, v149
    v_cvt_pk_bf16_f32 v245, v150, v151
    v_fma_f32 v152, v174, v202, v152
    v_mul_f32 v152, v175, v152
    v_fma_f32 v153, v174, v203, v153
    v_mul_f32 v153, v175, v153
    v_fma_f32 v154, v174, v204, v154
    v_mul_f32 v154, v175, v154
    s_mov_b64 exec, s[84:85]
    buffer_load_dwordx4 a[28:31], v59, s[36:39], s3 offen offset:3072
    s_mov_b64 exec, -1
    v_fma_f32 v155, v174, v205, v155
    v_mul_f32 v155, v175, v155
    v_cvt_pk_bf16_f32 v248, v152, v153
    v_cvt_pk_bf16_f32 v249, v154, v155
    v_fma_f32 v156, v172, v206, v156
    v_mul_f32 v156, v173, v156
    v_fma_f32 v157, v172, v207, v157
    v_mul_f32 v157, v173, v157
    v_fma_f32 v158, v172, v208, v158
    v_mul_f32 v158, v173, v158
    s_add_u32 s3, s59, 32768
    v_fma_f32 v159, v172, v209, v159
    v_mul_f32 v159, v173, v159
    v_cvt_pk_bf16_f32 v246, v156, v157
    v_cvt_pk_bf16_f32 v247, v158, v159
    v_fma_f32 v160, v174, v206, v160
    v_mul_f32 v160, v175, v160
    v_fma_f32 v161, v174, v207, v161
    v_mul_f32 v161, v175, v161
    v_fma_f32 v162, v174, v208, v162
    v_mul_f32 v162, v175, v162
    buffer_load_dwordx4 a[32:35], v59, s[36:39], s3 offen offset:0
    v_fma_f32 v163, v174, v209, v163
    v_mul_f32 v163, v175, v163
    v_cvt_pk_bf16_f32 v250, v160, v161
    v_cvt_pk_bf16_f32 v251, v162, v163
    v_fma_f32 v164, v172, v210, v164
    v_mul_f32 v164, v173, v164
    v_fma_f32 v165, v172, v211, v165
    v_mul_f32 v165, v173, v165
    v_fma_f32 v166, v172, v212, v166
    v_mul_f32 v166, v173, v166
    buffer_load_dwordx4 a[36:39], v59, s[36:39], s3 offen offset:1024
    v_fma_f32 v167, v172, v213, v167
    v_mul_f32 v167, v173, v167
    v_cvt_pk_bf16_f32 v252, v164, v165
    v_cvt_pk_bf16_f32 v253, v166, v167
    v_fma_f32 v168, v174, v210, v168
    v_mul_f32 v168, v175, v168
    v_fma_f32 v169, v174, v211, v169
    v_mul_f32 v169, v175, v169
    v_fma_f32 v170, v174, v212, v170
    buffer_load_dwordx4 a[40:43], v59, s[36:39], s3 offen offset:2048
    v_mul_f32 v170, v175, v170
    v_fma_f32 v171, v174, v213, v171
    v_mul_f32 v171, v175, v171
    v_cvt_pk_bf16_f32 v254, v168, v169
    v_cvt_pk_bf16_f32 v255, v170, v171
    v_mfma_f32_16x16x32_bf16 v[88:91], a[160:163], v[244:247], 0
    v_mfma_f32_16x16x32_bf16 v[92:95], a[164:167], v[244:247], 0
    v_mfma_f32_16x16x32_bf16 v[96:99], a[168:171], v[244:247], 0
    v_mfma_f32_16x16x32_bf16 v[100:103], a[172:175], v[244:247], 0
    v_mfma_f32_16x16x32_bf16 v[104:107], a[176:179], v[244:247], 0
    s_mov_b64 exec, s[84:85]
    buffer_load_dwordx4 a[44:47], v59, s[36:39], s3 offen offset:3072
    s_mov_b64 exec, -1
    v_mfma_f32_16x16x32_bf16 v[88:91], a[180:183], v[248:251], v[88:91]
    v_mfma_f32_16x16x32_bf16 v[92:95], a[184:187], v[248:251], v[92:95]
    v_mfma_f32_16x16x32_bf16 v[96:99], a[188:191], v[248:251], v[96:99]
    v_mfma_f32_16x16x32_bf16 v[100:103], a[192:195], v[248:251], v[100:103]
    v_mfma_f32_16x16x32_bf16 v[104:107], a[196:199], v[248:251], v[104:107]
    v_mfma_f32_16x16x32_bf16 v[88:91], a[200:203], v[252:255], v[88:91]
    v_mfma_f32_16x16x32_bf16 v[92:95], a[204:207], v[252:255], v[92:95]
    v_mfma_f32_16x16x32_bf16 v[96:99], a[208:211], v[252:255], v[96:99]
    v_mfma_f32_16x16x32_bf16 v[100:103], a[212:215], v[252:255], v[100:103]
    v_mfma_f32_16x16x32_bf16 v[104:107], a[216:219], v[252:255], v[104:107]
    s_add_u32 s3, s59, 49152
    s_nop 2
    v_max_f32 v61, v88, v89
    v_min_f32 v62, v88, v89
    v_max3_f32 v61, v61, v90, v91
    v_min3_f32 v62, v62, v90, v91
    v_max3_f32 v61, v61, v92, v93
    v_min3_f32 v62, v62, v92, v93
    v_max3_f32 v61, v61, v94, v95
    v_min3_f32 v62, v62, v94, v95
    v_max3_f32 v61, v61, v96, v97
    v_min3_f32 v62, v62, v96, v97
    buffer_load_dwordx4 a[48:51], v59, s[36:39], s3 offen offset:0
    v_max3_f32 v61, v61, v98, v99
    v_min3_f32 v62, v62, v98, v99
    v_max3_f32 v61, v61, v100, v101
    v_min3_f32 v62, v62, v100, v101
    v_max3_f32 v61, v61, v102, v103
    v_min3_f32 v62, v62, v102, v103
    v_max3_f32 v61, v61, v104, v105
    v_min3_f32 v62, v62, v104, v105
    v_max3_f32 v61, v61, v106, v107
    v_min3_f32 v62, v62, v106, v107
    buffer_load_dwordx4 a[52:55], v59, s[36:39], s3 offen offset:1024
    v_mul_f32 v61, s74, v61
    v_mul_f32 v62, s70, v62
    v_fma_f32 v108, v88, s74, v62
    v_fma_f32 v88, v88, s70, v61
    v_fma_f32 v109, v89, s74, v62
    v_fma_f32 v89, v89, s70, v61
    v_fma_f32 v110, v90, s74, v62
    v_fma_f32 v90, v90, s70, v61
    v_fma_f32 v111, v91, s74, v62
    v_fma_f32 v91, v91, s70, v61
    buffer_load_dwordx4 a[56:59], v59, s[36:39], s3 offen offset:2048
    v_fma_f32 v112, v92, s74, v62
    v_fma_f32 v92, v92, s70, v61
    v_fma_f32 v113, v93, s74, v62
    v_fma_f32 v93, v93, s70, v61
    v_fma_f32 v114, v94, s74, v62
    v_fma_f32 v94, v94, s70, v61
    v_fma_f32 v115, v95, s74, v62
    v_fma_f32 v95, v95, s70, v61
    v_fma_f32 v116, v96, s74, v62
    s_mov_b64 exec, s[84:85]
    buffer_load_dwordx4 a[60:63], v59, s[36:39], s3 offen offset:3072
    s_mov_b64 exec, -1
    v_fma_f32 v96, v96, s70, v61
    v_fma_f32 v117, v97, s74, v62
    v_fma_f32 v97, v97, s70, v61
    v_fma_f32 v118, v98, s74, v62
    v_fma_f32 v98, v98, s70, v61
    v_fma_f32 v119, v99, s74, v62
    v_fma_f32 v99, v99, s70, v61
    v_fma_f32 v120, v100, s74, v62
    v_fma_f32 v100, v100, s70, v61
    v_fma_f32 v121, v101, s74, v62
    v_fma_f32 v101, v101, s70, v61
    v_fma_f32 v122, v102, s74, v62
    v_fma_f32 v102, v102, s70, v61
    s_add_u32 s90, s45, s48
    s_add_u32 s91, s47, s48
    s_add_u32 m0, s90, 0
    s_add_u32 s69, s91, 51200
    buffer_load_dwordx4 v4, s[92:95], s69 offen offset:0 lds
    v_fma_f32 v123, v103, s74, v62
    v_fma_f32 v103, v103, s70, v61
    v_fma_f32 v124, v104, s74, v62
    v_fma_f32 v104, v104, s70, v61
    v_fma_f32 v125, v105, s74, v62
    v_fma_f32 v105, v105, s70, v61
    v_fma_f32 v126, v106, s74, v62
    v_fma_f32 v106, v106, s70, v61
    v_fma_f32 v127, v107, s74, v62
    v_fma_f32 v107, v107, s70, v61
    v_exp_f32 v88, v88
    v_exp_f32 v108, v108
    v_exp_f32 v89, v89
    buffer_load_dwordx4 v4, s[92:95], s69 offen offset:1024 lds
    v_exp_f32 v109, v109
    v_exp_f32 v90, v90
    v_exp_f32 v110, v110
    v_exp_f32 v91, v91
    v_exp_f32 v111, v111
    v_exp_f32 v92, v92
    v_exp_f32 v112, v112
    v_exp_f32 v93, v93
    v_exp_f32 v113, v113
    v_exp_f32 v94, v94
    v_exp_f32 v114, v114
    v_exp_f32 v95, v95
    buffer_load_dwordx4 v4, s[92:95], s69 offen offset:2048 lds
    v_exp_f32 v115, v115
    v_exp_f32 v96, v96
    v_exp_f32 v116, v116
    v_exp_f32 v97, v97
    v_exp_f32 v117, v117
    v_exp_f32 v98, v98
    v_exp_f32 v118, v118
    v_exp_f32 v99, v99
    v_exp_f32 v119, v119
    v_exp_f32 v100, v100
    v_exp_f32 v120, v120
    v_exp_f32 v101, v101
    v_exp_f32 v121, v121
    buffer_load_dwordx4 v4, s[92:95], s69 offen offset:3072 lds
    v_exp_f32 v102, v102
    v_exp_f32 v122, v122
    v_exp_f32 v103, v103
    v_exp_f32 v123, v123
    v_exp_f32 v104, v104
    v_exp_f32 v124, v124
    v_exp_f32 v105, v105
    v_exp_f32 v125, v125
    v_exp_f32 v106, v106
    v_exp_f32 v126, v126
    v_exp_f32 v107, v107
    v_exp_f32 v127, v127
    v_add_f32 v61, v88, v89
    s_add_u32 m0, s90, 4096
    s_add_u32 s69, s91, 55296
    buffer_load_dwordx4 v4, s[92:95], s69 offen offset:0 lds
    v_add_f32 v62, v108, v109
    v_add_f32 v61, v61, v90
    v_add_f32 v62, v62, v110
    v_add_f32 v61, v61, v91
    v_add_f32 v62, v62, v111
    v_add_f32 v61, v61, v92
    v_add_f32 v62, v62, v112
    v_add_f32 v61, v61, v93
    v_add_f32 v62, v62, v113
    v_add_f32 v61, v61, v94
    v_add_f32 v62, v62, v114
    v_add_f32 v61, v61, v95
    buffer_load_dwordx4 v4, s[92:95], s69 offen offset:1024 lds
    v_add_f32 v62, v62, v115
    v_add_f32 v61, v61, v96
    v_add_f32 v62, v62, v116
    v_add_f32 v61, v61, v97
    v_add_f32 v62, v62, v117
    v_add_f32 v61, v61, v98
    v_add_f32 v62, v62, v118
    v_add_f32 v61, v61, v99
    v_add_f32 v62, v62, v119
    v_add_f32 v61, v61, v100
    v_add_f32 v62, v62, v120
    v_add_f32 v61, v61, v101
    v_add_f32 v62, v62, v121
    buffer_load_dwordx4 v4, s[92:95], s69 offen offset:2048 lds
    v_add_f32 v61, v61, v102
    v_add_f32 v62, v62, v122
    v_add_f32 v61, v61, v103
    v_add_f32 v62, v62, v123
    v_add_f32 v61, v61, v104
    v_add_f32 v62, v62, v124
    v_add_f32 v61, v61, v105
    v_add_f32 v62, v62, v125
    v_add_f32 v61, v61, v106
    v_add_f32 v62, v62, v126
    v_add_f32 v61, v61, v107
    v_add_f32 v62, v62, v127
    buffer_load_dwordx4 v4, s[92:95], s69 offen offset:3072 lds
    v_rcp_f32 v61, v61
    v_rcp_f32 v62, v62
    v_mul_f32 v88, v61, v88
    v_mul_f32 v108, v62, v108
    v_mul_f32 v89, v61, v89
    v_mul_f32 v109, v62, v109
    v_mul_f32 v90, v61, v90
    v_mul_f32 v110, v62, v110
    v_mul_f32 v91, v61, v91
    v_mul_f32 v111, v62, v111
    v_mul_f32 v92, v61, v92
    v_mul_f32 v112, v62, v112
    v_mul_f32 v93, v61, v93
    s_add_u32 m0, s90, 8192
    s_add_u32 s69, s91, 59392
    buffer_load_dwordx4 v4, s[92:95], s69 offen offset:0 lds
    v_mul_f32 v113, v62, v113
    v_mul_f32 v94, v61, v94
    v_mul_f32 v114, v62, v114
    v_mul_f32 v95, v61, v95
    v_mul_f32 v115, v62, v115
    v_mul_f32 v96, v61, v96
    v_mul_f32 v116, v62, v116
    v_mul_f32 v97, v61, v97
    v_mul_f32 v117, v62, v117
    v_mul_f32 v98, v61, v98
    v_mul_f32 v118, v62, v118
    v_mul_f32 v99, v61, v99
    v_mul_f32 v119, v62, v119
    buffer_load_dwordx4 v4, s[92:95], s69 offen offset:1024 lds
    v_mul_f32 v100, v61, v100
    v_mul_f32 v120, v62, v120
    v_mul_f32 v101, v61, v101
    v_mul_f32 v121, v62, v121
    v_mul_f32 v102, v61, v102
    v_mul_f32 v122, v62, v122
    v_mul_f32 v103, v61, v103
    v_mul_f32 v123, v62, v123
    v_mul_f32 v104, v61, v104
    v_mul_f32 v124, v62, v124
    v_mul_f32 v105, v61, v105
    v_mul_f32 v125, v62, v125
    buffer_load_dwordx4 v4, s[92:95], s69 offen offset:2048 lds
    v_mul_f32 v106, v61, v106
    v_mul_f32 v126, v62, v126
    v_mul_f32 v107, v61, v107
    v_mul_f32 v127, v62, v127
    v_cvt_pk_bf16_f32 v216, v88, v89
    v_cvt_pk_bf16_f32 v226, v108, v109
    v_cvt_pk_bf16_f32 v217, v90, v91
    v_cvt_pk_bf16_f32 v227, v110, v111
    v_cvt_pk_bf16_f32 v218, v92, v93
    v_cvt_pk_bf16_f32 v228, v112, v113
    v_cvt_pk_bf16_f32 v219, v94, v95
    v_cvt_pk_bf16_f32 v229, v114, v115
    v_cvt_pk_bf16_f32 v220, v96, v97
    buffer_load_dwordx4 v4, s[92:95], s69 offen offset:3072 lds
    v_cvt_pk_bf16_f32 v230, v116, v117
    v_cvt_pk_bf16_f32 v221, v98, v99
    v_cvt_pk_bf16_f32 v231, v118, v119
    v_cvt_pk_bf16_f32 v222, v100, v101
    v_cvt_pk_bf16_f32 v232, v120, v121
    v_cvt_pk_bf16_f32 v223, v102, v103
    v_cvt_pk_bf16_f32 v233, v122, v123
    v_cvt_pk_bf16_f32 v224, v104, v105
    v_cvt_pk_bf16_f32 v234, v124, v125
    v_cvt_pk_bf16_f32 v225, v106, v107
    v_cvt_pk_bf16_f32 v235, v126, v127
    v_mov_b32 v236, 0
    s_add_u32 m0, s90, 12288
    s_add_u32 s69, s91, 63488
    buffer_load_dwordx4 v4, s[92:95], s69 offen offset:0 lds
    v_mov_b32 v237, 0
    v_mov_b32 v238, 0
    v_mov_b32 v239, 0
    v_permlane32_swap_b32 v216, v220
    v_permlane32_swap_b32 v217, v221
    v_permlane32_swap_b32 v218, v222
    v_permlane32_swap_b32 v219, v223
    v_permlane32_swap_b32 v224, v228
    v_permlane32_swap_b32 v225, v229
    v_permlane32_swap_b32 v226, v230
    v_permlane32_swap_b32 v227, v231
    v_permlane32_swap_b32 v232, v236
    v_permlane32_swap_b32 v233, v237
    v_permlane32_swap_b32 v234, v238
    v_permlane32_swap_b32 v235, v239
    s_waitcnt vmcnt(26)
    v_mfma_f32_16x16x32_bf16 v[88:91], a[240:243], a[0:3], 0
    v_mfma_f32_16x16x32_bf16 v[92:95], a[240:243], a[4:7], 0
    v_mfma_f32_16x16x32_bf16 v[96:99], a[240:243], a[8:11], 0
    v_mfma_f32_16x16x32_bf16 v[100:103], a[240:243], a[12:15], 0
    s_waitcnt vmcnt(21)
    v_mfma_f32_16x16x32_bf16 v[88:91], a[240:243], a[16:19], v[88:91]
    v_mfma_f32_16x16x32_bf16 v[92:95], a[240:243], a[20:23], v[92:95]
    v_mfma_f32_16x16x32_bf16 v[96:99], a[240:243], a[24:27], v[96:99]
    v_mfma_f32_16x16x32_bf16 v[100:103], a[240:243], a[28:31], v[100:103]
    s_waitcnt vmcnt(17)
    v_mfma_f32_16x16x32_bf16 v[88:91], a[240:243], a[32:35], v[88:91]
    v_mfma_f32_16x16x32_bf16 v[92:95], a[240:243], a[36:39], v[92:95]
    v_mfma_f32_16x16x32_bf16 v[96:99], a[240:243], a[40:43], v[96:99]
    v_mfma_f32_16x16x32_bf16 v[100:103], a[240:243], a[44:47], v[100:103]
    s_waitcnt vmcnt(13)
    v_mfma_f32_16x16x32_bf16 v[88:91], a[240:243], a[48:51], v[88:91]
    v_mfma_f32_16x16x32_bf16 v[92:95], a[240:243], a[52:55], v[92:95]
    v_mfma_f32_16x16x32_bf16 v[96:99], a[240:243], a[56:59], v[96:99]
    v_mfma_f32_16x16x32_bf16 v[100:103], a[240:243], a[60:63], v[100:103]
    s_nop 7
    v_cmp_u_f32 s[86:87], v100, v100
    s_and_b64 s[86:87], s[86:87], s[84:85]
    v_cmp_u_f32 vcc, v88, v92
    v_cmp_u_f32 s[0:1], v96, v96
    s_or_b64 vcc, vcc, s[0:1]
    s_or_b64 vcc, vcc, s[86:87]
    s_cmp_lg_u64 vcc, 0
    s_nop 1
    s_cbranch_scc1 REDO25
RBACK26:
    v_cvt_pk_bf16_f32 v88, v88, v89
    v_cvt_pk_bf16_f32 v89, v90, v91
    v_cvt_pk_bf16_f32 v92, v92, v93
    v_cvt_pk_bf16_f32 v93, v94, v95
    v_cvt_pk_bf16_f32 v96, v96, v97
    v_cvt_pk_bf16_f32 v97, v98, v99
    v_cvt_pk_bf16_f32 v100, v100, v101
    v_cvt_pk_bf16_f32 v101, v102, v103
    s_mov_b32 exec_hi, 0
    ds_write_b64 v60, v[88:89] offset:0
    ds_write_b64 v60, v[92:93] offset:1024
    ds_write_b64 v60, v[96:97] offset:2048
    s_mov_b32 exec_lo, s84
    ds_write_b64 v60, v[100:101] offset:3072
    s_mov_b64 exec, -1
    s_waitcnt lgkmcnt(0)
    s_barrier
    ds_read_b128 v[156:159], v39 offset:0
    ds_read_b128 v[160:163], v39 offset:32
    ds_read_b128 v[164:167], v39 offset:64
    ds_read_b128 v[120:123], v36 offset:0
    ds_read_b128 v[124:127], v36 offset:32
    ds_read_b128 v[128:131], v36 offset:64
    ds_read_b128 v[132:135], v37 offset:0
    ds_read_b128 v[136:139], v37 offset:32
    ds_read_b128 v[140:143], v37 offset:64
    ds_read_b128 v[144:147], v38 offset:0
    ds_read_b128 v[148:151], v38 offset:32
    ds_read_b128 v[152:155], v38 offset:64
    s_waitcnt lgkmcnt(11)
    v_mfma_f32_16x16x32_bf16 v[112:115], v[156:159], v[216:219], 0
    v_mfma_f32_16x16x32_bf16 v[116:119], v[156:159], v[220:223], 0
    s_waitcnt lgkmcnt(8)
    v_mfma_f32_16x16x32_bf16 v[88:91], v[120:123], v[216:219], 0
    v_mfma_f32_16x16x32_bf16 v[92:95], v[120:123], v[220:223], 0
    s_waitcnt lgkmcnt(5)
    v_mfma_f32_16x16x32_bf16 v[96:99], v[132:135], v[216:219], 0
    v_mfma_f32_16x16x32_bf16 v[100:103], v[132:135], v[220:223], 0
    s_waitcnt lgkmcnt(2)
    v_mfma_f32_16x16x32_bf16 v[104:107], v[144:147], v[216:219], 0
    v_mfma_f32_16x16x32_bf16 v[108:111], v[144:147], v[220:223], 0
    v_mfma_f32_16x16x32_bf16 v[112:115], v[160:163], v[224:227], v[112:115]
    v_mfma_f32_16x16x32_bf16 v[116:119], v[160:163], v[228:231], v[116:119]
    v_mfma_f32_16x16x32_bf16 v[88:91], v[124:127], v[224:227], v[88:91]
    v_mfma_f32_16x16x32_bf16 v[92:95], v[124:127], v[228:231], v[92:95]
    v_mfma_f32_16x16x32_bf16 v[96:99], v[136:139], v[224:227], v[96:99]
    v_mfma_f32_16x16x32_bf16 v[100:103], v[136:139], v[228:231], v[100:103]
    s_waitcnt lgkmcnt(1)
    v_mfma_f32_16x16x32_bf16 v[104:107], v[148:151], v[224:227], v[104:107]
    v_mfma_f32_16x16x32_bf16 v[108:111], v[148:151], v[228:231], v[108:111]
    v_mfma_f32_16x16x32_bf16 v[112:115], v[164:167], v[232:235], v[112:115]
    v_mfma_f32_16x16x32_bf16 v[116:119], v[164:167], v[236:239], v[116:119]
    v_mfma_f32_16x16x32_bf16 v[88:91], v[128:131], v[232:235], v[88:91]
    v_mfma_f32_16x16x32_bf16 v[92:95], v[128:131], v[236:239], v[92:95]
    v_mfma_f32_16x16x32_bf16 v[96:99], v[140:143], v[232:235], v[96:99]
    v_mfma_f32_16x16x32_bf16 v[100:103], v[140:143], v[236:239], v[100:103]
    s_waitcnt lgkmcnt(0)
    v_mfma_f32_16x16x32_bf16 v[104:107], v[152:155], v[232:235], v[104:107]
    v_mfma_f32_16x16x32_bf16 v[108:111], v[152:155], v[236:239], v[108:111]
    v_add_f32 v112, s71, v112
    v_add_f32 v113, s71, v113
    v_rcp_f32 v112, v112
    v_rcp_f32 v113, v113
    s_nop 0
    v_cndmask_b32 v114, v113, v112, s[76:77]
    v_mul_f32 v88, v112, v88
    v_mul_f32 v89, v112, v89
    v_mul_f32 v90, v112, v90
    v_mul_f32 v91, v112, v91
    v_cvt_pk_bf16_f32 v240, v88, v89
    v_cvt_pk_bf16_f32 v241, v90, v91
    v_mul_f32 v96, v114, v96
    v_mul_f32 v97, v114, v97
    v_mul_f32 v98, v114, v98
    v_mul_f32 v99, v114, v99
    v_cvt_pk_bf16_f32 v242, v96, v97
    v_cvt_pk_bf16_f32 v243, v98, v99
    v_mul_f32 v104, v113, v104
    v_mul_f32 v105, v113, v105
    v_mul_f32 v106, v113, v106
    v_mul_f32 v107, v113, v107
    v_cvt_pk_bf16_f32 v244, v104, v105
    v_cvt_pk_bf16_f32 v245, v106, v107
    v_add_f32 v116, s71, v116
    v_add_f32 v117, s71, v117
    v_rcp_f32 v116, v116
    v_rcp_f32 v117, v117
    s_nop 0
    v_cndmask_b32 v118, v117, v116, s[76:77]
    v_mul_f32 v92, v116, v92
    v_mul_f32 v93, v116, v93
    v_mul_f32 v94, v116, v94
    v_mul_f32 v95, v116, v95
    v_cvt_pk_bf16_f32 v246, v92, v93
    v_cvt_pk_bf16_f32 v247, v94, v95
    v_mul_f32 v100, v118, v100
    v_mul_f32 v101, v118, v101
    v_mul_f32 v102, v118, v102
    v_mul_f32 v103, v118, v103
    v_cvt_pk_bf16_f32 v248, v100, v101
    v_cvt_pk_bf16_f32 v249, v102, v103
    v_mul_f32 v108, v117, v108
    v_mul_f32 v109, v117, v109
    v_mul_f32 v110, v117, v110
    v_mul_f32 v111, v117, v111
    v_cvt_pk_bf16_f32 v250, v108, v109
    v_cvt_pk_bf16_f32 v251, v110, v111
    s_cmp_eq_u32 s50, 0
    s_nop 1
    s_cbranch_scc1 SLOW27
    buffer_store_dwordx4 v[240:243], v5, s[36:39], s57 offen offset:0
    buffer_store_dwordx4 v[246:249], v5, s[36:39], s57 offen offset:1024
    s_mov_b32 exec_hi, 0
    buffer_store_dwordx2 v[244:245], v6, s[36:39], s57 offen offset:0
    buffer_store_dwordx2 v[250:251], v6, s[36:39], s57 offen offset:1024
    s_mov_b64 exec, -1
BACK28:
    s_add_u32 s61, s61, 1
    v_add_u32 v13, s43, v4
    v_add_u32 v14, s43, v12
    v_mov_b32 v61, s61
    s_waitcnt vmcnt(0)
    s_cmp_eq_u32 s50, 0
    s_nop 0
    s_cbranch_scc1 SLOW29
    s_mov_b64 exec, 1
    buffer_store_dword v61, off, s[36:39], s60
    s_mov_b64 exec, -1
BACK30:
    ds_read_b128 v[128:131], v13 offset:0
    ds_read_b128 v[132:135], v13 offset:1024
    ds_read_b128 v[136:139], v14 offset:0
    ds_read_b128 v[140:143], v13 offset:2560
    ds_read_b128 v[144:147], v13 offset:3584
    ds_read_b128 v[204:207], v14 offset:2560
    ds_read_b128 v[208:211], v13 offset:5120
    ds_read_b128 v[212:215], v13 offset:6144
    s_mov_b32 s55, 131072
POB:
    buffer_load_dword v61, v9, s[36:39], 0 offen sc1
    s_waitcnt vmcnt(0)
    v_cmp_le_u32 vcc, s61, v61
    s_cmp_eq_u64 vcc, -1
    s_nop 3
    s_cbranch_scc1 POB_done
    s_sub_u32 s55, s55, 1
    s_cmp_eq_u32 s55, 0
    s_cbranch_scc1 ABORT
    s_branch POB
POB_done:
    s_add_u32 s67, s57, 0
    buffer_load_dwordx4 a[0:3], v4, s[36:39], s67 offen offset:0 sc1
    buffer_load_dwordx4 a[4:7], v4, s[36:39], s67 offen offset:1024 sc1
    buffer_load_dwordx4 a[8:11], v4, s[36:39], s67 offen offset:2048 sc1
    buffer_load_dwordx4 a[12:15], v4, s[36:39], s67 offen offset:3072 sc1
    s_add_u32 s67, s57, 4096
    buffer_load_dwordx4 a[16:19], v4, s[36:39], s67 offen offset:0 sc1
    buffer_load_dwordx4 a[20:23], v4, s[36:39], s67 offen offset:1024 sc1
    buffer_load_dwordx4 a[24:27], v4, s[36:39], s67 offen offset:2048 sc1
    buffer_load_dwordx4 a[28:31], v4, s[36:39], s67 offen offset:3072 sc1
    s_add_u32 s67, s57, 8192
    buffer_load_dwordx4 a[32:35], v4, s[36:39], s67 offen offset:0 sc1
    buffer_load_dwordx4 a[36:39], v4, s[36:39], s67 offen offset:1024 sc1
    buffer_load_dwordx4 a[40:43], v4, s[36:39], s67 offen offset:2048 sc1
    buffer_load_dwordx4 a[44:47], v4, s[36:39], s67 offen offset:3072 sc1
    s_waitcnt vmcnt(10) lgkmcnt(5)
    v_mfma_f32_16x16x32_bf16 v[64:67], v[128:131], a[0:3], v[64:67]
    s_add_u32 s67, s57, 12288
    v_mfma_f32_16x16x32_bf16 v[76:79], v[128:131], a[4:7], v[76:79]
    ds_read_b128 v[128:131], v14 offset:5120
    v_mfma_f32_16x16x32_bf16 v[68:71], v[132:135], a[0:3], v[68:71]
    buffer_load_dwordx4 a[48:51], v4, s[36:39], s67 offen offset:0 sc1
    v_mfma_f32_16x16x32_bf16 v[80:83], v[132:135], a[4:7], v[80:83]
    ds_read_b128 v[132:135], v13 offset:7680
    v_mfma_f32_16x16x32_bf16 v[72:75], v[136:139], a[0:3], v[72:75]
    buffer_load_dwordx4 a[52:55], v4, s[36:39], s67 offen offset:1024 sc1
    v_mfma_f32_16x16x32_bf16 v[84:87], v[136:139], a[4:7], v[84:87]
    ds_read_b128 v[136:139], v13 offset:8704
    s_waitcnt vmcnt(10) lgkmcnt(5)
    v_mfma_f32_16x16x32_bf16 v[64:67], v[140:143], a[8:11], v[64:67]
    buffer_load_dwordx4 a[56:59], v4, s[36:39], s67 offen offset:2048 sc1
    v_mfma_f32_16x16x32_bf16 v[76:79], v[140:143], a[12:15], v[76:79]
    ds_read_b128 v[140:143], v14 offset:7680
    v_mfma_f32_16x16x32_bf16 v[68:71], v[144:147], a[8:11], v[68:71]
    v_mfma_f32_16x16x32_bf16 v[80:83], v[144:147], a[12:15], v[80:83]
    ds_read_b128 v[144:147], v13 offset:10240
    v_mfma_f32_16x16x32_bf16 v[72:75], v[204:207], a[8:11], v[72:75]
    buffer_load_dwordx4 a[60:63], v4, s[36:39], s67 offen offset:3072 sc1
    v_mfma_f32_16x16x32_bf16 v[84:87], v[204:207], a[12:15], v[84:87]
    ds_read_b128 v[204:207], v13 offset:11264
    s_waitcnt vmcnt(10) lgkmcnt(5)
    v_mfma_f32_16x16x32_bf16 v[64:67], v[208:211], a[16:19], v[64:67]
    s_add_u32 s67, s57, 16384
    v_mfma_f32_16x16x32_bf16 v[76:79], v[208:211], a[20:23], v[76:79]
    ds_read_b128 v[208:211], v14 offset:10240
    v_mfma_f32_16x16x32_bf16 v[68:71], v[212:215], a[16:19], v[68:71]
    buffer_load_dwordx4 a[64:67], v4, s[36:39], s67 offen offset:0 sc1
    v_mfma_f32_16x16x32_bf16 v[80:83], v[212:215], a[20:23], v[80:83]
    ds_read_b128 v[212:215], v13 offset:12800
    v_mfma_f32_16x16x32_bf16 v[72:75], v[128:131], a[16:19], v[72:75]
    buffer_load_dwordx4 a[68:71], v4, s[36:39], s67 offen offset:1024 sc1
    v_mfma_f32_16x16x32_bf16 v[84:87], v[128:131], a[20:23], v[84:87]
    ds_read_b128 v[128:131], v13 offset:13824
    s_waitcnt vmcnt(10) lgkmcnt(5)
    v_mfma_f32_16x16x32_bf16 v[64:67], v[132:135], a[24:27], v[64:67]
    buffer_load_dwordx4 a[72:75], v4, s[36:39], s67 offen offset:2048 sc1
    v_mfma_f32_16x16x32_bf16 v[76:79], v[132:135], a[28:31], v[76:79]
    ds_read_b128 v[132:135], v14 offset:12800
    v_mfma_f32_16x16x32_bf16 v[68:71], v[136:139], a[24:27], v[68:71]
    v_mfma_f32_16x16x32_bf16 v[80:83], v[136:139], a[28:31], v[80:83]
    ds_read_b128 v[136:139], v13 offset:15360
    v_mfma_f32_16x16x32_bf16 v[72:75], v[140:143], a[24:27], v[72:75]
    buffer_load_dwordx4 a[76:79], v4, s[36:39], s67 offen offset:3072 sc1
    v_mfma_f32_16x16x32_bf16 v[84:87], v[140:143], a[28:31], v[84:87]
    ds_read_b128 v[140:143], v13 offset:16384
    s_waitcnt vmcnt(10) lgkmcnt(5)
    v_mfma_f32_16x16x32_bf16 v[64:67], v[144:147], a[32:35], v[64:67]
    s_add_u32 s67, s57, 20480
    v_mfma_f32_16x16x32_bf16 v[76:79], v[144:147], a[36:39], v[76:79]
    ds_read_b128 v[144:147], v14 offset:15360
    v_mfma_f32_16x16x32_bf16 v[68:71], v[204:207], a[32:35], v[68:71]
    buffer_load_dwordx4 a[80:83], v4, s[36:39], s67 offen offset:0 sc1
    v_mfma_f32_16x16x32_bf16 v[80:83], v[204:207], a[36:39], v[80:83]
    ds_read_b128 v[204:207], v13 offset:17920
    v_mfma_f32_16x16x32_bf16 v[72:75], v[208:211], a[32:35], v[72:75]
    buffer_load_dwordx4 a[84:87], v4, s[36:39], s67 offen offset:1024 sc1
    v_mfma_f32_16x16x32_bf16 v[84:87], v[208:211], a[36:39], v[84:87]
    ds_read_b128 v[208:211], v13 offset:18944
    s_waitcnt vmcnt(10) lgkmcnt(5)
    v_mfma_f32_16x16x32_bf16 v[64:67], v[212:215], a[40:43], v[64:67]
    buffer_load_dwordx4 a[88:91], v4, s[36:39], s67 offen offset:2048 sc1
    v_mfma_f32_16x16x32_bf16 v[76:79], v[212:215], a[44:47], v[76:79]
    ds_read_b128 v[212:215], v14 offset:17920
    v_mfma_f32_16x16x32_bf16 v[68:71], v[128:131], a[40:43], v[68:71]
    v_mfma_f32_16x16x32_bf16 v[80:83], v[128:131], a[44:47], v[80:83]
    ds_read_b128 v[128:131], v13 offset:20480
    v_mfma_f32_16x16x32_bf16 v[72:75], v[132:135], a[40:43], v[72:75]
    buffer_load_dwordx4 a[92:95], v4, s[36:39], s67 offen offset:3072 sc1
    v_mfma_f32_16x16x32_bf16 v[84:87], v[132:135], a[44:47], v[84:87]
    ds_read_b128 v[132:135], v13 offset:21504
    s_waitcnt vmcnt(10) lgkmcnt(5)
    v_mfma_f32_16x16x32_bf16 v[64:67], v[136:139], a[48:51], v[64:67]
    s_add_u32 s67, s57, 24576
    v_mfma_f32_16x16x32_bf16 v[76:79], v[136:139], a[52:55], v[76:79]
    ds_read_b128 v[136:139], v14 offset:20480
    v_mfma_f32_16x16x32_bf16 v[68:71], v[140:143], a[48:51], v[68:71]
    buffer_load_dwordx4 a[96:99], v4, s[36:39], s67 offen offset:0 sc1
    v_mfma_f32_16x16x32_bf16 v[80:83], v[140:143], a[52:55], v[80:83]
    ds_read_b128 v[140:143], v13 offset:23040
    v_mfma_f32_16x16x32_bf16 v[72:75], v[144:147], a[48:51], v[72:75]
    buffer_load_dwordx4 a[100:103], v4, s[36:39], s67 offen offset:1024 sc1
    v_mfma_f32_16x16x32_bf16 v[84:87], v[144:147], a[52:55], v[84:87]
    ds_read_b128 v[144:147], v13 offset:24064
    s_waitcnt vmcnt(10) lgkmcnt(5)
    v_mfma_f32_16x16x32_bf16 v[64:67], v[204:207], a[56:59], v[64:67]
    buffer_load_dwordx4 a[104:107], v4, s[36:39], s67 offen offset:2048 sc1
    v_mfma_f32_16x16x32_bf16 v[76:79], v[204:207], a[60:63], v[76:79]
    ds_read_b128 v[204:207], v14 offset:23040
    v_mfma_f32_16x16x32_bf16 v[68:71], v[208:211], a[56:59], v[68:71]
    v_mfma_f32_16x16x32_bf16 v[80:83], v[208:211], a[60:63], v[80:83]
    ds_read_b128 v[208:211], v13 offset:25600
    v_mfma_f32_16x16x32_bf16 v[72:75], v[212:215], a[56:59], v[72:75]
    buffer_load_dwordx4 a[108:111], v4, s[36:39], s67 offen offset:3072 sc1
    v_mfma_f32_16x16x32_bf16 v[84:87], v[212:215], a[60:63], v[84:87]
    ds_read_b128 v[212:215], v13 offset:26624
    s_waitcnt vmcnt(10) lgkmcnt(5)
    v_mfma_f32_16x16x32_bf16 v[64:67], v[128:131], a[64:67], v[64:67]
    s_add_u32 s67, s57, 28672
    v_mfma_f32_16x16x32_bf16 v[76:79], v[128:131], a[68:71], v[76:79]
    ds_read_b128 v[128:131], v14 offset:25600
    v_mfma_f32_16x16x32_bf16 v[68:71], v[132:135], a[64:67], v[68:71]
    buffer_load_dwordx4 a[112:115], v4, s[36:39], s67 offen offset:0 sc1
    v_mfma_f32_16x16x32_bf16 v[80:83], v[132:135], a[68:71], v[80:83]
    ds_read_b128 v[132:135], v13 offset:28160
    v_mfma_f32_16x16x32_bf16 v[72:75], v[136:139], a[64:67], v[72:75]
    buffer_load_dwordx4 a[116:119], v4, s[36:39], s67 offen offset:1024 sc1
    v_mfma_f32_16x16x32_bf16 v[84:87], v[136:139], a[68:71], v[84:87]
    ds_read_b128 v[136:139], v13 offset:29184
    s_waitcnt vmcnt(10) lgkmcnt(5)
    v_mfma_f32_16x16x32_bf16 v[64:67], v[140:143], a[72:75], v[64:67]
    buffer_load_dwordx4 a[120:123], v4, s[36:39], s67 offen offset:2048 sc1
    v_mfma_f32_16x16x32_bf16 v[76:79], v[140:143], a[76:79], v[76:79]
    ds_read_b128 v[140:143], v14 offset:28160
    v_mfma_f32_16x16x32_bf16 v[68:71], v[144:147], a[72:75], v[68:71]
    v_mfma_f32_16x16x32_bf16 v[80:83], v[144:147], a[76:79], v[80:83]
    ds_read_b128 v[144:147], v13 offset:30720
    v_mfma_f32_16x16x32_bf16 v[72:75], v[204:207], a[72:75], v[72:75]
    buffer_load_dwordx4 a[124:127], v4, s[36:39], s67 offen offset:3072 sc1
    v_mfma_f32_16x16x32_bf16 v[84:87], v[204:207], a[76:79], v[84:87]
    ds_read_b128 v[204:207], v13 offset:31744
    s_waitcnt vmcnt(10) lgkmcnt(5)
    v_mfma_f32_16x16x32_bf16 v[64:67], v[208:211], a[80:83], v[64:67]
    s_add_u32 s67, s57, 32768
    v_mfma_f32_16x16x32_bf16 v[76:79], v[208:211], a[84:87], v[76:79]
    ds_read_b128 v[208:211], v14 offset:30720
    v_mfma_f32_16x16x32_bf16 v[68:71], v[212:215], a[80:83], v[68:71]
    buffer_load_dwordx4 a[128:131], v4, s[36:39], s67 offen offset:0 sc1
    v_mfma_f32_16x16x32_bf16 v[80:83], v[212:215], a[84:87], v[80:83]
    ds_read_b128 v[212:215], v13 offset:33280
    v_mfma_f32_16x16x32_bf16 v[72:75], v[128:131], a[80:83], v[72:75]
    buffer_load_dwordx4 a[132:135], v4, s[36:39], s67 offen offset:1024 sc1
    v_mfma_f32_16x16x32_bf16 v[84:87], v[128:131], a[84:87], v[84:87]
    ds_read_b128 v[128:131], v13 offset:34304
    s_waitcnt vmcnt(10) lgkmcnt(5)
    v_mfma_f32_16x16x32_bf16 v[64:67], v[132:135], a[88:91], v[64:67]
    buffer_load_dwordx4 a[136:139], v4, s[36:39], s67 offen offset:2048 sc1
    v_mfma_f32_16x16x32_bf16 v[76:79], v[132:135], a[92:95], v[76:79]
    ds_read_b128 v[132:135], v14 offset:33280
    v_mfma_f32_16x16x32_bf16 v[68:71], v[136:139], a[88:91], v[68:71]
    v_mfma_f32_16x16x32_bf16 v[80:83], v[136:139], a[92:95], v[80:83]
    ds_read_b128 v[136:139], v13 offset:35840
    v_mfma_f32_16x16x32_bf16 v[72:75], v[140:143], a[88:91], v[72:75]
    buffer_load_dwordx4 a[140:143], v4, s[36:39], s67 offen offset:3072 sc1
    v_mfma_f32_16x16x32_bf16 v[84:87], v[140:143], a[92:95], v[84:87]
    ds_read_b128 v[140:143], v13 offset:36864
    s_waitcnt vmcnt(10) lgkmcnt(5)
    v_mfma_f32_16x16x32_bf16 v[64:67], v[144:147], a[96:99], v[64:67]
    s_add_u32 s67, s57, 36864
    v_mfma_f32_16x16x32_bf16 v[76:79], v[144:147], a[100:103], v[76:79]
    ds_read_b128 v[144:147], v14 offset:35840
    v_mfma_f32_16x16x32_bf16 v[68:71], v[204:207], a[96:99], v[68:71]
    buffer_load_dwordx4 a[144:147], v4, s[36:39], s67 offen offset:0 sc1
    v_mfma_f32_16x16x32_bf16 v[80:83], v[204:207], a[100:103], v[80:83]
    ds_read_b128 v[204:207], v13 offset:38400
    v_mfma_f32_16x16x32_bf16 v[72:75], v[208:211], a[96:99], v[72:75]
    buffer_load_dwordx4 a[148:151], v4, s[36:39], s67 offen offset:1024 sc1
    v_mfma_f32_16x16x32_bf16 v[84:87], v[208:211], a[100:103], v[84:87]
    ds_read_b128 v[208:211], v13 offset:39424
    s_waitcnt vmcnt(10) lgkmcnt(5)
    v_mfma_f32_16x16x32_bf16 v[64:67], v[212:215], a[104:107], v[64:67]
    buffer_load_dwordx4 a[152:155], v4, s[36:39], s67 offen offset:2048 sc1
    v_mfma_f32_16x16x32_bf16 v[76:79], v[212:215], a[108:111], v[76:79]
    ds_read_b128 v[212:215], v14 offset:38400
    v_mfma_f32_16x16x32_bf16 v[68:71], v[128:131], a[104:107], v[68:71]
    v_mfma_f32_16x16x32_bf16 v[80:83], v[128:131], a[108:111], v[80:83]
    ds_read_b128 v[128:131], v13 offset:40960
    v_mfma_f32_16x16x32_bf16 v[72:75], v[132:135], a[104:107], v[72:75]
    buffer_load_dwordx4 a[156:159], v4, s[36:39], s67 offen offset:3072 sc1
    v_mfma_f32_16x16x32_bf16 v[84:87], v[132:135], a[108:111], v[84:87]
    ds_read_b128 v[132:135], v13 offset:41984
    s_waitcnt vmcnt(10) lgkmcnt(5)
    v_mfma_f32_16x16x32_bf16 v[64:67], v[136:139], a[112:115], v[64:67]
    v_mfma_f32_16x16x32_bf16 v[76:79], v[136:139], a[116:119], v[76:79]
    ds_read_b128 v[136:139], v14 offset:40960
    v_mfma_f32_16x16x32_bf16 v[68:71], v[140:143], a[112:115], v[68:71]
    v_mfma_f32_16x16x32_bf16 v[80:83], v[140:143], a[116:119], v[80:83]
    ds_read_b128 v[140:143], v13 offset:43520
    v_mfma_f32_16x16x32_bf16 v[72:75], v[144:147], a[112:115], v[72:75]
    v_mfma_f32_16x16x32_bf16 v[84:87], v[144:147], a[116:119], v[84:87]
    ds_read_b128 v[144:147], v13 offset:44544
    s_waitcnt vmcnt(8) lgkmcnt(5)
    v_mfma_f32_16x16x32_bf16 v[64:67], v[204:207], a[120:123], v[64:67]
    v_mfma_f32_16x16x32_bf16 v[76:79], v[204:207], a[124:127], v[76:79]
    ds_read_b128 v[204:207], v14 offset:43520
    v_mfma_f32_16x16x32_bf16 v[68:71], v[208:211], a[120:123], v[68:71]
    v_mfma_f32_16x16x32_bf16 v[80:83], v[208:211], a[124:127], v[80:83]
    ds_read_b128 v[208:211], v13 offset:46080
    v_mfma_f32_16x16x32_bf16 v[72:75], v[212:215], a[120:123], v[72:75]
    v_mfma_f32_16x16x32_bf16 v[84:87], v[212:215], a[124:127], v[84:87]
    ds_read_b128 v[212:215], v13 offset:47104
    s_waitcnt vmcnt(6) lgkmcnt(5)
    v_mfma_f32_16x16x32_bf16 v[64:67], v[128:131], a[128:131], v[64:67]
    v_mfma_f32_16x16x32_bf16 v[76:79], v[128:131], a[132:135], v[76:79]
    ds_read_b128 v[128:131], v14 offset:46080
    v_mfma_f32_16x16x32_bf16 v[68:71], v[132:135], a[128:131], v[68:71]
    v_mfma_f32_16x16x32_bf16 v[80:83], v[132:135], a[132:135], v[80:83]
    ds_read_b128 v[132:135], v13 offset:48640
    v_mfma_f32_16x16x32_bf16 v[72:75], v[136:139], a[128:131], v[72:75]
    v_mfma_f32_16x16x32_bf16 v[84:87], v[136:139], a[132:135], v[84:87]
    ds_read_b128 v[136:139], v13 offset:49664
    s_waitcnt vmcnt(4) lgkmcnt(5)
    v_mfma_f32_16x16x32_bf16 v[64:67], v[140:143], a[136:139], v[64:67]
    v_mfma_f32_16x16x32_bf16 v[76:79], v[140:143], a[140:143], v[76:79]
    ds_read_b128 v[140:143], v14 offset:48640
    v_mfma_f32_16x16x32_bf16 v[68:71], v[144:147], a[136:139], v[68:71]
    v_mfma_f32_16x16x32_bf16 v[80:83], v[144:147], a[140:143], v[80:83]
    v_mfma_f32_16x16x32_bf16 v[72:75], v[204:207], a[136:139], v[72:75]
    v_mfma_f32_16x16x32_bf16 v[84:87], v[204:207], a[140:143], v[84:87]
    s_waitcnt vmcnt(2) lgkmcnt(3)
    v_mfma_f32_16x16x32_bf16 v[64:67], v[208:211], a[144:147], v[64:67]
    v_mfma_f32_16x16x32_bf16 v[76:79], v[208:211], a[148:151], v[76:79]
    v_mfma_f32_16x16x32_bf16 v[68:71], v[212:215], a[144:147], v[68:71]
    v_mfma_f32_16x16x32_bf16 v[80:83], v[212:215], a[148:151], v[80:83]
    v_mfma_f32_16x16x32_bf16 v[72:75], v[128:131], a[144:147], v[72:75]
    v_mfma_f32_16x16x32_bf16 v[84:87], v[128:131], a[148:151], v[84:87]
    s_waitcnt vmcnt(0) lgkmcnt(0)
    v_mfma_f32_16x16x32_bf16 v[64:67], v[132:135], a[152:155], v[64:67]
    v_mfma_f32_16x16x32_bf16 v[76:79], v[132:135], a[156:159], v[76:79]
    v_mfma_f32_16x16x32_bf16 v[68:71], v[136:139], a[152:155], v[68:71]
    v_mfma_f32_16x16x32_bf16 v[80:83], v[136:139], a[156:159], v[80:83]
    v_mfma_f32_16x16x32_bf16 v[72:75], v[140:143], a[152:155], v[72:75]
    v_mfma_f32_16x16x32_bf16 v[84:87], v[140:143], a[156:159], v[84:87]
    s_add_u32 s58, s58, 0x10000
    s_add_u32 s59, s59, 0x10000
    s_mov_b32 s66, s43
    s_mov_b32 s43, s44
    s_mov_b32 s44, s45
    s_mov_b32 s45, s66
    s_mov_b32 s66, s46
    s_mov_b32 s46, s47
    s_mov_b32 s47, s66
    s_cmp_lg_u32 s52, 0
    s_cbranch_scc1 FINAL
    v_cvt_pk_bf16_f32 v216, v64, v65
    v_cvt_pk_bf16_f32 v217, v66, v67
    v_cvt_pk_bf16_f32 v218, v68, v69
    v_cvt_pk_bf16_f32 v219, v70, v71
    v_cvt_pk_bf16_f32 v220, v72, v73
    v_cvt_pk_bf16_f32 v221, v74, v75
    v_cvt_pk_bf16_f32 v222, v76, v77
    v_cvt_pk_bf16_f32 v223, v78, v79
    v_cvt_pk_bf16_f32 v224, v80, v81
    v_cvt_pk_bf16_f32 v225, v82, v83
    v_cvt_pk_bf16_f32 v226, v84, v85
    v_cvt_pk_bf16_f32 v227, v86, v87
    s_cmp_eq_u32 s50, 0
    s_nop 1
    s_cbranch_scc1 SLOW31
    buffer_store_dwordx4 v[216:219], v5, s[36:39], s56 offen offset:0
    buffer_store_dwordx4 v[222:225], v5, s[36:39], s56 offen offset:1024
    s_mov_b32 exec_hi, 0
    buffer_store_dwordx2 v[220:221], v6, s[36:39], s56 offen offset:0
    buffer_store_dwordx2 v[226:227], v6, s[36:39], s56 offen offset:1024
    s_mov_b64 exec, -1
BACK32:
    v_lshlrev_b32 v64, 16, v216
    v_and_b32 v65, 0xffff0000, v216
    v_lshlrev_b32 v66, 16, v217
    v_and_b32 v67, 0xffff0000, v217
    v_lshlrev_b32 v68, 16, v218
    v_and_b32 v69, 0xffff0000, v218
    v_lshlrev_b32 v70, 16, v219
    v_and_b32 v71, 0xffff0000, v219
    v_lshlrev_b32 v72, 16, v220
    v_and_b32 v73, 0xffff0000, v220
    v_lshlrev_b32 v74, 16, v221
    v_and_b32 v75, 0xffff0000, v221
    v_lshlrev_b32 v76, 16, v222
    v_and_b32 v77, 0xffff0000, v222
    v_lshlrev_b32 v78, 16, v223
    v_and_b32 v79, 0xffff0000, v223
    v_lshlrev_b32 v80, 16, v224
    v_and_b32 v81, 0xffff0000, v224
    v_lshlrev_b32 v82, 16, v225
    v_and_b32 v83, 0xffff0000, v225
    v_lshlrev_b32 v84, 16, v226
    v_and_b32 v85, 0xffff0000, v226
    v_lshlrev_b32 v86, 16, v227
    v_and_b32 v87, 0xffff0000, v227
    v_add_f32 v228, v72, v73
    v_mul_f32 v229, v72, v72
    v_add_f32 v228, v228, v74
    v_fmac_f32 v229, v73, v73
    v_add_f32 v228, v228, v75
    v_fmac_f32 v229, v74, v74
    v_fmac_f32 v229, v75, v75
    v_add_f32 v230, v84, v85
    v_mul_f32 v231, v84, v84
    v_add_f32 v230, v230, v86
    v_fmac_f32 v231, v85, v85
    v_add_f32 v230, v230, v87
    v_fmac_f32 v231, v86, v86
    v_fmac_f32 v231, v87, v87
    s_mov_b32 exec_lo, 0
    v_mov_b32 v228, 0
    v_mov_b32 v229, 0
    v_mov_b32 v230, 0
    v_mov_b32 v231, 0
    s_mov_b64 exec, -1
    v_add_f32 v228, v228, v64
    v_fmac_f32 v229, v64, v64
    v_add_f32 v228, v228, v65
    v_fmac_f32 v229, v65, v65
    v_add_f32 v228, v228, v66
    v_fmac_f32 v229, v66, v66
    v_add_f32 v228, v228, v67
    v_fmac_f32 v229, v67, v67
    v_add_f32 v228, v228, v68
    v_fmac_f32 v229, v68, v68
    v_add_f32 v228, v228, v69
    v_fmac_f32 v229, v69, v69
    v_add_f32 v228, v228, v70
    v_fmac_f32 v229, v70, v70
    v_add_f32 v228, v228, v71
    v_fmac_f32 v229, v71, v71
    v_add_f32 v230, v230, v76
    v_fmac_f32 v231, v76, v76
    v_add_f32 v230, v230, v77
    v_fmac_f32 v231, v77, v77
    v_add_f32 v230, v230, v78
    v_fmac_f32 v231, v78, v78
    v_add_f32 v230, v230, v79
    v_fmac_f32 v231, v79, v79
    v_add_f32 v230, v230, v80
    v_fmac_f32 v231, v80, v80
    v_add_f32 v230, v230, v81
    v_fmac_f32 v231, v81, v81
    v_add_f32 v230, v230, v82
    v_fmac_f32 v231, v82, v82
    v_add_f32 v230, v230, v83
    v_fmac_f32 v231, v83, v83
    v_permlane32_swap_b32 v228, v229
    s_nop 0
    v_permlane32_swap_b32 v230, v231
    v_add_f32 v228, v228, v229
    v_add_f32 v230, v230, v231
    s_nop 1
    v_permlane16_swap_b32 v228, v230
    v_add_f32 v228, v228, v230
    s_cmp_eq_u32 s50, 0
    s_nop 1
    s_cbranch_scc1 SLOW33
    buffer_store_dword v228, v7, s[36:39], s56 offen
BACK34:
    s_add_u32 s61, s61, 1
    v_mov_b32 v61, s61
    s_waitcnt vmcnt(0)
    s_cmp_eq_u32 s50, 0
    s_nop 0
    s_cbranch_scc1 SLOW35
    s_mov_b64 exec, 1
    buffer_store_dword v61, off, s[36:39], s60
    s_mov_b64 exec, -1
BACK36:
    s_add_u32 s52, s52, 1
    s_branch LOOP
OUT5:
    s_mov_b64 exec, 1
    buffer_store_dword v238, off, s[36:39], s51 sc1
    s_mov_b64 exec, -1
    s_branch RET6
OUT7:
    s_mov_b32 s55, 131072
    s_waitcnt vmcnt(5)
PI2:
    v_cmp_le_u32 vcc, 2, v54
    s_cmp_eq_u64 vcc, -1
    s_nop 3
    s_cbranch_scc1 PI2_done
    s_sub_u32 s55, s55, 1
    s_cmp_eq_u32 s55, 0
    s_cbranch_scc1 ABORT
    buffer_load_dword v54, v11, s[36:39], 0 offen sc1
    s_waitcnt vmcnt(0)
    s_branch PI2
PI2_done:
    s_branch RET8
OUT9:
    s_add_u32 s66, s88, 0x40000
    buffer_load_dwordx4 v[224:227], v50, s[36:39], s66 offen offset:0 sc1
    buffer_load_dwordx4 v[228:231], v50, s[36:39], s66 offen offset:1024 sc1
    buffer_load_dwordx4 v[232:235], v50, s[36:39], s66 offen offset:2048 sc1
    buffer_load_dwordx4 v[236:239], v50, s[36:39], s66 offen offset:3072 sc1
    s_branch RET10
OUT11:
    s_waitcnt vmcnt(17)
    v_add_f32 v224, v224, v228
    v_add_f32 v232, v232, v236
    v_add_f32 v225, v225, v229
    v_add_f32 v233, v233, v237
    v_add_f32 v226, v226, v230
    v_add_f32 v234, v234, v238
    v_add_f32 v227, v227, v231
    v_add_f32 v235, v235, v239
    v_add_f32 v224, v224, v232
    v_add_f32 v225, v225, v233
    v_add_f32 v226, v226, v234
    v_add_f32 v227, v227, v235
    v_permlane32_swap_b32 v224, v225
    s_nop 0
    v_permlane32_swap_b32 v226, v227
    v_add_f32 v224, v224, v225
    v_add_f32 v226, v226, v227
    s_nop 1
    v_permlane16_swap_b32 v224, v226
    v_add_f32 v224, v224, v226
    s_mov_b32 exec_lo, 0xffffff
    s_mov_b32 exec_hi, 0xffff
    ds_write_b32 v51, v224 offset:512
    s_mov_b64 exec, -1
    s_branch RET12
REDO13:
    s_sub_u32 s53, s53, 1
    s_cbranch_scc1 RGIVE37
    s_waitcnt vmcnt(0) lgkmcnt(0)
    s_add_u32 s3, s59, 0
    buffer_load_dwordx4 a[0:3], v59, s[36:39], s3 offen offset:0 sc1
    s_mov_b64 exec, s[100:101]
    buffer_load_dwordx4 a[4:7], v59, s[36:39], s3 offen offset:1024 sc1
    s_mov_b64 exec, -1
    s_add_u32 s3, s59, 16384
    buffer_load_dwordx4 a[8:11], v59, s[36:39], s3 offen offset:0 sc1
    s_mov_b64 exec, s[100:101]
    buffer_load_dwordx4 a[12:15], v59, s[36:39], s3 offen offset:1024 sc1
    s_mov_b64 exec, -1
    s_add_u32 s3, s59, 32768
    buffer_load_dwordx4 a[16:19], v59, s[36:39], s3 offen offset:0 sc1
    s_mov_b64 exec, s[100:101]
    buffer_load_dwordx4 a[20:23], v59, s[36:39], s3 offen offset:1024 sc1
    s_mov_b64 exec, -1
    s_add_u32 s3, s59, 49152
    buffer_load_dwordx4 a[24:27], v59, s[36:39], s3 offen offset:0 sc1
    s_mov_b64 exec, s[100:101]
    buffer_load_dwordx4 a[28:31], v59, s[36:39], s3 offen offset:1024 sc1
    s_mov_b64 exec, -1
    s_waitcnt vmcnt(6)
    v_mfma_f32_16x16x32_bf16 v[88:91], a[240:243], a[0:3], 0
    v_mfma_f32_16x16x32_bf16 v[92:95], a[240:243], a[4:7], 0
    s_waitcnt vmcnt(4)
    v_mfma_f32_16x16x32_bf16 v[88:91], a[240:243], a[8:11], v[88:91]
    v_mfma_f32_16x16x32_bf16 v[92:95], a[240:243], a[12:15], v[92:95]
    s_waitcnt vmcnt(2)
    v_mfma_f32_16x16x32_bf16 v[88:91], a[240:243], a[16:19], v[88:91]
    v_mfma_f32_16x16x32_bf16 v[92:95], a[240:243], a[20:23], v[92:95]
    s_waitcnt vmcnt(0)
    v_mfma_f32_16x16x32_bf16 v[88:91], a[240:243], a[24:27], v[88:91]
    v_mfma_f32_16x16x32_bf16 v[92:95], a[240:243], a[28:31], v[92:95]
    s_nop 7
    v_cmp_u_f32 s[86:87], v92, v92
    s_and_b64 s[86:87], s[86:87], s[100:101]
    s_waitcnt vmcnt(0) lgkmcnt(0)
    v_cmp_u_f32 vcc, v88, v88
    s_or_b64 vcc, vcc, s[86:87]
    s_cmp_lg_u64 vcc, 0
    s_nop 2
    s_cbranch_scc1 REDO13
    s_branch RBACK14
RGIVE37:
    s_mov_b32 s53, 0
    s_branch RBACK14
SLOW15:
    buffer_store_dwordx4 v[240:243], v5, s[36:39], s57 offen offset:0 sc1
    buffer_store_dwordx4 v[246:249], v5, s[36:39], s57 offen offset:1024 sc1
    s_mov_b32 exec_hi, 0
    buffer_store_dwordx2 v[244:245], v6, s[36:39], s57 offen offset:0 sc1
    buffer_store_dwordx2 v[250:251], v6, s[36:39], s57 offen offset:1024 sc1
    s_mov_b64 exec, -1
    s_branch BACK16
SLOW17:
    s_mov_b64 exec, 1
    buffer_store_dword v61, off, s[36:39], s60 sc1
    s_mov_b64 exec, -1
    s_branch BACK18
SLOW19:
    buffer_store_dwordx4 v[216:219], v5, s[36:39], s56 offen offset:0 sc1
    buffer_store_dwordx4 v[222:225], v5, s[36:39], s56 offen offset:1024 sc1
    s_mov_b32 exec_hi, 0
    buffer_store_dwordx2 v[220:221], v6, s[36:39], s56 offen offset:0 sc1
    buffer_store_dwordx2 v[226:227], v6, s[36:39], s56 offen offset:1024 sc1
    s_mov_b64 exec, -1
    s_branch BACK20
SLOW21:
    buffer_store_dword v228, v7, s[36:39], s56 offen sc1
    s_branch BACK22
SLOW23:
    s_mov_b64 exec, 1
    buffer_store_dword v61, off, s[36:39], s60 sc1
    s_mov_b64 exec, -1
    s_branch BACK24
REDO25:
    s_sub_u32 s53, s53, 1
    s_cbranch_scc1 RGIVE38
    s_waitcnt vmcnt(0) lgkmcnt(0)
    s_add_u32 s3, s59, 0
    buffer_load_dwordx4 a[0:3], v59, s[36:39], s3 offen offset:0 sc1
    buffer_load_dwordx4 a[4:7], v59, s[36:39], s3 offen offset:1024 sc1
    buffer_load_dwordx4 a[8:11], v59, s[36:39], s3 offen offset:2048 sc1
    s_mov_b64 exec, s[84:85]
    buffer_load_dwordx4 a[12:15], v59, s[36:39], s3 offen offset:3072 sc1
    s_mov_b64 exec, -1
    s_add_u32 s3, s59, 16384
    buffer_load_dwordx4 a[16:19], v59, s[36:39], s3 offen offset:0 sc1
    buffer_load_dwordx4 a[20:23], v59, s[36:39], s3 offen offset:1024 sc1
    buffer_load_dwordx4 a[24:27], v59, s[36:39], s3 offen offset:2048 sc1
    s_mov_b64 exec, s[84:85]
    buffer_load_dwordx4 a[28:31], v59, s[36:39], s3 offen offset:3072 sc1
    s_mov_b64 exec, -1
    s_add_u32 s3, s59, 32768
    buffer_load_dwordx4 a[32:35], v59, s[36:39], s3 offen offset:0 sc1
    buffer_load_dwordx4 a[36:39], v59, s[36:39], s3 offen offset:1024 sc1
    buffer_load_dwordx4 a[40:43], v59, s[36:39], s3 offen offset:2048 sc1
    s_mov_b64 exec, s[84:85]
    buffer_load_dwordx4 a[44:47], v59, s[36:39], s3 offen offset:3072 sc1
    s_mov_b64 exec, -1
    s_add_u32 s3, s59, 49152
    buffer_load_dwordx4 a[48:51], v59, s[36:39], s3 offen offset:0 sc1
    buffer_load_dwordx4 a[52:55], v59, s[36:39], s3 offen offset:1024 sc1
    buffer_load_dwordx4 a[56:59], v59, s[36:39], s3 offen offset:2048 sc1
    s_mov_b64 exec, s[84:85]
    buffer_load_dwordx4 a[60:63], v59, s[36:39], s3 offen offset:3072 sc1
    s_mov_b64 exec, -1
    s_waitcnt vmcnt(12)
    v_mfma_f32_16x16x32_bf16 v[88:91], a[240:243], a[0:3], 0
    v_mfma_f32_16x16x32_bf16 v[92:95], a[240:243], a[4:7], 0
    v_mfma_f32_16x16x32_bf16 v[96:99], a[240:243], a[8:11], 0
    v_mfma_f32_16x16x32_bf16 v[100:103], a[240:243], a[12:15], 0
    s_waitcnt vmcnt(8)
    v_mfma_f32_16x16x32_bf16 v[88:91], a[240:243], a[16:19], v[88:91]
    v_mfma_f32_16x16x32_bf16 v[92:95], a[240:243], a[20:23], v[92:95]
    v_mfma_f32_16x16x32_bf16 v[96:99], a[240:243], a[24:27], v[96:99]
    v_mfma_f32_16x16x32_bf16 v[100:103], a[240:243], a[28:31], v[100:103]
    s_waitcnt vmcnt(4)
    v_mfma_f32_16x16x32_bf16 v[88:91], a[240:243], a[32:35], v[88:91]
    v_mfma_f32_16x16x32_bf16 v[92:95], a[240:243], a[36:39], v[92:95]
    v_mfma_f32_16x16x32_bf16 v[96:99], a[240:243], a[40:43], v[96:99]
    v_mfma_f32_16x16x32_bf16 v[100:103], a[240:243], a[44:47], v[100:103]
    s_waitcnt vmcnt(0)
    v_mfma_f32_16x16x32_bf16 v[88:91], a[240:243], a[48:51], v[88:91]
    v_mfma_f32_16x16x32_bf16 v[92:95], a[240:243], a[52:55], v[92:95]
    v_mfma_f32_16x16x32_bf16 v[96:99], a[240:243], a[56:59], v[96:99]
    v_mfma_f32_16x16x32_bf16 v[100:103], a[240:243], a[60:63], v[100:103]
    s_nop 7
    v_cmp_u_f32 s[86:87], v100, v100
    s_and_b64 s[86:87], s[86:87], s[84:85]
    s_waitcnt vmcnt(0) lgkmcnt(0)
    v_cmp_u_f32 vcc, v88, v92
    v_cmp_u_f32 s[0:1], v96, v96
    s_or_b64 vcc, vcc, s[0:1]
    s_or_b64 vcc, vcc, s[86:87]
    s_cmp_lg_u64 vcc, 0
    s_nop 1
    s_cbranch_scc1 REDO25
    s_branch RBACK26
RGIVE38:
    s_mov_b32 s53, 0
    s_branch RBACK26
SLOW27:
    buffer_store_dwordx4 v[240:243], v5, s[36:39], s57 offen offset:0 sc1
    buffer_store_dwordx4 v[246:249], v5, s[36:39], s57 offen offset:1024 sc1
    s_mov_b32 exec_hi, 0
    buffer_store_dwordx2 v[244:245], v6, s[36:39], s57 offen offset:0 sc1
    buffer_store_dwordx2 v[250:251], v6, s[36:39], s57 offen offset:1024 sc1
    s_mov_b64 exec, -1
    s_branch BACK28
SLOW29:
    s_mov_b64 exec, 1
    buffer_store_dword v61, off, s[36:39], s60 sc1
    s_mov_b64 exec, -1
    s_branch BACK30
SLOW31:
    buffer_store_dwordx4 v[216:219], v5, s[36:39], s56 offen offset:0 sc1
    buffer_store_dwordx4 v[222:225], v5, s[36:39], s56 offen offset:1024 sc1
    s_mov_b32 exec_hi, 0
    buffer_store_dwordx2 v[220:221], v6, s[36:39], s56 offen offset:0 sc1
    buffer_store_dwordx2 v[226:227], v6, s[36:39], s56 offen offset:1024 sc1
    s_mov_b64 exec, -1
    s_branch BACK32
SLOW33:
    buffer_store_dword v228, v7, s[36:39], s56 offen sc1
    s_branch BACK34
SLOW35:
    s_mov_b64 exec, 1
    buffer_store_dword v61, off, s[36:39], s60 sc1
    s_mov_b64 exec, -1
    s_branch BACK36
FINAL:
    v_cvt_pk_bf16_f32 v216, v64, v65
    v_cvt_pk_bf16_f32 v217, v66, v67
    v_cvt_pk_bf16_f32 v218, v68, v69
    v_cvt_pk_bf16_f32 v219, v70, v71
    v_cvt_pk_bf16_f32 v220, v72, v73
    v_cvt_pk_bf16_f32 v221, v74, v75
    v_cvt_pk_bf16_f32 v222, v76, v77
    v_cvt_pk_bf16_f32 v223, v78, v79
    v_cvt_pk_bf16_f32 v224, v80, v81
    v_cvt_pk_bf16_f32 v225, v82, v83
    v_cvt_pk_bf16_f32 v226, v84, v85
    v_cvt_pk_bf16_f32 v227, v86, v87
    buffer_store_dwordx2 v[216:217], v48, s[28:31], s62 offen offset:0
    buffer_store_dwordx2 v[218:219], v48, s[28:31], s62 offen offset:32
    buffer_store_dwordx2 v[222:223], v48, s[28:31], s63 offen offset:0
    buffer_store_dwordx2 v[224:225], v48, s[28:31], s63 offen offset:32
    s_mov_b32 exec_hi, 0
    buffer_store_dwordx2 v[220:221], v49, s[28:31], s62 offen
    buffer_store_dwordx2 v[226:227], v49, s[28:31], s63 offen
    s_mov_b64 exec, -1
ABORT:
    s_mov_b64 exec, -1
    s_waitcnt vmcnt(0) lgkmcnt(0)
END:
s_endpgm
.section .rodata,"a"
.p2align 6
.amdhsa_kernel interleave_layers__linear_attn_block__linear_kernel_hedgehog__prompt_kernel
  .amdhsa_next_free_vgpr 512
  .amdhsa_next_free_sgpr 102
  .amdhsa_accum_offset 256
  .amdhsa_group_segment_fixed_size 0
  .amdhsa_kernarg_size 80
  .amdhsa_user_sgpr_count 2
  .amdhsa_user_sgpr_kernarg_segment_ptr 1
  .amdhsa_system_sgpr_workgroup_id_x 1
.end_amdhsa_kernel
```
